```python
import torch

def _softmax(x, axis=-1):
    return torch.softmax(x, dim=axis)
def _gelu(x):
    return torch.nn.functional.gelu(x, approximate="tanh")
def _silu(x):
    return torch.nn.functional.silu(x)
def _sigmoid(x):
    return torch.sigmoid(x)
def _layernorm(x, axis=-1, eps=1e-5):
    m = x.mean(dim=axis, keepdim=True)
    v = x.var(dim=axis, keepdim=True, unbiased=False)
    return (x - m) / torch.sqrt(v + eps)
def _scatter_add(tgt, idx, src, axis=0):
    return tgt.clone().index_add_(axis, idx, src)
def _segment_sum(src, seg, n):
    out = torch.zeros((n,) + src.shape[1:], dtype=src.dtype)
    return out.index_add_(0, seg, src)
def _pad(x, pw):
    flat = tuple(v for pair in reversed(pw) for v in pair)
    return torch.nn.functional.pad(x, flat)

kernel_name = 'recurrent_scan__sliding_block__geglu_ffn__prompt'

def setup_inputs():

    _w = (lambda a: (lambda t: t.to(torch.bfloat16) if t.is_floating_point() else t)(torch.as_tensor(a)))
    def _A_setup():
        B, S, D = 1, 2048, 448
        return {
            "x": _w((lambda *s: torch.randn(*s, dtype=torch.bfloat16) * 0.05)(B, S, D)),
            "wqkv": _w((lambda *s: torch.randn(*s, dtype=torch.bfloat16) * 0.05)(D, 3 * D)),
            "wo": _w((lambda *s: torch.randn(*s, dtype=torch.bfloat16) * 0.05)(D, D)),
        }
    _A_in = _A_setup()

    def _B_setup():
        B, S, D, F = 1, 2048, 448, 1792
        return {
            "x": _w((lambda *s: torch.randn(*s, dtype=torch.bfloat16) * 0.05)(B, S, D)),
            "w_gate": _w((lambda *s: torch.randn(*s, dtype=torch.bfloat16) * 0.05)(D, F)),
            "w_up": _w((lambda *s: torch.randn(*s, dtype=torch.bfloat16) * 0.05)(D, F)),
            "w_down": _w((lambda *s: torch.randn(*s, dtype=torch.bfloat16) * 0.05)(F, D)),
        }
    _B_in = _B_setup()

    return {
        "A_x": _A_in["x"],
        "A_wqkv": _A_in["wqkv"],
        "A_wo": _A_in["wo"],
        "B_x": _B_in["x"],
        "B_w_gate": _B_in["w_gate"],
        "B_w_up": _B_in["w_up"],
        "B_w_down": _B_in["w_down"],
    }

def reference(A_x, A_wqkv, A_wo, B_x, B_w_gate, B_w_up, B_w_down):
    def _A_ref(x, wqkv, wo):
        B, S, D = x.shape
        H = 16; Dh = D // H; W = 256
        qkv = (lambda x, *d: x.permute(*d))((x @ wqkv).reshape(B, S, 3, H, Dh), 2, 0, 3, 1, 4)
        q, k, v = qkv[0], qkv[1], qkv[2]
        scores = torch.einsum("bhqd,bhkd->bhqk", q, k) * (Dh ** -0.5)
        idx = torch.arange(S)
        mask = (idx[:, None] - idx[None, :] >= 0) & (idx[:, None] - idx[None, :] < W)
        scores = torch.where(mask[None, None], scores, -1e9)
        p = _softmax(scores, axis=-1)
        o = torch.einsum("bhqk,bhkd->bhqd", p, v)
        return (lambda x, *d: x.permute(*d))(o, 0, 2, 1, 3).reshape(B, S, D) @ wo

    def _B_ref(x, w_gate, w_up, w_down):
        return (_gelu(x @ w_gate) * (x @ w_up)) @ w_down

    x = A_x
    xn = _layernorm(x, axis=-1)
    s = _A_ref(xn, A_wqkv, A_wo)
    g = _silu(_B_ref(xn, B_w_gate, B_w_up, B_w_down))
    return x + s * g
```

```asm
; @launch grid=(256,1,1) block=(512,1,1) lds=163840
.amdgcn_target "amdgcn-amd-amdhsa--gfx950"
.text
.globl recurrent_scan__sliding_block__geglu_ffn__prompt_kernel
.p2align 8
.type recurrent_scan__sliding_block__geglu_ffn__prompt_kernel,@function
recurrent_scan__sliding_block__geglu_ffn__prompt_kernel:
    s_cmp_ge_u32 s2, 256
    s_nop 0
    s_cbranch_scc1 L_end
    s_load_dwordx2 s[52:53], s[0:1], 0
    s_load_dwordx2 s[36:37], s[0:1], 32
    s_load_dwordx2 s[44:45], s[0:1], 8
    s_load_dwordx2 s[68:69], s[0:1], 64
    s_memrealtime s[76:77]
    s_getpc_b64 s[78:79]
L_pc:
    s_lshr_b32 s4, s2, 3
    v_lshrrev_b32 v22, 5, v0
    s_lshl_b32 s34, s4, 4
    v_add_u32 v22, s34, v22
    v_lshlrev_b32 v22, 7, v22
    v_min_u32 v22, L_code_end-L_pc-4, v22
    v_lshrrev_b32_e64 v1, 6, v0
    global_load_dword v23, v22, s[78:79]
    v_readfirstlane_b32 s5, v1
    v_and_b32 v0, 63, v0
    s_and_b32 s3, s2, 7
    s_and_b32 s6, s3, 1
    s_lshl_b32 s6, s6, 2
    s_and_b32 s98, s4, 3
    s_add_u32 s6, s6, s98
    s_lshr_b32 s99, s4, 2
    s_and_b32 s90, s3, 1
    s_add_u32 s90, s90, s99
    s_lshl_b32 s13, s98, 1
    s_add_u32 s90, s90, s13
    s_cmp_ge_u32 s90, 7
    s_cselect_b32 s13, 7, 0
    s_sub_u32 s90, s90, s13
    s_cmp_ge_u32 s90, 7
    s_cselect_b32 s13, 7, 0
    s_sub_u32 s90, s90, s13
    v_lshrrev_b32 v12, 3, v0
    v_and_b32 v13, 7, v0
    v_lshrrev_b32 v9, 4, v0
    v_xor_b32 v10, v9, v13
    v_mul_u32_u24 v2, 896, v12
    v_lshl_add_u32 v2, v10, 4, v2
    v_xor_b32 v3, 64, v2
    s_lshl_b32 s8, s6, 3
    s_add_u32 s8, s8, s5
    s_lshr_b32 s15, s5, 2
    s_mov_b32 s54, 1835008
    s_mov_b32 s55, 0x00020000
    s_mul_i32 s16, s8, 28672
    s_lshl_b32 s17, s5, 12
    s_add_u32 s17, s17, 86016
    s_lshr_b32 s7, s3, 1
    s_lshl_b32 s13, s7, 1
    s_add_u32 s13, s13, 18
    s_mul_i32 s7, s7, 6
    s_cmp_lt_u32 s99, 6
    s_cselect_b32 s7, s7, s13
    s_add_u32 s7, s7, s99
    s_cmp_lg_u32 s15, 0
    s_waitcnt lgkmcnt(0)
    s_cbranch_scc1 L_x0a
    s_lshl_b32 s32, s90, 7
    s_add_u32 m0, s17, 0
    s_add_u32 s32, s32, s16
    buffer_load_dwordx4 v2, s[52:55], s32 offen lds
    s_add_u32 m0, s17, 1024
    s_add_u32 s32, s32, 7168
    buffer_load_dwordx4 v3, s[52:55], s32 offen lds
    s_add_u32 m0, s17, 2048
    s_add_u32 s32, s32, 7168
    buffer_load_dwordx4 v2, s[52:55], s32 offen lds
    s_add_u32 m0, s17, 3072
    s_add_u32 s32, s32, 7168
    buffer_load_dwordx4 v3, s[52:55], s32 offen lds
    s_or_b32 s34, s2, s5
    s_cmp_lg_u32 s34, 0
    s_cbranch_scc1 L_x0a
    s_mov_b32 s70, 256
    s_mov_b32 s71, 0x00020000
    s_mul_i32 s34, s76, 0x9E3779B1
    s_or_b32 s34, s34, 1
    v_mov_b32_e64 v20, s34
    buffer_store_dword v20, off, s[68:71], 0 sc0 sc1
L_x0a:
    v_and_b32 v9, 1, v9
    v_lshlrev_b32 v9, 2, v9
    v_xor_b32_e64 v9, v9, v13
    v_mul_u32_u24 v4, 3584, v12
    v_lshl_add_u32 v4, v9, 4, v4
    v_lshrrev_b32_e64 v12, 2, v0
    v_and_b32 v13, 3, v0
    v_mul_u32_u24 v5, 2688, v12
    v_lshl_add_u32 v5, v13, 4, v5
    s_and_b32 s14, s5, 3
    s_mov_b32 s38, 1605632
    s_mov_b32 s39, 0x00020000
    s_mov_b32 s46, 1204224
    s_mov_b32 s47, 0x00020000
    s_mul_i32 s11, s5, 21504
    s_lshl_b32 s13, s5, 9
    s_add_u32 s13, s13, 57344
    s_mov_b32 s74, -1
    s_mov_b32 s75, 0
    s_cmp_lt_u32 s7, 16
    s_cbranch_scc1 L_a_A1
    s_cmp_lt_u32 s7, 24
    s_cbranch_scc1 L_a_A2
    s_branch L_a_B
L_a_A1:
    s_add_u32 s19, s7, 32
    s_mul_i32 s10, s5, 28672
    s_lshl_b32 s34, s7, 7
    s_add_u32 s10, s10, s34
    s_lshl_b32 s12, s5, 10
    s_mov_b32 s34, s19
    s_and_b32 s25, s34, 1
    s_mul_i32 s33, s34, 56
    s_add_u32 s11, s11, s33
    s_lshl_b32 s33, s25, 3
    s_sub_u32 s11, s11, s33
    s_mul_i32 s34, s90, 229376
    s_add_u32 m0, s12, 0
    s_add_u32 s34, s34, s10
    buffer_load_dwordx4 v4, s[36:39], s34 offen lds
    s_mul_i32 s34, s90, 172032
    s_add_u32 m0, s13, 0
    s_add_u32 s34, s34, s11
    s_mov_b64 exec, s[74:75]
    buffer_load_dwordx4 v5, s[44:47], s34 offen lds
    s_mov_b64 exec, -1
    s_load_dwordx2 s[48:49], s[0:1], 72
    s_load_dwordx2 s[40:41], s[0:1], 40
    s_load_dwordx2 s[56:57], s[0:1], 48
    s_load_dwordx2 s[60:61], s[0:1], 16
    s_load_dwordx2 s[64:65], s[0:1], 56
    v_lshlrev_b32 v1, 4, v0
    s_cmp_eq_u32 s15, 0
    s_cbranch_scc1 L_nosrA1
    v_and_b32 v137, 31, v0
    v_cmp_gt_u32 vcc, 28, v137
    v_lshrrev_b32 v136, 5, v0
    v_mul_u32_u24 v136, 896, v136
    v_lshl_add_u32 v136, v137, 5, v136
    v_mov_b32 v137, 0x7fffff00
    v_cndmask_b32 v136, v137, v136, vcc
    s_lshl_b32 s98, s6, 8
    s_lshl_b32 s34, s7, 3
    s_add_u32 s98, s98, s34
    s_lshl_b32 s34, s14, 1
    s_add_u32 s98, s98, s34
    s_mul_i32 s33, s98, 896
    buffer_load_dwordx4 v[80:83], v136, s[52:55], s33 offen
    buffer_load_dwordx4 v[84:87], v136, s[52:55], s33 offen offset:16
L_nosrA1:
    s_add_u32 s91, s90, 1
    s_cmp_ge_u32 s91, 7
    s_cselect_b32 s34, 7, 0
    s_sub_u32 s91, s91, s34
    s_add_u32 s92, s90, 2
    s_cmp_ge_u32 s92, 7
    s_cselect_b32 s34, 7, 0
    s_sub_u32 s92, s92, s34
    s_add_u32 s93, s90, 3
    s_cmp_ge_u32 s93, 7
    s_cselect_b32 s34, 7, 0
    s_sub_u32 s93, s93, s34
    s_add_u32 s94, s90, 4
    s_cmp_ge_u32 s94, 7
    s_cselect_b32 s34, 7, 0
    s_sub_u32 s94, s94, s34
    s_add_u32 s95, s90, 5
    s_cmp_ge_u32 s95, 7
    s_cselect_b32 s34, 7, 0
    s_sub_u32 s95, s95, s34
    s_add_u32 s96, s90, 6
    s_cmp_ge_u32 s96, 7
    s_cselect_b32 s34, 7, 0
    s_sub_u32 s96, s96, s34
    s_mov_b32 s70, 256
    s_mov_b32 s71, 0x00020000
    s_mov_b32 s50, 19922944
    s_mov_b32 s51, 0x00020000
    s_mov_b32 s42, 1605632
    s_mov_b32 s43, 0x00020000
    s_mov_b32 s58, 1605632
    s_mov_b32 s59, 0x00020000
    s_mov_b32 s62, 401408
    s_mov_b32 s63, 0x00020000
    s_mov_b32 s66, 1835008
    s_mov_b32 s67, 0x00020000
    v_and_b32_e64 v6, 31, v0
    v_bfe_u32 v7, v0, 1, 3
    v_lshrrev_b32 v17, 5, v0
    v_xor_b32 v7, v7, v17
    v_lshlrev_b32_e64 v7, 4, v7
    v_lshl_add_u32 v6, v6, 7, v7
    v_add_u32 v6, s17, v6
    v_xor_b32 v7, 32, v6
    v_xor_b32_e64 v8, 64, v6
    v_xor_b32 v9, 96, v6
    v_and_b32_e64 v18, 3, v12
    v_lshl_add_u32 v17, v17, 3, v18
    v_bfe_u32 v19, v0, 4, 1
    v_lshl_add_u32 v20, v19, 2, v13
    v_and_b32 v21, 1, v13
    v_lshlrev_b32 v21, 1, v21
    v_lshl_add_u32 v21, v19, 2, v21
    v_lshrrev_b32 v22, 1, v13
    v_add_u32 v21, v21, v22
    v_lshlrev_b32 v21, 3, v21
    v_lshrrev_b32 v18, 1, v18
    v_lshl_add_u32 v10, v18, 6, v21
    v_lshl_add_u32 v10, v17, 7, v10
    v_xor_b32 v11, 64, v10
    s_lshl_b32 s34, s15, 6
    s_lshl_b32 s35, s14, 11
    v_xor_b32 v13, s34, v10
    v_add_u32 v13, s35, v13
    v_add_u32 v12, s25, v20
    v_and_b32 v12, 7, v12
    v_lshlrev_b32 v12, 3, v12
    v_lshl_add_u32 v12, v17, 6, v12
    v_add_u32 v12, 57344, v12
    s_mul_i32 s34, s14, 1024
    s_mul_i32 s35, s15, 4096
    s_add_u32 s34, s34, s35
    v_add_u32 v14, s34, v12
    v_bfe_u32 v19, v0, 2, 1
    v_bfe_u32 v20, v0, 4, 1
    v_xor_b32 v19, v19, v20
    v_and_b32 v20, 3, v0
    v_or_b32 v19, v19, v20
    v_cmp_eq_u32 vcc, 0, v19
    v_mov_b32 v20, 0x3f803f80
    v_and_b32 v19, 31, v0
    v_cndmask_b32 v24, 0, v20, vcc
    v_cmp_eq_u32 vcc, 28, v19
    v_mov_b32 v25, v24
    v_mov_b32 v26, v24
    v_cndmask_b32 v17, 0, v20, vcc
    v_mov_b32 v27, v24
    v_lshlrev_b32 v16, 4, v19
    v_add_u32 v16, 151552, v16
    s_lshl_b32 s34, s14, 2
    s_lshl_b32 s35, s15, 9
    s_add_u32 s34, s34, s35
    v_add_u32 v15, s34, v16
    s_mov_b32 s72, 0
    s_mov_b32 s73, -1
    v_mov_b32 v30, 0
    v_mov_b32 v31, 0
    v_mov_b32 v34, 0
    v_mov_b32 v35, 0
    v_mov_b32_e64 v38, 0
    v_mov_b32 v22, 156672
    v_add_u32_e64 v22, v22, v1
    v_mov_b32 v39, 0
    ds_write_b32 v22, v30
    s_add_u32 s34, s19, 0
    s_lshr_b32 s35, s34, 4
    s_and_b32 s34, s34, 15
    s_lshl_b32 s20, s35, 21
    s_lshl_b32 s34, s34, 17
    s_add_u32 s20, s20, s34
    s_lshl_b32 s34, s8, 11
    s_add_u32 s20, s20, s34
    s_add_u32 s20, s20, 2097152
    s_cmp_eq_u32 s35, 0
    s_cselect_b32 s26, 0x3f80, 0
    s_lshl_b32 s19, s19, 8
    s_lshl_b32 s34, s8, 2
    s_add_u32 s19, s19, s34
    s_add_u32 s19, s19, 18939904
    s_lshl_b32 s18, s7, 12
    s_mul_i32 s34, s8, 114688
    s_add_u32 s18, s18, s34
    s_add_u32 s18, s18, 8388608
    s_cmp_eq_u32 s15, 0
    s_cbranch_scc1 L_x0b1
    s_lshl_b32 s32, s90, 7
    s_add_u32 m0, s17, 0
    s_add_u32 s32, s32, s16
    buffer_load_dwordx4 v2, s[52:55], s32 offen lds
    s_add_u32 m0, s17, 1024
    s_add_u32 s32, s32, 7168
    buffer_load_dwordx4 v3, s[52:55], s32 offen lds
    s_add_u32 m0, s17, 2048
    s_add_u32 s32, s32, 7168
    buffer_load_dwordx4 v2, s[52:55], s32 offen lds
    s_add_u32 m0, s17, 3072
    s_add_u32 s32, s32, 7168
    buffer_load_dwordx4 v3, s[52:55], s32 offen lds
L_x0b1:
    s_mul_i32 s34, s91, 229376
    s_add_u32 m0, s12, 8192
    s_add_u32 s34, s34, s10
    buffer_load_dwordx4 v4, s[36:39], s34 offen lds
    s_mul_i32 s34, s91, 172032
    s_add_u32 m0, s13, 4096
    s_add_u32 s34, s34, s11
    s_mov_b64 exec, s[74:75]
    buffer_load_dwordx4 v5, s[44:47], s34 offen lds
    s_mov_b64 exec, -1
    s_cmp_eq_u32 s15, 0
    s_cbranch_scc1 L_x0b2
    s_waitcnt vmcnt(8) lgkmcnt(0)
    s_branch L_x0c2
L_x0b2:
    s_waitcnt vmcnt(2) lgkmcnt(0)
L_x0c2:
    s_barrier
    s_cmp_eq_u32 s15, 0
    s_cbranch_scc1 L_st3
    s_waitcnt vmcnt(6)
    v_lshlrev_b32 v96, 16, v80
    v_and_b32 v97, 0xffff0000, v80
    v_lshlrev_b32_e64 v98, 16, v81
    v_and_b32 v99, 0xffff0000, v81
    v_lshlrev_b32_e64 v100, 16, v82
    v_and_b32 v101, 0xffff0000, v82
    v_lshlrev_b32_e64 v102, 16, v83
    v_and_b32 v103, 0xffff0000, v83
    v_lshlrev_b32_e64 v104, 16, v84
    v_and_b32 v105, 0xffff0000, v84
    v_lshlrev_b32_e64 v106, 16, v85
    v_and_b32 v107, 0xffff0000, v85
    v_lshlrev_b32_e64 v108, 16, v86
    v_and_b32 v109, 0xffff0000, v86
    v_lshlrev_b32_e64 v110, 16, v87
    v_and_b32 v111, 0xffff0000, v87
    v_add_f32 v128, v96, v97
    v_mul_f32 v129, v96, v96
    v_fmac_f32 v129, v97, v97
    v_add_f32 v128, v128, v98
    v_fmac_f32 v129, v98, v98
    v_add_f32 v128, v128, v99
    v_fmac_f32 v129, v99, v99
    v_add_f32 v128, v128, v100
    v_fmac_f32 v129, v100, v100
    v_add_f32 v128, v128, v101
    v_fmac_f32 v129, v101, v101
    v_add_f32 v128, v128, v102
    v_fmac_f32 v129, v102, v102
    v_add_f32 v128, v128, v103
    v_fmac_f32 v129, v103, v103
    v_add_f32 v128, v128, v104
    v_fmac_f32 v129, v104, v104
    v_add_f32 v128, v128, v105
    v_fmac_f32 v129, v105, v105
    v_add_f32 v128, v128, v106
    v_fmac_f32 v129, v106, v106
    v_add_f32 v128, v128, v107
    v_fmac_f32 v129, v107, v107
    v_add_f32 v128, v128, v108
    v_fmac_f32 v129, v108, v108
    v_add_f32 v128, v128, v109
    v_fmac_f32 v129, v109, v109
    v_add_f32 v128, v128, v110
    v_fmac_f32 v129, v110, v110
    v_add_f32 v128, v128, v111
    v_fmac_f32 v129, v111, v111
    s_nop 0
    v_add_f32_dpp v128, v128, v128 quad_perm:[1,0,3,2] row_mask:0xf bank_mask:0xf
    v_add_f32_dpp v129, v129, v129 quad_perm:[1,0,3,2] row_mask:0xf bank_mask:0xf
    s_nop 0
    v_add_f32_dpp v128, v128, v128 quad_perm:[2,3,0,1] row_mask:0xf bank_mask:0xf
    v_add_f32_dpp v129, v129, v129 quad_perm:[2,3,0,1] row_mask:0xf bank_mask:0xf
    s_nop 0
    v_add_f32_dpp v128, v128, v128 row_half_mirror row_mask:0xf bank_mask:0xf
    v_add_f32_dpp v129, v129, v129 row_half_mirror row_mask:0xf bank_mask:0xf
    s_nop 0
    v_add_f32_dpp v128, v128, v128 row_mirror row_mask:0xf bank_mask:0xf
    v_add_f32_dpp v129, v129, v129 row_mirror row_mask:0xf bank_mask:0xf
    v_mov_b32 v130, v128
    v_mov_b32_e64 v131, v129
    s_mov_b32 s76, 0x3b124925
    v_permlane16_swap_b32 v128, v130
    v_permlane16_swap_b32 v129, v131
    v_add_f32 v128, v128, v130
    v_add_f32 v129, v129, v131
    v_mul_f32 v128, s76, v128
    v_mul_f32 v129, s76, v129
    v_fma_f32 v129, -v128, v128, v129
    v_max_f32_e64 v129, 0, v129
    v_add_f32 v129, 0x3727c5ac, v129
    s_lshl_b32 s98, s98, 4
    s_add_u32 s98, s98, 18874368
L_st3:
    s_waitcnt vmcnt(2)
    ds_read_b128 v[144:147], v6 offset:0
    ds_read_b128 v[148:151], v7 offset:0
    ds_read_b128 v[152:155], v8 offset:0
    ds_read_b128 v[156:159], v9 offset:0
    ds_read_b64_tr_b16 v[40:41], v10 offset:0
    ds_read_b64_tr_b16 v[42:43], v10 offset:512
    ds_read_b64_tr_b16 v[44:45], v11 offset:0
    ds_read_b64_tr_b16 v[46:47], v11 offset:512
    ds_read_b64_tr_b16 v[48:49], v12 offset:0
    ds_read_b64_tr_b16 v[50:51], v12 offset:256
    s_waitcnt lgkmcnt(0)
    v_mfma_f32_32x32x16_bf16 v[80:95], v[40:43], v[144:147], 0
    s_lshl_b32 s32, s91, 7
    s_add_u32 m0, s17, 32768
    s_nop 0
    s_add_u32 s32, s32, s16
    buffer_load_dwordx4 v2, s[52:55], s32 offen lds
    ds_read_b64_tr_b16 v[52:53], v10 offset:2048
    ds_read_b64_tr_b16 v[54:55], v10 offset:2560
    v_mfma_f32_32x32x16_bf16 v[96:111], v[44:47], v[144:147], 0
    s_add_u32 m0, s17, 33792
    s_add_u32 s32, s32, 7168
    buffer_load_dwordx4 v3, s[52:55], s32 offen lds
    ds_read_b64_tr_b16 v[56:57], v11 offset:2048
    ds_read_b64_tr_b16 v[58:59], v11 offset:2560
    v_mfma_f32_32x32x16_bf16 v[112:127], v[144:147], v[48:51], 0
    s_add_u32 m0, s17, 34816
    s_add_u32 s32, s32, 7168
    buffer_load_dwordx4 v2, s[52:55], s32 offen lds
    ds_read_b64_tr_b16 v[60:61], v12 offset:1024
    ds_read_b64_tr_b16 v[62:63], v12 offset:1280
    ds_read_b64_tr_b16 v[72:73], v13 offset:0
    ds_read_b64_tr_b16 v[74:75], v13 offset:512
    s_nop 0
    s_waitcnt lgkmcnt(2)
    v_mfma_f32_32x32x16_bf16 v[80:95], v[52:55], v[148:151], v[80:95]
    s_add_u32 m0, s17, 35840
    s_add_u32 s32, s32, 7168
    buffer_load_dwordx4 v3, s[52:55], s32 offen lds
    ds_read_b64_tr_b16 v[40:41], v10 offset:4096
    ds_read_b64_tr_b16 v[42:43], v10 offset:4608
    v_mfma_f32_32x32x16_bf16 v[96:111], v[56:59], v[148:151], v[96:111]
    s_mul_i32 s34, s92, 229376
    s_add_u32 m0, s12, 16384
    s_add_u32 s34, s34, s10
    buffer_load_dwordx4 v4, s[36:39], s34 offen lds
    s_mul_i32 s34, s92, 172032
    ds_read_b64_tr_b16 v[44:45], v11 offset:4096
    ds_read_b64_tr_b16 v[46:47], v11 offset:4608
    s_waitcnt lgkmcnt(4)
    v_mfma_f32_16x16x32_bf16 v[64:67], v[24:27], v[72:75], 0
    v_mfma_f32_32x32x16_bf16 v[112:127], v[148:151], v[60:63], v[112:127]
    s_add_u32 m0, s13, 8192
    s_add_u32 s34, s34, s11
    s_mov_b64 exec, s[74:75]
    buffer_load_dwordx4 v5, s[44:47], s34 offen lds
    s_nop 0
    s_mov_b64 exec, -1
    ds_read_b64_tr_b16 v[48:49], v12 offset:2048
    ds_read_b64_tr_b16 v[50:51], v12 offset:2304
    s_waitcnt lgkmcnt(0)
    v_mfma_f32_32x32x16_bf16 v[80:95], v[40:43], v[152:155], v[80:95]
    s_lshl_b32 s32, s92, 7
    s_add_u32 m0, s17, 0
    s_add_u32 s32, s32, s16
    buffer_load_dwordx4 v2, s[52:55], s32 offen lds
    s_add_u32 m0, s17, 1024
    s_add_u32 s32, s32, 7168
    buffer_load_dwordx4 v3, s[52:55], s32 offen lds
    s_add_u32 m0, s17, 2048
    s_add_u32 s32, s32, 7168
    buffer_load_dwordx4 v2, s[52:55], s32 offen lds
    s_add_u32 m0, s17, 3072
    s_add_u32 s32, s32, 7168
    buffer_load_dwordx4 v3, s[52:55], s32 offen lds
    ds_read_b64_tr_b16 v[52:53], v10 offset:6144
    ds_read_b64_tr_b16 v[54:55], v10 offset:6656
    v_mfma_f32_32x32x16_bf16 v[96:111], v[44:47], v[152:155], v[96:111]
    ds_read_b64_tr_b16 v[56:57], v11 offset:6144
    ds_read_b64_tr_b16 v[58:59], v11 offset:6656
    v_mfma_f32_32x32x16_bf16 v[112:127], v[152:155], v[48:51], v[112:127]
    ds_read_b64_tr_b16 v[60:61], v12 offset:3072
    ds_read_b64_tr_b16 v[62:63], v12 offset:3328
    s_waitcnt vmcnt(10)
    s_barrier
    s_waitcnt lgkmcnt(0)
    v_mfma_f32_32x32x16_bf16 v[80:95], v[52:55], v[156:159], v[80:95]
    s_waitcnt vmcnt(6)
    ds_read_b128 v[160:163], v6 offset:32768
    ds_read_b128 v[164:167], v7 offset:32768
    v_mfma_f32_32x32x16_bf16 v[96:111], v[56:59], v[156:159], v[96:111]
    ds_read_b128 v[168:171], v8 offset:32768
    ds_read_b128 v[172:175], v9 offset:32768
    ds_read_b64_tr_b16 v[40:41], v10 offset:8192
    ds_read_b64_tr_b16 v[42:43], v10 offset:8704
    v_mfma_f32_32x32x16_bf16 v[112:127], v[156:159], v[60:63], v[112:127]
    s_lshl_b32 s78, s2, 3
    s_add_u32 s78, s78, s5
    v_min_u32 v23, 6, v0
    v_lshlrev_b32 v23, 7, v23
    s_mul_i32 s79, s78, 784
    buffer_load_dword v143, v23, s[40:43], s79 offen
    s_lshr_b32 s79, s78, 2
    s_mul_i32 s79, s79, 3584
    s_and_b32 s78, s78, 3
    s_lshl_b32 s78, s78, 7
    s_add_u32 s79, s79, s78
    s_add_u32 s79, s79, 3072
    buffer_load_dword v143, off, s[36:39], s79
    ds_read_b64_tr_b16 v[44:45], v11 offset:8192
    ds_read_b64_tr_b16 v[46:47], v11 offset:8704
    ds_read_b64_tr_b16 v[48:49], v12 offset:4096
    ds_read_b64_tr_b16 v[50:51], v12 offset:4352
    s_waitcnt lgkmcnt(0)
    v_mfma_f32_32x32x16_bf16 v[80:95], v[40:43], v[160:163], v[80:95]
    s_mul_i32 s34, s93, 229376
    s_add_u32 m0, s12, 24576
    s_add_u32 s34, s34, s10
    buffer_load_dwordx4 v4, s[36:39], s34 offen lds
    s_mul_i32 s34, s93, 172032
    ds_read_b64_tr_b16 v[52:53], v10 offset:10240
    ds_read_b64_tr_b16 v[54:55], v10 offset:10752
    v_mfma_f32_32x32x16_bf16 v[96:111], v[44:47], v[160:163], v[96:111]
    ds_read_b64_tr_b16 v[56:57], v11 offset:10240
    ds_read_b64_tr_b16 v[58:59], v11 offset:10752
    v_mfma_f32_32x32x16_bf16 v[112:127], v[160:163], v[48:51], v[112:127]
    s_add_u32 m0, s13, 12288
    s_add_u32 s34, s34, s11
    s_mov_b64 exec, s[74:75]
    buffer_load_dwordx4 v5, s[44:47], s34 offen lds
    s_mov_b64 exec, -1
    ds_read_b64_tr_b16 v[60:61], v12 offset:5120
    ds_read_b64_tr_b16 v[62:63], v12 offset:5376
    ds_read_b64_tr_b16 v[72:73], v13 offset:8192
    ds_read_b64_tr_b16 v[74:75], v13 offset:8704
    ds_read_b64_tr_b16 v[76:77], v14 offset:0
    ds_read_b64_tr_b16 v[78:79], v14 offset:256
    s_waitcnt lgkmcnt(4)
    v_mfma_f32_32x32x16_bf16 v[80:95], v[52:55], v[164:167], v[80:95]
    buffer_load_dword v138, off, s[68:71], 0 sc1
    ds_read_b64_tr_b16 v[40:41], v10 offset:12288
    ds_read_b64_tr_b16 v[42:43], v10 offset:12800
    v_mfma_f32_32x32x16_bf16 v[96:111], v[56:59], v[164:167], v[96:111]
    s_lshl_b32 s32, s93, 7
    s_add_u32 m0, s17, 32768
    s_add_u32 s32, s32, s16
    buffer_load_dwordx4 v2, s[52:55], s32 offen lds
    s_add_u32 m0, s17, 33792
    s_add_u32 s32, s32, 7168
    buffer_load_dwordx4 v3, s[52:55], s32 offen lds
    s_add_u32 m0, s17, 34816
    s_add_u32 s32, s32, 7168
    buffer_load_dwordx4 v2, s[52:55], s32 offen lds
    s_add_u32 m0, s17, 35840
    s_add_u32 s32, s32, 7168
    buffer_load_dwordx4 v3, s[52:55], s32 offen lds
    ds_read_b64_tr_b16 v[44:45], v11 offset:12288
    ds_read_b64_tr_b16 v[46:47], v11 offset:12800
    s_nop 0
    s_waitcnt lgkmcnt(6)
    v_mfma_f32_16x16x32_bf16 v[64:67], v[24:27], v[72:75], v[64:67]
    v_mfma_f32_32x32x16_bf16 v[112:127], v[164:167], v[60:63], v[112:127]
    ds_read_b64_tr_b16 v[48:49], v12 offset:6144
    ds_read_b64_tr_b16 v[50:51], v12 offset:6400
    s_waitcnt lgkmcnt(6)
    v_mfma_f32_16x16x32_bf16 v[68:71], v[24:27], v[76:79], 0
    s_waitcnt lgkmcnt(0)
    v_mfma_f32_32x32x16_bf16 v[80:95], v[40:43], v[168:171], v[80:95]
    ds_read_b64_tr_b16 v[52:53], v10 offset:14336
    ds_read_b64_tr_b16 v[54:55], v10 offset:14848
    v_mfma_f32_32x32x16_bf16 v[96:111], v[44:47], v[168:171], v[96:111]
    ds_read_b64_tr_b16 v[56:57], v11 offset:14336
    ds_read_b64_tr_b16 v[58:59], v11 offset:14848
    v_mfma_f32_32x32x16_bf16 v[112:127], v[168:171], v[48:51], v[112:127]
    ds_read_b64_tr_b16 v[60:61], v12 offset:7168
    ds_read_b64_tr_b16 v[62:63], v12 offset:7424
    s_waitcnt vmcnt(13)
    s_barrier
    s_waitcnt lgkmcnt(0)
    v_mfma_f32_32x32x16_bf16 v[80:95], v[52:55], v[172:175], v[80:95]
    s_waitcnt vmcnt(9)
    ds_read_b128 v[176:179], v6 offset:0
    ds_read_b128 v[180:183], v7 offset:0
    v_mfma_f32_32x32x16_bf16 v[96:111], v[56:59], v[172:175], v[96:111]
    ds_read_b128 v[184:187], v8 offset:0
    ds_read_b128 v[188:191], v9 offset:0
    ds_read_b64_tr_b16 v[40:41], v10 offset:16384
    ds_read_b64_tr_b16 v[42:43], v10 offset:16896
    v_mfma_f32_32x32x16_bf16 v[112:127], v[172:175], v[60:63], v[112:127]
    ds_read_b64_tr_b16 v[44:45], v11 offset:16384
    ds_read_b64_tr_b16 v[46:47], v11 offset:16896
    ds_read_b64_tr_b16 v[48:49], v12 offset:8192
    ds_read_b64_tr_b16 v[50:51], v12 offset:8448
    s_waitcnt lgkmcnt(0)
    v_mfma_f32_32x32x16_bf16 v[80:95], v[40:43], v[176:179], v[80:95]
    s_mul_i32 s34, s94, 229376
    s_add_u32 m0, s12, 32768
    s_add_u32 s34, s34, s10
    buffer_load_dwordx4 v4, s[36:39], s34 offen lds
    s_mul_i32 s34, s94, 172032
    ds_read_b64_tr_b16 v[52:53], v10 offset:18432
    ds_read_b64_tr_b16 v[54:55], v10 offset:18944
    v_mfma_f32_32x32x16_bf16 v[96:111], v[44:47], v[176:179], v[96:111]
    ds_read_b64_tr_b16 v[56:57], v11 offset:18432
    ds_read_b64_tr_b16 v[58:59], v11 offset:18944
    v_mfma_f32_32x32x16_bf16 v[112:127], v[176:179], v[48:51], v[112:127]
    s_add_u32 m0, s13, 16384
    s_add_u32 s34, s34, s11
    s_mov_b64 exec, s[74:75]
    buffer_load_dwordx4 v5, s[44:47], s34 offen lds
    s_mov_b64 exec, -1
    ds_read_b64_tr_b16 v[60:61], v12 offset:9216
    ds_read_b64_tr_b16 v[62:63], v12 offset:9472
    ds_read_b64_tr_b16 v[72:73], v13 offset:16384
    ds_read_b64_tr_b16 v[74:75], v13 offset:16896
    s_waitcnt lgkmcnt(2)
    v_mfma_f32_32x32x16_bf16 v[80:95], v[52:55], v[180:183], v[80:95]
    ds_read_b64_tr_b16 v[40:41], v10 offset:20480
    ds_read_b64_tr_b16 v[42:43], v10 offset:20992
    v_mfma_f32_32x32x16_bf16 v[96:111], v[56:59], v[180:183], v[96:111]
    s_lshl_b32 s32, s94, 7
    s_add_u32 m0, s17, 0
    s_nop 0
    s_add_u32 s32, s32, s16
    buffer_load_dwordx4 v2, s[52:55], s32 offen lds
    s_add_u32 m0, s17, 1024
    s_add_u32 s32, s32, 7168
    buffer_load_dwordx4 v3, s[52:55], s32 offen lds
    s_add_u32 m0, s17, 2048
    s_add_u32 s32, s32, 7168
    buffer_load_dwordx4 v2, s[52:55], s32 offen lds
    s_add_u32 m0, s17, 3072
    s_add_u32 s32, s32, 7168
    buffer_load_dwordx4 v3, s[52:55], s32 offen lds
    ds_read_b64_tr_b16 v[44:45], v11 offset:20480
    ds_read_b64_tr_b16 v[46:47], v11 offset:20992
    s_waitcnt lgkmcnt(4)
    v_mfma_f32_16x16x32_bf16 v[64:67], v[24:27], v[72:75], v[64:67]
    v_mfma_f32_32x32x16_bf16 v[112:127], v[180:183], v[60:63], v[112:127]
    s_waitcnt vmcnt(10)
    v_readfirstlane_b32 s97, v138
    s_nop 0
    s_cmp_lg_u32 s97, 0
    s_cbranch_scc1 L_nok4
    s_mov_b32 s76, 200000
L_nlp4:
    s_sleep 1
    buffer_load_dword v138, off, s[68:71], 0 sc1
    s_waitcnt vmcnt(0)
    v_readfirstlane_b32 s97, v138
    s_nop 0
    s_cmp_lg_u32 s97, 0
    s_cbranch_scc1 L_nok4
    s_sub_u32 s76, s76, 1
    s_cbranch_scc0 L_nlp4
L_nok4:
    s_cmp_eq_u32 s15, 0
    s_cbranch_scc1 L_nos4
    v_lshrrev_b32 v136, 5, v0
    v_lshlrev_b32 v136, 4, v136
    v_mov_b32_e64 v130, s97
    v_mov_b32 v131, s97
    buffer_store_dwordx4 v[128:131], v136, s[48:51], s98 offen sc1
L_nos4:
    ds_read_b64_tr_b16 v[48:49], v12 offset:10240
    ds_read_b64_tr_b16 v[50:51], v12 offset:10496
    s_waitcnt lgkmcnt(0)
    v_mfma_f32_32x32x16_bf16 v[80:95], v[40:43], v[184:187], v[80:95]
    ds_read_b64_tr_b16 v[52:53], v10 offset:22528
    ds_read_b64_tr_b16 v[54:55], v10 offset:23040
    v_mfma_f32_32x32x16_bf16 v[96:111], v[44:47], v[184:187], v[96:111]
    ds_read_b64_tr_b16 v[56:57], v11 offset:22528
    ds_read_b64_tr_b16 v[58:59], v11 offset:23040
    v_mfma_f32_32x32x16_bf16 v[112:127], v[184:187], v[48:51], v[112:127]
    ds_read_b64_tr_b16 v[60:61], v12 offset:11264
    ds_read_b64_tr_b16 v[62:63], v12 offset:11520
    s_barrier
    s_waitcnt lgkmcnt(0)
    v_mfma_f32_32x32x16_bf16 v[80:95], v[52:55], v[188:191], v[80:95]
    s_nop 0
    s_waitcnt vmcnt(6)
    ds_read_b128 v[192:195], v6 offset:32768
    ds_read_b128 v[196:199], v7 offset:32768
    v_mfma_f32_32x32x16_bf16 v[96:111], v[56:59], v[188:191], v[96:111]
    ds_read_b128 v[200:203], v8 offset:32768
    ds_read_b128 v[204:207], v9 offset:32768
    ds_read_b64_tr_b16 v[40:41], v10 offset:24576
    ds_read_b64_tr_b16 v[42:43], v10 offset:25088
    v_mfma_f32_32x32x16_bf16 v[112:127], v[188:191], v[60:63], v[112:127]
    ds_read_b64_tr_b16 v[44:45], v11 offset:24576
    ds_read_b64_tr_b16 v[46:47], v11 offset:25088
    ds_read_b64_tr_b16 v[48:49], v12 offset:12288
    ds_read_b64_tr_b16 v[50:51], v12 offset:12544
    s_waitcnt lgkmcnt(0)
    v_mfma_f32_32x32x16_bf16 v[80:95], v[40:43], v[192:195], v[80:95]
    s_mul_i32 s34, s95, 229376
    s_add_u32 m0, s12, 40960
    s_add_u32 s34, s34, s10
    buffer_load_dwordx4 v4, s[36:39], s34 offen lds
    s_mul_i32 s34, s95, 172032
    ds_read_b64_tr_b16 v[52:53], v10 offset:26624
    ds_read_b64_tr_b16 v[54:55], v10 offset:27136
    v_mfma_f32_32x32x16_bf16 v[96:111], v[44:47], v[192:195], v[96:111]
    ds_read_b64_tr_b16 v[56:57], v11 offset:26624
    ds_read_b64_tr_b16 v[58:59], v11 offset:27136
    v_mfma_f32_32x32x16_bf16 v[112:127], v[192:195], v[48:51], v[112:127]
    s_add_u32 m0, s13, 20480
    s_add_u32 s34, s34, s11
    s_mov_b64 exec, s[74:75]
    buffer_load_dwordx4 v5, s[44:47], s34 offen lds
    s_mov_b64 exec, -1
    ds_read_b64_tr_b16 v[60:61], v12 offset:13312
    ds_read_b64_tr_b16 v[62:63], v12 offset:13568
    ds_read_b64_tr_b16 v[72:73], v13 offset:24576
    ds_read_b64_tr_b16 v[74:75], v13 offset:25088
    ds_read_b64_tr_b16 v[76:77], v14 offset:8192
    ds_read_b64_tr_b16 v[78:79], v14 offset:8448
    s_waitcnt lgkmcnt(4)
    v_mfma_f32_32x32x16_bf16 v[80:95], v[52:55], v[196:199], v[80:95]
    ds_read_b64_tr_b16 v[40:41], v10 offset:28672
    ds_read_b64_tr_b16 v[42:43], v10 offset:29184
    v_mfma_f32_32x32x16_bf16 v[96:111], v[56:59], v[196:199], v[96:111]
    s_lshl_b32 s32, s95, 7
    s_add_u32 m0, s17, 32768
    s_add_u32 s32, s32, s16
    buffer_load_dwordx4 v2, s[52:55], s32 offen lds
    s_add_u32 m0, s17, 33792
    s_add_u32 s32, s32, 7168
    buffer_load_dwordx4 v3, s[52:55], s32 offen lds
    s_add_u32 m0, s17, 34816
    s_add_u32 s32, s32, 7168
    buffer_load_dwordx4 v2, s[52:55], s32 offen lds
    s_add_u32 m0, s17, 35840
    s_add_u32 s32, s32, 7168
    buffer_load_dwordx4 v3, s[52:55], s32 offen lds
    ds_read_b64_tr_b16 v[44:45], v11 offset:28672
    ds_read_b64_tr_b16 v[46:47], v11 offset:29184
    s_nop 0
    s_waitcnt lgkmcnt(6)
    v_mfma_f32_16x16x32_bf16 v[64:67], v[24:27], v[72:75], v[64:67]
    v_mfma_f32_32x32x16_bf16 v[112:127], v[196:199], v[60:63], v[112:127]
    ds_read_b64_tr_b16 v[48:49], v12 offset:14336
    ds_read_b64_tr_b16 v[50:51], v12 offset:14592
    s_waitcnt lgkmcnt(6)
    v_mfma_f32_16x16x32_bf16 v[68:71], v[24:27], v[76:79], v[68:71]
    s_waitcnt lgkmcnt(0)
    v_mfma_f32_32x32x16_bf16 v[80:95], v[40:43], v[200:203], v[80:95]
    ds_read_b64_tr_b16 v[52:53], v10 offset:30720
    ds_read_b64_tr_b16 v[54:55], v10 offset:31232
    v_mfma_f32_32x32x16_bf16 v[96:111], v[44:47], v[200:203], v[96:111]
    ds_read_b64_tr_b16 v[56:57], v11 offset:30720
    ds_read_b64_tr_b16 v[58:59], v11 offset:31232
    v_mfma_f32_32x32x16_bf16 v[112:127], v[200:203], v[48:51], v[112:127]
    ds_read_b64_tr_b16 v[60:61], v12 offset:15360
    ds_read_b64_tr_b16 v[62:63], v12 offset:15616
    s_waitcnt vmcnt(10)
    s_barrier
    s_waitcnt lgkmcnt(0)
    v_mfma_f32_32x32x16_bf16 v[80:95], v[52:55], v[204:207], v[80:95]
    s_waitcnt vmcnt(6)
    ds_read_b128 v[208:211], v6 offset:0
    ds_read_b128 v[212:215], v7 offset:0
    v_mfma_f32_32x32x16_bf16 v[96:111], v[56:59], v[204:207], v[96:111]
    ds_read_b128 v[216:219], v8 offset:0
    ds_read_b128 v[220:223], v9 offset:0
    ds_read_b64_tr_b16 v[40:41], v10 offset:32768
    ds_read_b64_tr_b16 v[42:43], v10 offset:33280
    v_mfma_f32_32x32x16_bf16 v[112:127], v[204:207], v[60:63], v[112:127]
    ds_read_b64_tr_b16 v[44:45], v11 offset:32768
    ds_read_b64_tr_b16 v[46:47], v11 offset:33280
    ds_read_b64_tr_b16 v[48:49], v12 offset:16384
    ds_read_b64_tr_b16 v[50:51], v12 offset:16640
    s_waitcnt lgkmcnt(0)
    v_mfma_f32_32x32x16_bf16 v[80:95], v[40:43], v[208:211], v[80:95]
    s_mul_i32 s34, s96, 229376
    s_add_u32 m0, s12, 49152
    s_add_u32 s34, s34, s10
    buffer_load_dwordx4 v4, s[36:39], s34 offen lds
    s_mul_i32 s34, s96, 172032
    ds_read_b64_tr_b16 v[52:53], v10 offset:34816
    ds_read_b64_tr_b16 v[54:55], v10 offset:35328
    v_mfma_f32_32x32x16_bf16 v[96:111], v[44:47], v[208:211], v[96:111]
    ds_read_b64_tr_b16 v[56:57], v11 offset:34816
    ds_read_b64_tr_b16 v[58:59], v11 offset:35328
    v_mfma_f32_32x32x16_bf16 v[112:127], v[208:211], v[48:51], v[112:127]
    s_add_u32 m0, s13, 24576
    s_add_u32 s34, s34, s11
    s_mov_b64 exec, s[74:75]
    buffer_load_dwordx4 v5, s[44:47], s34 offen lds
    s_mov_b64 exec, -1
    ds_read_b64_tr_b16 v[60:61], v12 offset:17408
    ds_read_b64_tr_b16 v[62:63], v12 offset:17664
    ds_read_b64_tr_b16 v[72:73], v13 offset:32768
    ds_read_b64_tr_b16 v[74:75], v13 offset:33280
    s_waitcnt lgkmcnt(2)
    v_mfma_f32_32x32x16_bf16 v[80:95], v[52:55], v[212:215], v[80:95]
    ds_read_b64_tr_b16 v[40:41], v10 offset:36864
    ds_read_b64_tr_b16 v[42:43], v10 offset:37376
    v_mfma_f32_32x32x16_bf16 v[96:111], v[56:59], v[212:215], v[96:111]
    s_lshl_b32 s32, s96, 7
    s_add_u32 m0, s17, 0
    s_nop 0
    s_add_u32 s32, s32, s16
    buffer_load_dwordx4 v2, s[52:55], s32 offen lds
    s_add_u32 m0, s17, 1024
    s_add_u32 s32, s32, 7168
    buffer_load_dwordx4 v3, s[52:55], s32 offen lds
    s_add_u32 m0, s17, 2048
    s_add_u32 s32, s32, 7168
    buffer_load_dwordx4 v2, s[52:55], s32 offen lds
    s_add_u32 m0, s17, 3072
    s_add_u32 s32, s32, 7168
    buffer_load_dwordx4 v3, s[52:55], s32 offen lds
    ds_read_b64_tr_b16 v[44:45], v11 offset:36864
    ds_read_b64_tr_b16 v[46:47], v11 offset:37376
    s_waitcnt lgkmcnt(4)
    v_mfma_f32_16x16x32_bf16 v[64:67], v[24:27], v[72:75], v[64:67]
    v_mfma_f32_32x32x16_bf16 v[112:127], v[212:215], v[60:63], v[112:127]
    ds_read_b64_tr_b16 v[48:49], v12 offset:18432
    ds_read_b64_tr_b16 v[50:51], v12 offset:18688
    s_waitcnt lgkmcnt(0)
    v_mfma_f32_32x32x16_bf16 v[80:95], v[40:43], v[216:219], v[80:95]
    ds_read_b64_tr_b16 v[52:53], v10 offset:38912
    ds_read_b64_tr_b16 v[54:55], v10 offset:39424
    v_mfma_f32_32x32x16_bf16 v[96:111], v[44:47], v[216:219], v[96:111]
    v_mov_b32 v5, 156672
    ds_read_b64_tr_b16 v[56:57], v11 offset:38912
    ds_read_b64_tr_b16 v[58:59], v11 offset:39424
    v_mfma_f32_32x32x16_bf16 v[112:127], v[216:219], v[48:51], v[112:127]
    s_mul_i32 s34, s90, 229376
    s_add_u32 m0, s12, 0
    s_add_u32 s34, s34, s10
    buffer_load_dwordx4 v4, s[40:43], s34 offen lds
    ds_read_b64_tr_b16 v[60:61], v12 offset:19456
    ds_read_b64_tr_b16 v[62:63], v12 offset:19712
    s_waitcnt vmcnt(11)
    s_barrier
    s_waitcnt lgkmcnt(0)
    v_mfma_f32_32x32x16_bf16 v[80:95], v[52:55], v[220:223], v[80:95]
    s_waitcnt vmcnt(7)
    ds_read_b128 v[224:227], v6 offset:32768
    ds_read_b128 v[228:231], v7 offset:32768
    v_mfma_f32_32x32x16_bf16 v[96:111], v[56:59], v[220:223], v[96:111]
    s_mul_i32 s34, s91, 229376
    s_add_u32 m0, s12, 8192
    s_nop 0
    s_add_u32 s34, s34, s10
    buffer_load_dwordx4 v4, s[40:43], s34 offen lds
    ds_read_b128 v[232:235], v8 offset:32768
    ds_read_b128 v[236:239], v9 offset:32768
    ds_read_b64_tr_b16 v[40:41], v10 offset:40960
    ds_read_b64_tr_b16 v[42:43], v10 offset:41472
    v_mfma_f32_32x32x16_bf16 v[112:127], v[220:223], v[60:63], v[112:127]
    v_and_b32_e64 v22, 31, v0
    v_lshlrev_b32 v22, 4, v22
    s_lshl_b32 s99, s8, 9
    s_add_u32 s99, s99, 18874368
    buffer_load_dwordx4 v[18:21], v22, s[48:51], s99 offen sc1
    ds_read_b64_tr_b16 v[44:45], v11 offset:40960
    ds_read_b64_tr_b16 v[46:47], v11 offset:41472
    ds_read_b64_tr_b16 v[48:49], v12 offset:20480
    ds_read_b64_tr_b16 v[50:51], v12 offset:20736
    s_waitcnt lgkmcnt(0)
    v_mfma_f32_32x32x16_bf16 v[80:95], v[40:43], v[224:227], v[80:95]
    s_mul_i32 s34, s92, 229376
    s_add_u32 m0, s12, 16384
    s_add_u32 s34, s34, s10
    buffer_load_dwordx4 v4, s[40:43], s34 offen lds
    ds_read_b64_tr_b16 v[52:53], v10 offset:43008
    ds_read_b64_tr_b16 v[54:55], v10 offset:43520
    v_mfma_f32_32x32x16_bf16 v[96:111], v[44:47], v[224:227], v[96:111]
    ds_read_b64_tr_b16 v[56:57], v11 offset:43008
    ds_read_b64_tr_b16 v[58:59], v11 offset:43520
    v_mfma_f32_32x32x16_bf16 v[112:127], v[224:227], v[48:51], v[112:127]
    s_mul_i32 s34, s93, 229376
    s_add_u32 m0, s12, 24576
    s_add_u32 s34, s34, s10
    buffer_load_dwordx4 v4, s[40:43], s34 offen lds
    ds_read_b64_tr_b16 v[60:61], v12 offset:21504
    ds_read_b64_tr_b16 v[62:63], v12 offset:21760
    ds_read_b64_tr_b16 v[72:73], v13 offset:40960
    ds_read_b64_tr_b16 v[74:75], v13 offset:41472
    ds_read_b64_tr_b16 v[76:77], v14 offset:16384
    ds_read_b64_tr_b16 v[78:79], v14 offset:16640
    s_waitcnt lgkmcnt(4)
    v_mfma_f32_32x32x16_bf16 v[80:95], v[52:55], v[228:231], v[80:95]
    ds_read_b64_tr_b16 v[40:41], v10 offset:45056
    ds_read_b64_tr_b16 v[42:43], v10 offset:45568
    v_mfma_f32_32x32x16_bf16 v[96:111], v[56:59], v[228:231], v[96:111]
    s_mul_i32 s34, s94, 229376
    s_add_u32 m0, s12, 57344
    s_add_u32 s34, s34, s10
    buffer_load_dwordx4 v4, s[40:43], s34 offen lds
    ds_read_b64_tr_b16 v[44:45], v11 offset:45056
    ds_read_b64_tr_b16 v[46:47], v11 offset:45568
    s_waitcnt lgkmcnt(6)
    v_mfma_f32_16x16x32_bf16 v[64:67], v[24:27], v[72:75], v[64:67]
    v_mfma_f32_32x32x16_bf16 v[112:127], v[228:231], v[60:63], v[112:127]
    ds_read_b64_tr_b16 v[48:49], v12 offset:22528
    ds_read_b64_tr_b16 v[50:51], v12 offset:22784
    s_waitcnt lgkmcnt(6)
    v_mfma_f32_16x16x32_bf16 v[68:71], v[24:27], v[76:79], v[68:71]
    s_waitcnt lgkmcnt(0)
    v_mfma_f32_32x32x16_bf16 v[80:95], v[40:43], v[232:235], v[80:95]
    s_mul_i32 s34, s95, 229376
    s_add_u32 m0, s12, 65536
    s_nop 0
    s_add_u32 s34, s34, s10
    buffer_load_dwordx4 v4, s[40:43], s34 offen lds
    ds_read_b64_tr_b16 v[52:53], v10 offset:47104
    ds_read_b64_tr_b16 v[54:55], v10 offset:47616
    v_mfma_f32_32x32x16_bf16 v[96:111], v[44:47], v[232:235], v[96:111]
    ds_read_b64_tr_b16 v[56:57], v11 offset:47104
    ds_read_b64_tr_b16 v[58:59], v11 offset:47616
    v_mfma_f32_32x32x16_bf16 v[112:127], v[232:235], v[48:51], v[112:127]
    s_mul_i32 s34, s96, 229376
    s_add_u32 m0, s12, 32768
    s_nop 0
    s_add_u32 s34, s34, s10
    buffer_load_dwordx4 v4, s[40:43], s34 offen lds
    ds_read_b64_tr_b16 v[60:61], v12 offset:23552
    ds_read_b64_tr_b16 v[62:63], v12 offset:23808
    s_waitcnt vmcnt(12)
    s_barrier
    s_waitcnt lgkmcnt(0)
    v_mfma_f32_32x32x16_bf16 v[80:95], v[52:55], v[236:239], v[80:95]
    s_waitcnt vmcnt(8)
    ds_read_b128 v[240:243], v6 offset:0
    ds_read_b128 v[244:247], v7 offset:0
    v_mfma_f32_32x32x16_bf16 v[96:111], v[56:59], v[236:239], v[96:111]
    ds_read_b128 v[248:251], v8 offset:0
    ds_read_b128 v[252:255], v9 offset:0
    ds_read_b64_tr_b16 v[40:41], v10 offset:49152
    ds_read_b64_tr_b16 v[42:43], v10 offset:49664
    v_mfma_f32_32x32x16_bf16 v[112:127], v[236:239], v[60:63], v[112:127]
    ds_read_b64_tr_b16 v[44:45], v11 offset:49152
    ds_read_b64_tr_b16 v[46:47], v11 offset:49664
    ds_read_b64_tr_b16 v[48:49], v12 offset:24576
    ds_read_b64_tr_b16 v[50:51], v12 offset:24832
    s_waitcnt lgkmcnt(0)
    v_mfma_f32_32x32x16_bf16 v[80:95], v[40:43], v[240:243], v[80:95]
    s_waitcnt vmcnt(5)
    v_cmp_ne_u32 vcc, s97, v20
    s_cbranch_vccz L_ok5
    s_mov_b32 s76, 200000
L_lp5:
    s_sleep 6
    buffer_load_dwordx4 v[18:21], v22, s[48:51], s99 offen sc1
    s_waitcnt vmcnt(0)
    v_cmp_ne_u32 vcc, s97, v20
    s_cbranch_vccz L_ok5
    s_sub_u32 s76, s76, 1
    s_cbranch_scc0 L_lp5
L_ok5:
    v_rsq_f32_e64 v22, v19
    ds_read_b64_tr_b16 v[52:53], v10 offset:51200
    ds_read_b64_tr_b16 v[54:55], v10 offset:51712
    v_mfma_f32_32x32x16_bf16 v[96:111], v[44:47], v[240:243], v[96:111]
    v_cvt_pk_bf16_f32 v28, -v18, -v18
    v_and_b32 v23, 0xffff0000, v28
    v_sub_f32 v23, -v18, v23
    ds_read_b64_tr_b16 v[56:57], v11 offset:51200
    ds_read_b64_tr_b16 v[58:59], v11 offset:51712
    v_mfma_f32_32x32x16_bf16 v[112:127], v[240:243], v[48:51], v[112:127]
    v_cvt_pk_bf16_f32 v29, v23, v23
    v_cndmask_b32 v28, v28, 0, s[72:73]
    v_cndmask_b32 v29, v29, 0, s[72:73]
    ds_read_b64_tr_b16 v[60:61], v12 offset:25600
    ds_read_b64_tr_b16 v[62:63], v12 offset:25856
    ds_read_b64_tr_b16 v[72:73], v13 offset:49152
    ds_read_b64_tr_b16 v[74:75], v13 offset:49664
    ds_read_b64_tr_b16 v[76:77], v14 offset:24576
    ds_read_b64_tr_b16 v[78:79], v14 offset:24832
    s_waitcnt lgkmcnt(4)
    v_mfma_f32_32x32x16_bf16 v[80:95], v[52:55], v[244:247], v[80:95]
    v_mov_b32 v18, v22
    v_mul_f32 v20, 0xc0135761, v22
    v_mul_f32 v21, 0xbdd2d3e8, v22
    v_mul_f32_e64 v23, v22, v22
    ds_read_b64_tr_b16 v[40:41], v10 offset:53248
    ds_read_b64_tr_b16 v[42:43], v10 offset:53760
    v_mfma_f32_32x32x16_bf16 v[96:111], v[56:59], v[244:247], v[96:111]
    s_lshl_b32 s78, s2, 3
    s_add_u32 s78, s78, s5
    v_min_u32 v7, 6, v0
    v_lshlrev_b32 v7, 7, v7
    s_mul_i32 s79, s78, 784
    buffer_load_dword v6, v7, s[56:59], s79 offen
    s_mul_i32 s79, s78, 196
    v_min_u32 v7, 128, v7
    buffer_load_dword v6, v7, s[60:63], s79 offen
    v_mul_f32 v21, v21, v23
    v_and_b32 v22, 31, v0
    v_lshlrev_b32_e64 v22, 2, v22
    ds_read_b64_tr_b16 v[44:45], v11 offset:53248
    ds_read_b64_tr_b16 v[46:47], v11 offset:53760
    s_waitcnt lgkmcnt(6)
    v_mfma_f32_16x16x32_bf16 v[64:67], v[24:27], v[72:75], v[64:67]
    v_mfma_f32_32x32x16_bf16 v[112:127], v[244:247], v[60:63], v[112:127]
    s_lshl_b32 s76, s5, 7
    s_add_u32 s76, s76, 155648
    v_add_u32_e64 v22, s76, v22
    ds_read_b64_tr_b16 v[48:49], v12 offset:26624
    ds_read_b64_tr_b16 v[50:51], v12 offset:26880
    s_waitcnt lgkmcnt(6)
    s_cmp_lg_u32 s15, 0
    s_cbranch_scc1 L_sk6
    v_mfma_f32_16x16x32_bf16 v[68:71], v[24:27], v[76:79], v[68:71]
L_sk6:
    s_waitcnt lgkmcnt(0)
    v_mfma_f32_32x32x16_bf16 v[80:95], v[40:43], v[248:251], v[80:95]
    ds_write_b32 v22, v18
    v_lshrrev_b32 v8, 5, v0
    v_lshlrev_b32 v8, 4, v8
    ds_read_b64_tr_b16 v[52:53], v10 offset:55296
    ds_read_b64_tr_b16 v[54:55], v10 offset:55808
    v_mfma_f32_32x32x16_bf16 v[96:111], v[44:47], v[248:251], v[96:111]
    v_add_u32_e64 v8, s76, v8
    s_mov_b32 s74, 0xf0000000
    s_mov_b32 s75, 0xf0000000
    v_mov_b32_e64 v9, 1
    ds_read_b64_tr_b16 v[56:57], v11 offset:55296
    ds_read_b64_tr_b16 v[58:59], v11 offset:55808
    v_mfma_f32_32x32x16_bf16 v[112:127], v[248:251], v[48:51], v[112:127]
    ds_read_b64_tr_b16 v[60:61], v12 offset:27648
    ds_read_b64_tr_b16 v[62:63], v12 offset:27904
    ds_write_b32 v15, v64
    ds_write_b32 v15, v68 offset:1024
    s_waitcnt lgkmcnt(2)
    v_mfma_f32_32x32x16_bf16 v[112:127], v[252:255], v[60:63], v[112:127]
    v_add_u32 v12, 57344, v10
    v_add_u32 v14, 57344, v11
    v_add_u32 v7, 57344, v13
    s_waitcnt vmcnt(2) lgkmcnt(0)
    s_barrier
    s_setprio 2
    s_cmp_lg_u32 s15, 0
    s_cbranch_scc1 L_p1g_A1
    ds_read_b128 v[72:75], v16 offset:1024
    ds_read_b128 v[76:79], v16 offset:1536
    ds_read_b64_tr_b16 v[40:41], v11 offset:0
    ds_read_b64_tr_b16 v[42:43], v11 offset:512
    ds_read_b64_tr_b16 v[44:45], v11 offset:2048
    ds_read_b64_tr_b16 v[46:47], v11 offset:2560
    ds_read_b64_tr_b16 v[48:49], v11 offset:4096
    ds_read_b64_tr_b16 v[50:51], v11 offset:4608
    v_mfma_f32_32x32x16_bf16 v[80:95], v[52:55], v[252:255], v[80:95]
    v_mfma_f32_32x32x16_bf16 v[96:111], v[56:59], v[252:255], v[96:111]
    ds_read_b64_tr_b16 v[52:53], v11 offset:6144
    ds_read_b64_tr_b16 v[54:55], v11 offset:6656
    s_waitcnt lgkmcnt(6)
    v_mfma_f32_32x32x16_bf16 v[128:143], v[40:43], v[144:147], 0
    v_add_f32 v72, v72, v76
    v_add_f32 v73, v73, v77
    v_add_f32 v74, v74, v78
    v_add_f32 v75, v75, v79
    v_add_f32 v72, v72, v73
    ds_read_b64_tr_b16 v[56:57], v11 offset:8192
    ds_read_b64_tr_b16 v[58:59], v11 offset:8704
    ds_read_b64_tr_b16 v[60:61], v13 offset:0
    ds_read_b64_tr_b16 v[62:63], v13 offset:512
    s_waitcnt lgkmcnt(8)
    v_mfma_f32_32x32x16_bf16 v[128:143], v[44:47], v[148:151], v[128:143]
    v_add_f32 v74, v74, v75
    v_add_f32_e64 v72, v72, v74
    v_cvt_pk_bf16_f32 v73, v72, v72
    v_and_b32 v73, 0xffff0000, v73
    v_sub_f32 v73, v72, v73
    v_cvt_pk_bf16_f32 v32, v72, v73
    v_cvt_pk_bf16_f32 v33, v72, v73
    ds_read_b64_tr_b16 v[40:41], v11 offset:10240
    ds_read_b64_tr_b16 v[42:43], v11 offset:10752
    s_waitcnt lgkmcnt(8)
    v_mfma_f32_32x32x16_bf16 v[128:143], v[48:51], v[152:155], v[128:143]
    ds_read_b128 v[72:75], v16 offset:0
    ds_read_b128 v[76:79], v16 offset:512
    v_mfma_f32_32x32x16_bf16 v[112:127], v[28:31], v[32:35], v[112:127]
    s_waitcnt lgkmcnt(1)
    v_add_f32 v72, v72, v73
    v_add_f32_e64 v74, v74, v75
    v_mfma_f32_16x16x32_bf16 v[64:67], v[24:27], v[60:63], 0
    ds_read_b64_tr_b16 v[44:45], v11 offset:12288
    ds_read_b64_tr_b16 v[46:47], v11 offset:12800
    ds_read_b64_tr_b16 v[60:61], v13 offset:8192
    ds_read_b64_tr_b16 v[62:63], v13 offset:8704
    v_mfma_f32_32x32x16_bf16 v[128:143], v[52:55], v[156:159], v[128:143]
    v_add_f32_e64 v72, v72, v74
    v_cvt_pk_bf16_f32 v73, v72, v72
    v_and_b32 v73, 0xffff0000, v73
    v_sub_f32 v73, v72, v73
    v_cvt_pk_bf16_f32 v36, v72, v73
    v_cvt_pk_bf16_f32 v37, v72, v73
    s_nop 1
    v_mfma_f32_32x32x16_bf16 v[80:95], v[36:39], v[28:31], v[80:95]
    ds_read_b64_tr_b16 v[48:49], v11 offset:14336
    ds_read_b64_tr_b16 v[50:51], v11 offset:14848
    v_mfma_f32_32x32x16_bf16 v[128:143], v[56:59], v[160:163], v[128:143]
    s_waitcnt lgkmcnt(6)
    v_add_f32 v76, v76, v77
    v_add_f32_e64 v78, v78, v79
    v_add_f32 v76, v76, v78
    v_cvt_pk_bf16_f32 v77, v76, v76
    v_and_b32 v77, 0xffff0000, v77
    s_waitcnt lgkmcnt(2)
    v_mfma_f32_16x16x32_bf16 v[64:67], v[24:27], v[60:63], v[64:67]
    ds_read_b64_tr_b16 v[52:53], v11 offset:16384
    ds_read_b64_tr_b16 v[54:55], v11 offset:16896
    ds_read_b64_tr_b16 v[60:61], v13 offset:16384
    ds_read_b64_tr_b16 v[62:63], v13 offset:16896
    v_mfma_f32_32x32x16_bf16 v[128:143], v[40:43], v[164:167], v[128:143]
    v_sub_f32 v77, v76, v77
    v_cvt_pk_bf16_f32 v32, v76, v77
    v_cvt_pk_bf16_f32 v33, v76, v77
    s_nop 1
    v_mfma_f32_32x32x16_bf16 v[96:111], v[32:35], v[28:31], v[96:111]
    ds_read_b128 v[72:75], v8 offset:0
    ds_read_b128 v[76:79], v8 offset:32
    ds_read_b64_tr_b16 v[56:57], v11 offset:18432
    ds_read_b64_tr_b16 v[58:59], v11 offset:18944
    v_mfma_f32_32x32x16_bf16 v[128:143], v[44:47], v[168:171], v[128:143]
    s_waitcnt lgkmcnt(2)
    v_mul_f32 v112, v112, v72
    v_mul_f32 v113, v113, v73
    v_mul_f32 v114, v114, v74
    v_mul_f32 v115, v115, v75
    v_mul_f32 v116, v116, v76
    v_mfma_f32_16x16x32_bf16 v[64:67], v[24:27], v[60:63], v[64:67]
    ds_read_b64_tr_b16 v[40:41], v11 offset:20480
    ds_read_b64_tr_b16 v[42:43], v11 offset:20992
    ds_read_b64_tr_b16 v[60:61], v13 offset:24576
    ds_read_b64_tr_b16 v[62:63], v13 offset:25088
    v_mfma_f32_32x32x16_bf16 v[128:143], v[48:51], v[172:175], v[128:143]
    v_mul_f32 v117, v117, v77
    v_mul_f32 v118, v118, v78
    v_mul_f32_e64 v119, v119, v79
    ds_read_b128 v[72:75], v8 offset:64
    ds_read_b128 v[76:79], v8 offset:96
    s_waitcnt lgkmcnt(0)
    v_mul_f32 v120, v120, v72
    ds_read_b64_tr_b16 v[44:45], v11 offset:22528
    ds_read_b64_tr_b16 v[46:47], v11 offset:23040
    v_mfma_f32_32x32x16_bf16 v[128:143], v[52:55], v[176:179], v[128:143]
    v_mul_f32 v121, v121, v73
    v_mul_f32 v122, v122, v74
    v_mul_f32 v123, v123, v75
    v_mul_f32 v124, v124, v76
    v_mul_f32 v125, v125, v77
    v_mul_f32 v126, v126, v78
    v_mfma_f32_16x16x32_bf16 v[64:67], v[24:27], v[60:63], v[64:67]
    ds_read_b64_tr_b16 v[48:49], v11 offset:24576
    ds_read_b64_tr_b16 v[50:51], v11 offset:25088
    ds_read_b64_tr_b16 v[60:61], v7 offset:0
    ds_read_b64_tr_b16 v[62:63], v7 offset:512
    v_mfma_f32_32x32x16_bf16 v[128:143], v[56:59], v[180:183], v[128:143]
    v_mul_f32_e64 v127, v127, v79
    v_cvt_pk_bf16_f32 v112, v112, v113
    v_cvt_pk_bf16_f32 v113, v114, v115
    v_cvt_pk_bf16_f32 v114, v116, v117
    v_cvt_pk_bf16_f32 v115, v118, v119
    v_cvt_pk_bf16_f32 v116, v120, v121
    v_cvt_pk_bf16_f32 v117, v122, v123
    ds_read_b64_tr_b16 v[52:53], v10 offset:0
    ds_read_b64_tr_b16 v[54:55], v10 offset:512
    v_mfma_f32_32x32x16_bf16 v[128:143], v[40:43], v[184:187], v[128:143]
    v_cvt_pk_bf16_f32 v118, v124, v125
    v_cvt_pk_bf16_f32 v119, v126, v127
    v_cndmask_b32 v112, v112, v17, s[74:75]
    v_cndmask_b32 v113, v113, v17, s[74:75]
    v_cndmask_b32 v114, v114, v17, s[74:75]
    v_cndmask_b32 v115, v115, v17, s[74:75]
    s_nop 0
    s_waitcnt lgkmcnt(2)
    v_mfma_f32_16x16x32_bf16 v[64:67], v[24:27], v[60:63], v[64:67]
    ds_read_b64_tr_b16 v[56:57], v10 offset:2048
    ds_read_b64_tr_b16 v[58:59], v10 offset:2560
    ds_read_b64_tr_b16 v[60:61], v7 offset:8192
    ds_read_b64_tr_b16 v[62:63], v7 offset:8704
    v_mfma_f32_32x32x16_bf16 v[128:143], v[44:47], v[188:191], v[128:143]
    v_cndmask_b32 v116, v116, v17, s[74:75]
    v_cndmask_b32 v117, v117, v17, s[74:75]
    v_cndmask_b32 v118, v118, v17, s[74:75]
    v_cndmask_b32 v119, v119, v17, s[74:75]
    buffer_store_dwordx4 v[112:115], v1, s[48:51], s20 offen sc1
    buffer_store_dwordx4 v[116:119], v1, s[48:51], s20 offen offset:1024 sc1
    s_setprio 0
    ds_read_b64_tr_b16 v[40:41], v10 offset:4096
    ds_read_b64_tr_b16 v[42:43], v10 offset:4608
    v_mfma_f32_32x32x16_bf16 v[128:143], v[48:51], v[192:195], v[128:143]
    v_mul_f32 v72, v80, v80
    v_mul_f32 v73, v81, v81
    v_mul_f32 v74, v82, v82
    v_mul_f32 v75, v83, v83
    v_fma_f32 v72, v72, v21, v20
    s_waitcnt lgkmcnt(2)
    v_mfma_f32_16x16x32_bf16 v[64:67], v[24:27], v[60:63], v[64:67]
    ds_read_b64_tr_b16 v[44:45], v10 offset:6144
    ds_read_b64_tr_b16 v[46:47], v10 offset:6656
    ds_read_b64_tr_b16 v[60:61], v13 offset:32768
    ds_read_b64_tr_b16 v[62:63], v13 offset:33280
    v_mfma_f32_32x32x16_bf16 v[112:127], v[52:55], v[144:147], 0
    v_fma_f32 v73, v73, v21, v20
    v_fma_f32 v74, v74, v21, v20
    v_fma_f32 v75, v75, v21, v20
    v_mul_f32 v72, v72, v80
    v_mul_f32 v73, v73, v81
    v_mul_f32_e64 v74, v74, v82
    ds_read_b64_tr_b16 v[48:49], v10 offset:8192
    ds_read_b64_tr_b16 v[50:51], v10 offset:8704
    v_mfma_f32_32x32x16_bf16 v[112:127], v[56:59], v[148:151], v[112:127]
    v_mul_f32 v75, v75, v83
    v_exp_f32 v72, v72
    v_exp_f32 v73, v73
    v_exp_f32 v74, v74
    v_exp_f32 v75, v75
    s_waitcnt lgkmcnt(2)
    v_mfma_f32_16x16x32_bf16 v[64:67], v[24:27], v[60:63], v[64:67]
    ds_read_b64_tr_b16 v[52:53], v10 offset:10240
    ds_read_b64_tr_b16 v[54:55], v10 offset:10752
    v_mfma_f32_32x32x16_bf16 v[112:127], v[40:43], v[152:155], v[112:127]
    v_fma_f32 v72, v72, v19, v19
    v_fma_f32 v73, v73, v19, v19
    v_fma_f32 v74, v74, v19, v19
    v_fma_f32 v75, v75, v19, v19
    v_rcp_f32 v72, v72
    v_rcp_f32 v73, v73
    ds_read_b64_tr_b16 v[56:57], v10 offset:12288
    ds_read_b64_tr_b16 v[58:59], v10 offset:12800
    v_mfma_f32_32x32x16_bf16 v[112:127], v[44:47], v[156:159], v[112:127]
    v_rcp_f32 v74, v74
    v_rcp_f32 v75, v75
    v_mul_f32 v80, v80, v72
    v_mul_f32 v81, v81, v73
    v_mul_f32 v82, v82, v74
    v_mul_f32 v83, v83, v75
    ds_read_b64_tr_b16 v[40:41], v10 offset:14336
    ds_read_b64_tr_b16 v[42:43], v10 offset:14848
    s_waitcnt lgkmcnt(6)
    v_mfma_f32_32x32x16_bf16 v[112:127], v[48:51], v[160:163], v[112:127]
    v_mul_f32 v76, v84, v84
    v_mul_f32 v77, v85, v85
    v_mul_f32 v78, v86, v86
    v_mul_f32 v79, v87, v87
    v_fma_f32 v76, v76, v21, v20
    ds_write_b32 v15, v64 offset:2048
    ds_read_b64_tr_b16 v[44:45], v10 offset:16384
    ds_read_b64_tr_b16 v[46:47], v10 offset:16896
    s_waitcnt lgkmcnt(7)
    v_mfma_f32_32x32x16_bf16 v[112:127], v[52:55], v[164:167], v[112:127]
    v_fma_f32 v77, v77, v21, v20
    v_fma_f32 v78, v78, v21, v20
    v_fma_f32 v79, v79, v21, v20
    v_mul_f32 v76, v76, v84
    v_mul_f32 v77, v77, v85
    v_mul_f32_e64 v78, v78, v86
    ds_read_b64_tr_b16 v[48:49], v10 offset:18432
    ds_read_b64_tr_b16 v[50:51], v10 offset:18944
    s_waitcnt lgkmcnt(7)
    v_mfma_f32_32x32x16_bf16 v[112:127], v[56:59], v[168:171], v[112:127]
    v_mul_f32 v79, v79, v87
    v_exp_f32 v76, v76
    v_exp_f32 v77, v77
    v_exp_f32_e64 v78, v78
    v_exp_f32 v79, v79
    s_waitcnt lgkmcnt(4)
    s_mov_b64 exec, 1
    ds_add_u32 v5, v9 offset:48
    s_mov_b64 exec, -1
    ds_read_b64_tr_b16 v[52:53], v10 offset:20480
    ds_read_b64_tr_b16 v[54:55], v10 offset:20992
    v_mfma_f32_32x32x16_bf16 v[112:127], v[40:43], v[172:175], v[112:127]
    v_fma_f32 v76, v76, v19, v19
    v_fma_f32 v77, v77, v19, v19
    v_fma_f32 v78, v78, v19, v19
    v_fma_f32 v79, v79, v19, v19
    v_rcp_f32 v76, v76
    v_rcp_f32 v77, v77
    ds_read_b64_tr_b16 v[56:57], v10 offset:22528
    ds_read_b64_tr_b16 v[58:59], v10 offset:23040
    s_waitcnt lgkmcnt(7)
    v_mfma_f32_32x32x16_bf16 v[112:127], v[44:47], v[176:179], v[112:127]
    v_rcp_f32 v78, v78
    v_rcp_f32 v79, v79
    v_mul_f32 v84, v84, v76
    v_mul_f32 v85, v85, v77
    v_mul_f32 v86, v86, v78
    v_mul_f32_e64 v87, v87, v79
    v_mov_b32 v23, s97
    s_waitcnt vmcnt(0)
    buffer_store_dword v23, off, s[48:51], s19 offset:0 sc1
    ds_read_b64_tr_b16 v[40:41], v10 offset:24576
    ds_read_b64_tr_b16 v[42:43], v10 offset:25088
    s_waitcnt lgkmcnt(7)
    v_mfma_f32_32x32x16_bf16 v[112:127], v[48:51], v[180:183], v[112:127]
    v_mul_f32 v72, v88, v88
    v_mul_f32 v73, v89, v89
    v_mul_f32 v74, v90, v90
    v_mul_f32 v75, v91, v91
    v_fma_f32 v72, v72, v21, v20
    ds_read_b64_tr_b16 v[44:45], v10 offset:26624
    ds_read_b64_tr_b16 v[46:47], v10 offset:27136
    s_waitcnt lgkmcnt(6)
    v_mfma_f32_32x32x16_bf16 v[112:127], v[52:55], v[184:187], v[112:127]
    v_fma_f32 v73, v73, v21, v20
    v_fma_f32 v74, v74, v21, v20
    v_fma_f32 v75, v75, v21, v20
    v_mul_f32 v72, v72, v88
    v_mul_f32 v73, v73, v89
    v_mul_f32_e64 v74, v74, v90
    ds_read_b64_tr_b16 v[48:49], v11 offset:26624
    ds_read_b64_tr_b16 v[50:51], v11 offset:27136
    s_waitcnt lgkmcnt(6)
    v_mfma_f32_32x32x16_bf16 v[112:127], v[56:59], v[188:191], v[112:127]
    v_mul_f32 v75, v75, v91
    v_exp_f32 v72, v72
    v_exp_f32 v73, v73
    v_exp_f32_e64 v74, v74
    v_exp_f32 v75, v75
    ds_read_b64_tr_b16 v[52:53], v10 offset:28672
    ds_read_b64_tr_b16 v[54:55], v10 offset:29184
    s_waitcnt lgkmcnt(6)
    v_mfma_f32_32x32x16_bf16 v[112:127], v[40:43], v[192:195], v[112:127]
    v_fma_f32 v72, v72, v19, v19
    v_fma_f32 v73, v73, v19, v19
    v_fma_f32 v74, v74, v19, v19
    v_fma_f32 v75, v75, v19, v19
    v_rcp_f32 v72, v72
    v_rcp_f32 v73, v73
    ds_read_b64_tr_b16 v[56:57], v11 offset:28672
    ds_read_b64_tr_b16 v[58:59], v11 offset:29184
    s_waitcnt lgkmcnt(6)
    v_mfma_f32_32x32x16_bf16 v[112:127], v[44:47], v[196:199], v[112:127]
    v_rcp_f32 v74, v74
    v_rcp_f32 v75, v75
    v_mul_f32 v88, v88, v72
    v_mul_f32 v89, v89, v73
    v_mul_f32 v90, v90, v74
    v_mul_f32_e64 v91, v91, v75
    ds_read_b64_tr_b16 v[40:41], v10 offset:30720
    ds_read_b64_tr_b16 v[42:43], v10 offset:31232
    s_waitcnt lgkmcnt(6)
    v_mfma_f32_32x32x16_bf16 v[128:143], v[48:51], v[196:199], v[128:143]
    v_mul_f32 v76, v92, v92
    v_mul_f32 v77, v93, v93
    v_mul_f32 v78, v94, v94
    v_mul_f32 v79, v95, v95
    v_fma_f32 v76, v76, v21, v20
    ds_read_b64_tr_b16 v[44:45], v11 offset:30720
    ds_read_b64_tr_b16 v[46:47], v11 offset:31232
    s_waitcnt lgkmcnt(6)
    v_mfma_f32_32x32x16_bf16 v[112:127], v[52:55], v[200:203], v[112:127]
    v_fma_f32 v77, v77, v21, v20
    v_fma_f32 v78, v78, v21, v20
    v_fma_f32 v79, v79, v21, v20
    v_mul_f32 v76, v76, v92
    v_mul_f32 v77, v77, v93
    v_mul_f32_e64 v78, v78, v94
    ds_read_b64_tr_b16 v[48:49], v12 offset:0
    ds_read_b64_tr_b16 v[50:51], v12 offset:512
    s_waitcnt lgkmcnt(6)
    v_mfma_f32_32x32x16_bf16 v[128:143], v[56:59], v[200:203], v[128:143]
    v_mul_f32 v79, v79, v95
    v_exp_f32 v76, v76
    v_exp_f32 v77, v77
    v_exp_f32_e64 v78, v78
    v_exp_f32 v79, v79
    ds_read_b64_tr_b16 v[52:53], v14 offset:0
    ds_read_b64_tr_b16 v[54:55], v14 offset:512
    s_waitcnt lgkmcnt(6)
    v_mfma_f32_32x32x16_bf16 v[112:127], v[40:43], v[204:207], v[112:127]
    v_fma_f32 v76, v76, v19, v19
    v_fma_f32 v77, v77, v19, v19
    v_fma_f32 v78, v78, v19, v19
    v_fma_f32 v79, v79, v19, v19
    v_rcp_f32 v76, v76
    v_rcp_f32 v77, v77
    s_lshl_b32 s76, s4, 3
    s_add_u32 s76, s76, s5
    v_min_u32 v23, 12, v0
    v_lshlrev_b32 v23, 7, v23
    s_mul_i32 s77, s76, 1568
    buffer_load_dword v151, v23, s[60:63], s77 offen
    ds_read_b64_tr_b16 v[56:57], v12 offset:2048
    ds_read_b64_tr_b16 v[58:59], v12 offset:2560
    s_waitcnt lgkmcnt(6)
    v_mfma_f32_32x32x16_bf16 v[128:143], v[44:47], v[204:207], v[128:143]
    v_rcp_f32 v78, v78
    v_rcp_f32 v79, v79
    v_mul_f32 v92, v92, v76
    v_mul_f32 v93, v93, v77
    v_mul_f32 v94, v94, v78
    v_mul_f32_e64 v95, v95, v79
    ds_read_b64_tr_b16 v[40:41], v14 offset:2048
    ds_read_b64_tr_b16 v[42:43], v14 offset:2560
    s_waitcnt lgkmcnt(6)
    v_mfma_f32_32x32x16_bf16 v[112:127], v[48:51], v[208:211], v[112:127]
    v_mul_f32 v72, v96, v96
    v_mul_f32 v73, v97, v97
    v_mul_f32 v74, v98, v98
    v_mul_f32 v75, v99, v99
    v_fma_f32 v72, v72, v21, v20
    ds_read_b64_tr_b16 v[44:45], v12 offset:4096
    ds_read_b64_tr_b16 v[46:47], v12 offset:4608
    s_waitcnt lgkmcnt(6)
    v_mfma_f32_32x32x16_bf16 v[128:143], v[52:55], v[208:211], v[128:143]
    v_fma_f32 v73, v73, v21, v20
    v_fma_f32 v74, v74, v21, v20
    v_fma_f32 v75, v75, v21, v20
    v_mul_f32 v72, v72, v96
    v_mul_f32 v73, v73, v97
    v_mul_f32_e64 v74, v74, v98
    ds_read_b64_tr_b16 v[48:49], v14 offset:4096
    ds_read_b64_tr_b16 v[50:51], v14 offset:4608
    s_waitcnt lgkmcnt(6)
    v_mfma_f32_32x32x16_bf16 v[112:127], v[56:59], v[212:215], v[112:127]
    v_mul_f32 v75, v75, v99
    v_exp_f32 v72, v72
    v_exp_f32 v73, v73
    v_exp_f32_e64 v74, v74
    v_exp_f32 v75, v75
    ds_read_b64_tr_b16 v[52:53], v12 offset:6144
    ds_read_b64_tr_b16 v[54:55], v12 offset:6656
    s_waitcnt lgkmcnt(6)
    v_mfma_f32_32x32x16_bf16 v[128:143], v[40:43], v[212:215], v[128:143]
    v_fma_f32 v72, v72, v19, v19
    v_fma_f32 v73, v73, v19, v19
    v_fma_f32 v74, v74, v19, v19
    v_fma_f32 v75, v75, v19, v19
    v_rcp_f32 v72, v72
    v_rcp_f32 v73, v73
    ds_read_b64_tr_b16 v[56:57], v14 offset:6144
    ds_read_b64_tr_b16 v[58:59], v14 offset:6656
    s_waitcnt lgkmcnt(6)
    v_mfma_f32_32x32x16_bf16 v[112:127], v[44:47], v[216:219], v[112:127]
    v_rcp_f32 v74, v74
    v_rcp_f32 v75, v75
    v_mul_f32 v96, v96, v72
    v_mul_f32 v97, v97, v73
    v_mul_f32 v98, v98, v74
    v_mul_f32_e64 v99, v99, v75
    ds_read_b64_tr_b16 v[40:41], v12 offset:8192
    ds_read_b64_tr_b16 v[42:43], v12 offset:8704
    s_waitcnt lgkmcnt(6)
    v_mfma_f32_32x32x16_bf16 v[128:143], v[48:51], v[216:219], v[128:143]
    v_mul_f32 v76, v100, v100
    v_mul_f32 v77, v101, v101
    v_mul_f32 v78, v102, v102
    v_mul_f32 v79, v103, v103
    v_fma_f32 v76, v76, v21, v20
    ds_read_b64_tr_b16 v[44:45], v14 offset:8192
    ds_read_b64_tr_b16 v[46:47], v14 offset:8704
    s_waitcnt lgkmcnt(6)
    v_mfma_f32_32x32x16_bf16 v[112:127], v[52:55], v[220:223], v[112:127]
    v_fma_f32 v77, v77, v21, v20
    v_fma_f32 v78, v78, v21, v20
    v_fma_f32 v79, v79, v21, v20
    v_mul_f32 v76, v76, v100
    v_mul_f32 v77, v77, v101
    v_mul_f32_e64 v78, v78, v102
    ds_read_b64_tr_b16 v[48:49], v12 offset:10240
    ds_read_b64_tr_b16 v[50:51], v12 offset:10752
    s_waitcnt lgkmcnt(6)
    v_mfma_f32_32x32x16_bf16 v[128:143], v[56:59], v[220:223], v[128:143]
    v_mul_f32 v79, v79, v103
    v_exp_f32 v76, v76
    v_exp_f32 v77, v77
    v_exp_f32_e64 v78, v78
    v_exp_f32 v79, v79
    ds_read_b64_tr_b16 v[52:53], v14 offset:10240
    ds_read_b64_tr_b16 v[54:55], v14 offset:10752
    s_waitcnt lgkmcnt(6)
    v_mfma_f32_32x32x16_bf16 v[112:127], v[40:43], v[224:227], v[112:127]
    v_fma_f32 v76, v76, v19, v19
    v_fma_f32 v77, v77, v19, v19
    v_fma_f32 v78, v78, v19, v19
    v_fma_f32 v79, v79, v19, v19
    v_rcp_f32 v76, v76
    v_rcp_f32 v77, v77
    ds_read_b64_tr_b16 v[56:57], v12 offset:12288
    ds_read_b64_tr_b16 v[58:59], v12 offset:12800
    s_waitcnt lgkmcnt(6)
    v_mfma_f32_32x32x16_bf16 v[128:143], v[44:47], v[224:227], v[128:143]
    v_rcp_f32 v78, v78
    v_rcp_f32 v79, v79
    v_mul_f32 v100, v100, v76
    v_mul_f32 v101, v101, v77
    v_mul_f32 v102, v102, v78
    v_mul_f32 v103, v103, v79
    ds_read_b64_tr_b16 v[40:41], v14 offset:12288
    ds_read_b64_tr_b16 v[42:43], v14 offset:12800
    s_waitcnt lgkmcnt(6)
    v_mfma_f32_32x32x16_bf16 v[112:127], v[48:51], v[228:231], v[112:127]
    s_mov_b32 s76, 200000
L_ll7:
    ds_read_b32 v23, v5 offset:48
    s_waitcnt lgkmcnt(0)
    v_readfirstlane_b32 s77, v23
    s_nop 0
    s_cmp_eq_u32 s77, 8
    s_cbranch_scc1 L_lk7
    s_sleep 1
    s_sub_u32 s76, s76, 1
    s_cbranch_scc0 L_ll7
L_lk7:
    ds_read_b128 v[216:219], v16 offset:2048
    ds_read_b128 v[220:223], v16 offset:2560
    ds_read_b64_tr_b16 v[44:45], v12 offset:14336
    ds_read_b64_tr_b16 v[46:47], v12 offset:14848
    v_mfma_f32_32x32x16_bf16 v[128:143], v[52:55], v[228:231], v[128:143]
    v_mul_f32 v72, v104, v104
    v_mul_f32 v73, v105, v105
    v_mul_f32 v74, v106, v106
    v_mul_f32 v75, v107, v107
    v_fma_f32 v72, v72, v21, v20
    v_fma_f32 v73, v73, v21, v20
    ds_read_b64_tr_b16 v[48:49], v14 offset:14336
    ds_read_b64_tr_b16 v[50:51], v14 offset:14848
    v_mfma_f32_32x32x16_bf16 v[112:127], v[56:59], v[232:235], v[112:127]
    v_fma_f32 v74, v74, v21, v20
    v_fma_f32 v75, v75, v21, v20
    v_mul_f32 v72, v72, v104
    v_mul_f32 v73, v73, v105
    v_mul_f32 v74, v74, v106
    v_mul_f32 v75, v75, v107
    v_exp_f32 v72, v72
    s_lshr_b32 s16, s4, 4
    s_lshl_b32 s34, s3, 1
    s_add_u32 s16, s16, s34
    s_and_b32 s17, s4, 15
    s_lshl_b32 s21, s17, 2
    ds_read_b64_tr_b16 v[52:53], v10 offset:32768
    ds_read_b64_tr_b16 v[54:55], v10 offset:33280
    v_mfma_f32_32x32x16_bf16 v[128:143], v[40:43], v[232:235], v[128:143]
    v_exp_f32 v73, v73
    s_waitcnt lgkmcnt(7)
    v_add_f32 v216, v216, v217
    v_add_f32 v218, v218, v219
    v_add_f32_e64 v216, v216, v218
    v_cvt_pk_bf16_f32 v217, v216, v216
    v_and_b32 v217, 0xffff0000, v217
    s_mul_i32 s20, s14, 3
    s_add_u32 s20, s20, s21
    s_add_u32 s22, s21, s14
    v_and_b32 v152, 7, v0
    v_cmp_lt_u32 vcc, 2, v152
    ds_read_b64_tr_b16 v[56:57], v11 offset:32768
    ds_read_b64_tr_b16 v[58:59], v11 offset:33280
    s_waitcnt lgkmcnt(6)
    v_mfma_f32_32x32x16_bf16 v[112:127], v[44:47], v[236:239], v[112:127]
    v_sub_f32_e64 v217, v216, v217
    v_cvt_pk_bf16_f32 v32, v216, v217
    v_cvt_pk_bf16_f32 v33, v216, v217
    v_add_f32 v220, v220, v221
    v_add_f32 v222, v222, v223
    v_add_f32 v220, v220, v222
    v_subrev_u32 v153, 3, v152
    v_mov_b32 v154, 1024
    v_cndmask_b32_e64 v153, v152, v153, vcc
    v_mov_b32 v155, 2048
    v_cndmask_b32 v154, v154, v155, vcc
    ds_read_b64_tr_b16 v[40:41], v10 offset:34816
    ds_read_b64_tr_b16 v[42:43], v10 offset:35328
    s_waitcnt lgkmcnt(6)
    v_mfma_f32_32x32x16_bf16 v[128:143], v[48:51], v[236:239], v[128:143]
    v_cvt_pk_bf16_f32 v221, v220, v220
    v_and_b32 v221, 0xffff0000, v221
    v_sub_f32_e64 v221, v220, v221
    v_cvt_pk_bf16_f32 v36, v220, v221
    v_cvt_pk_bf16_f32 v37, v220, v221
    v_mfma_f32_32x32x16_bf16 v[112:127], v[32:35], v[28:31], v[112:127]
    s_nop 0
    v_mfma_f32_32x32x16_bf16 v[128:143], v[36:39], v[28:31], v[128:143]
    v_add_u32 v153, s20, v153
    v_subrev_u32 v153, 8, v153
    v_max_i32 v153, 0, v153
    v_add_u32 v153, v153, v154
    v_cmp_lt_u32 vcc, 5, v152
    ds_read_b64_tr_b16 v[44:45], v11 offset:34816
    ds_read_b64_tr_b16 v[46:47], v11 offset:35328
    s_waitcnt lgkmcnt(6)
    v_mfma_f32_32x32x16_bf16 v[112:127], v[52:55], v[240:243], v[112:127]
    v_exp_f32 v74, v74
    v_exp_f32_e64 v75, v75
    v_fma_f32 v72, v72, v19, v19
    v_fma_f32 v73, v73, v19, v19
    v_fma_f32 v74, v74, v19, v19
    v_fma_f32 v75, v75, v19, v19
    v_rcp_f32 v72, v72
    v_mov_b32 v154, s22
    s_lshl_b32 s23, s16, 8
    v_cndmask_b32 v153, v153, v154, vcc
    v_lshlrev_b32_e64 v3, 2, v153
    s_add_u32 s23, s23, 18939904
    ds_read_b64_tr_b16 v[48:49], v10 offset:36864
    ds_read_b64_tr_b16 v[50:51], v10 offset:37376
    s_waitcnt lgkmcnt(6)
    v_mfma_f32_32x32x16_bf16 v[128:143], v[56:59], v[240:243], v[128:143]
    v_rcp_f32 v73, v73
    v_rcp_f32 v74, v74
    v_rcp_f32 v75, v75
    v_mul_f32 v104, v104, v72
    v_mul_f32 v105, v105, v73
    v_mul_f32 v106, v106, v74
    v_mul_f32 v107, v107, v75
    s_mul_i32 s21, s14, 12288
    s_add_u32 s21, s21, 86016
    s_lshl_b32 s24, s16, 17
    s_mov_b32 s25, 0
    buffer_load_dword v6, v3, s[48:51], s23 offen sc1
    ds_read_b64_tr_b16 v[52:53], v11 offset:36864
    ds_read_b64_tr_b16 v[54:55], v11 offset:37376
    s_waitcnt lgkmcnt(6)
    v_mfma_f32_32x32x16_bf16 v[112:127], v[40:43], v[244:247], v[112:127]
    v_mul_f32 v76, v108, v108
    v_mul_f32 v77, v109, v109
    v_mul_f32 v78, v110, v110
    v_mul_f32_e64 v79, v111, v111
    v_fma_f32 v76, v76, v21, v20
    v_fma_f32 v77, v77, v21, v20
    v_fma_f32 v78, v78, v21, v20
    ds_read_b64_tr_b16 v[56:57], v10 offset:38912
    ds_read_b64_tr_b16 v[58:59], v10 offset:39424
    s_waitcnt lgkmcnt(6)
    v_mfma_f32_32x32x16_bf16 v[128:143], v[44:47], v[244:247], v[128:143]
    v_fma_f32 v79, v79, v21, v20
    v_mul_f32 v76, v76, v108
    v_mul_f32 v77, v77, v109
    v_mul_f32 v78, v78, v110
    v_mul_f32 v79, v79, v111
    v_exp_f32 v76, v76
    v_exp_f32_e64 v77, v77
    ds_read_b64_tr_b16 v[40:41], v11 offset:38912
    ds_read_b64_tr_b16 v[42:43], v11 offset:39424
    s_waitcnt lgkmcnt(6)
    v_mfma_f32_32x32x16_bf16 v[112:127], v[48:51], v[248:251], v[112:127]
    v_exp_f32 v78, v78
    v_exp_f32_e64 v79, v79
    v_fma_f32 v76, v76, v19, v19
    v_fma_f32 v77, v77, v19, v19
    v_fma_f32 v78, v78, v19, v19
    v_fma_f32 v79, v79, v19, v19
    v_rcp_f32 v76, v76
    s_waitcnt lgkmcnt(4)
    v_mfma_f32_32x32x16_bf16 v[128:143], v[52:55], v[248:251], v[128:143]
    s_waitcnt lgkmcnt(0)
    s_mov_b64 exec, 1
    ds_add_u32 v5, v9 offset:80
    s_mov_b64 exec, -1
    v_rcp_f32 v77, v77
    v_rcp_f32 v78, v78
    v_rcp_f32 v79, v79
    v_mul_f32 v108, v108, v76
    v_mul_f32 v109, v109, v77
    v_mul_f32 v110, v110, v78
    v_mul_f32 v111, v111, v79
    v_mfma_f32_32x32x16_bf16 v[112:127], v[56:59], v[252:255], v[112:127]
    v_mfma_f32_32x32x16_bf16 v[128:143], v[40:43], v[252:255], v[128:143]
    s_lshl_b32 s99, s8, 7
    s_lshl_b32 s34, s7, 2
    s_add_u32 s99, s99, s34
    s_add_u32 s99, s99, 18956288
    s_nop 6
    v_mul_f32 v80, v80, v112
    v_mul_f32 v81, v81, v113
    v_mul_f32 v82, v82, v114
    v_mul_f32 v83, v83, v115
    v_mul_f32 v84, v84, v116
    v_mul_f32 v85, v85, v117
    v_mul_f32 v86, v86, v118
    v_mul_f32 v87, v87, v119
    v_cvt_pk_bf16_f32 v80, v80, v81
    v_cvt_pk_bf16_f32 v81, v82, v83
    v_cvt_pk_bf16_f32 v82, v84, v85
    v_cvt_pk_bf16_f32 v83, v86, v87
    buffer_store_dwordx4 v[80:83], v1, s[48:51], s18 offen offset:0 sc1
    v_mul_f32 v88, v88, v120
    v_mul_f32 v89, v89, v121
    v_mul_f32 v90, v90, v122
    v_mul_f32 v91, v91, v123
    v_mul_f32 v92, v92, v124
    v_mul_f32 v93, v93, v125
    v_mul_f32 v94, v94, v126
    v_mul_f32 v95, v95, v127
    v_cvt_pk_bf16_f32 v88, v88, v89
    v_cvt_pk_bf16_f32 v89, v90, v91
    v_cvt_pk_bf16_f32 v90, v92, v93
    v_cvt_pk_bf16_f32 v91, v94, v95
    buffer_store_dwordx4 v[88:91], v1, s[48:51], s18 offen offset:1024 sc1
    v_mul_f32 v96, v96, v128
    v_mul_f32 v97, v97, v129
    v_mul_f32 v98, v98, v130
    v_mul_f32 v99, v99, v131
    v_mul_f32 v100, v100, v132
    v_mul_f32 v101, v101, v133
    v_mul_f32 v102, v102, v134
    v_mul_f32 v103, v103, v135
    v_cvt_pk_bf16_f32 v96, v96, v97
    v_cvt_pk_bf16_f32 v97, v98, v99
    v_cvt_pk_bf16_f32 v98, v100, v101
    v_cvt_pk_bf16_f32 v99, v102, v103
    buffer_store_dwordx4 v[96:99], v1, s[48:51], s18 offen offset:2048 sc1
    v_mul_f32 v104, v104, v136
    v_mul_f32 v105, v105, v137
    v_mul_f32 v106, v106, v138
    v_mul_f32 v107, v107, v139
    v_mul_f32 v108, v108, v140
    v_mul_f32 v109, v109, v141
    v_mul_f32 v110, v110, v142
    v_mul_f32 v111, v111, v143
    v_cvt_pk_bf16_f32 v104, v104, v105
    v_cvt_pk_bf16_f32 v105, v106, v107
    v_cvt_pk_bf16_f32 v106, v108, v109
    v_cvt_pk_bf16_f32 v107, v110, v111
    buffer_store_dwordx4 v[104:107], v1, s[48:51], s18 offen offset:3072 sc1
    s_waitcnt vmcnt(4)
    s_branch L_attn
L_p1g_A1:
    ds_read_b128 v[72:75], v16 offset:1024
    ds_read_b128 v[76:79], v16 offset:1536
    ds_read_b64_tr_b16 v[40:41], v11 offset:0
    ds_read_b64_tr_b16 v[42:43], v11 offset:512
    ds_read_b64_tr_b16 v[44:45], v11 offset:2048
    ds_read_b64_tr_b16 v[46:47], v11 offset:2560
    ds_read_b64_tr_b16 v[48:49], v11 offset:4096
    ds_read_b64_tr_b16 v[50:51], v11 offset:4608
    v_mfma_f32_32x32x16_bf16 v[80:95], v[52:55], v[252:255], v[80:95]
    v_mfma_f32_32x32x16_bf16 v[96:111], v[56:59], v[252:255], v[96:111]
    ds_read_b64_tr_b16 v[52:53], v11 offset:6144
    ds_read_b64_tr_b16 v[54:55], v11 offset:6656
    s_waitcnt lgkmcnt(6)
    v_mfma_f32_32x32x16_bf16 v[128:143], v[40:43], v[144:147], 0
    v_add_f32 v72, v72, v76
    v_add_f32 v73, v73, v77
    v_add_f32 v74, v74, v78
    v_add_f32 v75, v75, v79
    v_add_f32 v72, v72, v73
    ds_read_b64_tr_b16 v[56:57], v11 offset:8192
    ds_read_b64_tr_b16 v[58:59], v11 offset:8704
    ds_read_b64_tr_b16 v[60:61], v13 offset:0
    ds_read_b64_tr_b16 v[62:63], v13 offset:512
    s_waitcnt lgkmcnt(8)
    v_mfma_f32_32x32x16_bf16 v[128:143], v[44:47], v[148:151], v[128:143]
    v_add_f32 v74, v74, v75
    v_add_f32_e64 v72, v72, v74
    v_cvt_pk_bf16_f32 v73, v72, v72
    v_and_b32 v73, 0xffff0000, v73
    v_sub_f32 v73, v72, v73
    v_cvt_pk_bf16_f32 v32, v72, v73
    v_cvt_pk_bf16_f32 v33, v72, v73
    ds_read_b64_tr_b16 v[40:41], v11 offset:10240
    ds_read_b64_tr_b16 v[42:43], v11 offset:10752
    s_waitcnt lgkmcnt(8)
    v_mfma_f32_32x32x16_bf16 v[128:143], v[48:51], v[152:155], v[128:143]
    ds_read_b128 v[72:75], v16 offset:0
    ds_read_b128 v[76:79], v16 offset:512
    v_mfma_f32_32x32x16_bf16 v[112:127], v[28:31], v[32:35], v[112:127]
    s_waitcnt lgkmcnt(1)
    v_add_f32 v72, v72, v73
    v_add_f32_e64 v74, v74, v75
    v_mfma_f32_16x16x32_bf16 v[64:67], v[24:27], v[60:63], 0
    ds_read_b64_tr_b16 v[44:45], v11 offset:12288
    ds_read_b64_tr_b16 v[46:47], v11 offset:12800
    ds_read_b64_tr_b16 v[60:61], v13 offset:8192
    ds_read_b64_tr_b16 v[62:63], v13 offset:8704
    v_mfma_f32_32x32x16_bf16 v[128:143], v[52:55], v[156:159], v[128:143]
    v_add_f32_e64 v72, v72, v74
    v_cvt_pk_bf16_f32 v73, v72, v72
    v_and_b32 v73, 0xffff0000, v73
    v_sub_f32 v73, v72, v73
    v_cvt_pk_bf16_f32 v36, v72, v73
    v_cvt_pk_bf16_f32 v37, v72, v73
    s_nop 1
    v_mfma_f32_32x32x16_bf16 v[80:95], v[36:39], v[28:31], v[80:95]
    ds_read_b64_tr_b16 v[48:49], v11 offset:14336
    ds_read_b64_tr_b16 v[50:51], v11 offset:14848
    v_mfma_f32_32x32x16_bf16 v[128:143], v[56:59], v[160:163], v[128:143]
    s_waitcnt lgkmcnt(6)
    v_add_f32 v76, v76, v77
    v_add_f32_e64 v78, v78, v79
    v_add_f32 v76, v76, v78
    v_cvt_pk_bf16_f32 v77, v76, v76
    v_and_b32 v77, 0xffff0000, v77
    s_waitcnt lgkmcnt(2)
    v_mfma_f32_16x16x32_bf16 v[64:67], v[24:27], v[60:63], v[64:67]
    ds_read_b64_tr_b16 v[52:53], v11 offset:16384
    ds_read_b64_tr_b16 v[54:55], v11 offset:16896
    ds_read_b64_tr_b16 v[60:61], v13 offset:16384
    ds_read_b64_tr_b16 v[62:63], v13 offset:16896
    v_mfma_f32_32x32x16_bf16 v[128:143], v[40:43], v[164:167], v[128:143]
    v_sub_f32 v77, v76, v77
    v_cvt_pk_bf16_f32 v32, v76, v77
    v_cvt_pk_bf16_f32 v33, v76, v77
    s_nop 1
    v_mfma_f32_32x32x16_bf16 v[96:111], v[32:35], v[28:31], v[96:111]
    ds_read_b128 v[72:75], v8 offset:0
    ds_read_b128 v[76:79], v8 offset:32
    ds_read_b64_tr_b16 v[56:57], v11 offset:18432
    ds_read_b64_tr_b16 v[58:59], v11 offset:18944
    v_mfma_f32_32x32x16_bf16 v[128:143], v[44:47], v[168:171], v[128:143]
    s_waitcnt lgkmcnt(2)
    v_mul_f32 v112, v112, v72
    v_mul_f32 v113, v113, v73
    v_mul_f32 v114, v114, v74
    v_mul_f32 v115, v115, v75
    v_mul_f32 v116, v116, v76
    v_mfma_f32_16x16x32_bf16 v[64:67], v[24:27], v[60:63], v[64:67]
    ds_read_b64_tr_b16 v[40:41], v11 offset:20480
    ds_read_b64_tr_b16 v[42:43], v11 offset:20992
    ds_read_b64_tr_b16 v[60:61], v13 offset:24576
    ds_read_b64_tr_b16 v[62:63], v13 offset:25088
    v_mfma_f32_32x32x16_bf16 v[128:143], v[48:51], v[172:175], v[128:143]
    v_mul_f32 v117, v117, v77
    v_mul_f32 v118, v118, v78
    v_mul_f32_e64 v119, v119, v79
    ds_read_b128 v[72:75], v8 offset:64
    ds_read_b128 v[76:79], v8 offset:96
    s_waitcnt lgkmcnt(0)
    v_mul_f32 v120, v120, v72
    ds_read_b64_tr_b16 v[44:45], v11 offset:22528
    ds_read_b64_tr_b16 v[46:47], v11 offset:23040
    v_mfma_f32_32x32x16_bf16 v[128:143], v[52:55], v[176:179], v[128:143]
    v_mul_f32 v121, v121, v73
    v_mul_f32 v122, v122, v74
    v_mul_f32 v123, v123, v75
    v_mul_f32 v124, v124, v76
    v_mul_f32 v125, v125, v77
    v_mul_f32 v126, v126, v78
    v_mfma_f32_16x16x32_bf16 v[64:67], v[24:27], v[60:63], v[64:67]
    ds_read_b64_tr_b16 v[48:49], v11 offset:24576
    ds_read_b64_tr_b16 v[50:51], v11 offset:25088
    ds_read_b64_tr_b16 v[60:61], v7 offset:0
    ds_read_b64_tr_b16 v[62:63], v7 offset:512
    v_mfma_f32_32x32x16_bf16 v[128:143], v[56:59], v[180:183], v[128:143]
    v_mul_f32_e64 v127, v127, v79
    v_cvt_pk_bf16_f32 v112, v112, v113
    v_cvt_pk_bf16_f32 v113, v114, v115
    v_cvt_pk_bf16_f32 v114, v116, v117
    v_cvt_pk_bf16_f32 v115, v118, v119
    v_cvt_pk_bf16_f32 v116, v120, v121
    v_cvt_pk_bf16_f32 v117, v122, v123
    ds_read_b64_tr_b16 v[52:53], v10 offset:0
    ds_read_b64_tr_b16 v[54:55], v10 offset:512
    v_mfma_f32_32x32x16_bf16 v[128:143], v[40:43], v[184:187], v[128:143]
    v_cvt_pk_bf16_f32 v118, v124, v125
    v_cvt_pk_bf16_f32 v119, v126, v127
    v_cndmask_b32 v112, v112, v17, s[74:75]
    v_cndmask_b32 v113, v113, v17, s[74:75]
    v_cndmask_b32 v114, v114, v17, s[74:75]
    v_cndmask_b32 v115, v115, v17, s[74:75]
    s_nop 0
    s_waitcnt lgkmcnt(2)
    v_mfma_f32_16x16x32_bf16 v[64:67], v[24:27], v[60:63], v[64:67]
    ds_read_b64_tr_b16 v[56:57], v10 offset:2048
    ds_read_b64_tr_b16 v[58:59], v10 offset:2560
    ds_read_b64_tr_b16 v[60:61], v7 offset:8192
    ds_read_b64_tr_b16 v[62:63], v7 offset:8704
    v_mfma_f32_32x32x16_bf16 v[128:143], v[44:47], v[188:191], v[128:143]
    v_cndmask_b32 v116, v116, v17, s[74:75]
    v_cndmask_b32 v117, v117, v17, s[74:75]
    v_cndmask_b32 v118, v118, v17, s[74:75]
    v_cndmask_b32 v119, v119, v17, s[74:75]
    buffer_store_dwordx4 v[112:115], v1, s[48:51], s20 offen sc1
    buffer_store_dwordx4 v[116:119], v1, s[48:51], s20 offen offset:1024 sc1
    s_setprio 2
    ds_read_b64_tr_b16 v[40:41], v10 offset:4096
    ds_read_b64_tr_b16 v[42:43], v10 offset:4608
    v_mfma_f32_32x32x16_bf16 v[128:143], v[48:51], v[192:195], v[128:143]
    v_mul_f32 v72, v80, v80
    v_mul_f32 v73, v81, v81
    v_mul_f32 v74, v82, v82
    v_mul_f32 v75, v83, v83
    v_fma_f32 v72, v72, v21, v20
    s_waitcnt lgkmcnt(2)
    v_mfma_f32_16x16x32_bf16 v[64:67], v[24:27], v[60:63], v[64:67]
    ds_read_b64_tr_b16 v[44:45], v10 offset:6144
    ds_read_b64_tr_b16 v[46:47], v10 offset:6656
    ds_read_b64_tr_b16 v[60:61], v13 offset:32768
    ds_read_b64_tr_b16 v[62:63], v13 offset:33280
    v_mfma_f32_32x32x16_bf16 v[112:127], v[52:55], v[144:147], 0
    v_fma_f32 v73, v73, v21, v20
    v_fma_f32 v74, v74, v21, v20
    v_fma_f32 v75, v75, v21, v20
    v_mul_f32 v72, v72, v80
    v_mul_f32 v73, v73, v81
    v_mul_f32_e64 v74, v74, v82
    ds_read_b64_tr_b16 v[48:49], v10 offset:8192
    ds_read_b64_tr_b16 v[50:51], v10 offset:8704
    v_mfma_f32_32x32x16_bf16 v[112:127], v[56:59], v[148:151], v[112:127]
    v_mul_f32 v75, v75, v83
    v_exp_f32 v72, v72
    v_exp_f32 v73, v73
    v_exp_f32 v74, v74
    v_exp_f32_e64 v75, v75
    s_min_u32 s34, s4, 27
    s_lshr_b32 s35, s34, 2
    s_and_b32 s34, s34, 3
    s_lshl_b32 s34, s34, 1
    s_add_u32 s34, s34, s35
    s_add_u32 s34, s34, s3
    s_mul_i32 s13, s34, 37
    s_waitcnt lgkmcnt(2)
    v_mfma_f32_16x16x32_bf16 v[64:67], v[24:27], v[60:63], v[64:67]
    ds_read_b64_tr_b16 v[52:53], v10 offset:10240
    ds_read_b64_tr_b16 v[54:55], v10 offset:10752
    v_mfma_f32_32x32x16_bf16 v[112:127], v[40:43], v[152:155], v[112:127]
    v_fma_f32 v72, v72, v19, v19
    v_fma_f32 v73, v73, v19, v19
    v_fma_f32 v74, v74, v19, v19
    v_fma_f32 v75, v75, v19, v19
    v_rcp_f32 v72, v72
    v_rcp_f32 v73, v73
    s_lshr_b32 s13, s13, 8
    s_mul_i32 s13, s13, 7
    s_sub_u32 s10, s34, s13
    s_lshl_b32 s10, s10, 2
    s_lshl_b32 s35, s35, 7
    s_mul_i32 s12, s14, 401408
    s_add_u32 s12, s12, s35
    ds_read_b64_tr_b16 v[56:57], v10 offset:12288
    ds_read_b64_tr_b16 v[58:59], v10 offset:12800
    v_mfma_f32_32x32x16_bf16 v[112:127], v[44:47], v[156:159], v[112:127]
    v_rcp_f32 v74, v74
    v_rcp_f32 v75, v75
    v_mul_f32 v80, v80, v72
    v_mul_f32 v81, v81, v73
    v_mul_f32 v82, v82, v74
    v_mul_f32 v83, v83, v75
    s_add_u32 s13, s12, 401408
    s_mul_i32 s9, s10, 14336
    s_add_u32 s9, s9, s12
    s_lshl_b32 s11, s14, 11
    s_cmp_lt_u32 s4, 28
    s_cselect_b32 s58, s58, 0
    v_and_b32_e64 v2, 7, v0
    ds_read_b64_tr_b16 v[40:41], v10 offset:14336
    ds_read_b64_tr_b16 v[42:43], v10 offset:14848
    s_waitcnt lgkmcnt(6)
    v_mfma_f32_32x32x16_bf16 v[112:127], v[48:51], v[160:163], v[112:127]
    v_mul_f32 v76, v84, v84
    v_mul_f32 v77, v85, v85
    v_mul_f32 v78, v86, v86
    v_mul_f32_e64 v79, v87, v87
    v_fma_f32 v76, v76, v21, v20
    v_bfe_u32 v3, v0, 4, 1
    v_lshlrev_b32 v3, 2, v3
    v_xor_b32 v2, v2, v3
    v_lshlrev_b32 v2, 4, v2
    v_lshrrev_b32 v3, 3, v0
    v_mul_u32_u24 v3, 896, v3
    v_add_u32 v2, v2, v3
    v_add_u32 v3, 6144, v2
    ds_write_b32 v15, v64 offset:2048
    ds_read_b64_tr_b16 v[44:45], v10 offset:16384
    ds_read_b64_tr_b16 v[46:47], v10 offset:16896
    s_waitcnt lgkmcnt(7)
    v_mfma_f32_32x32x16_bf16 v[112:127], v[52:55], v[164:167], v[112:127]
    v_fma_f32 v77, v77, v21, v20
    v_fma_f32 v78, v78, v21, v20
    v_fma_f32 v79, v79, v21, v20
    v_mul_f32 v76, v76, v84
    v_mul_f32 v77, v77, v85
    v_mul_f32_e64 v78, v78, v86
    ds_read_b64_tr_b16 v[48:49], v10 offset:18432
    ds_read_b64_tr_b16 v[50:51], v10 offset:18944
    s_waitcnt lgkmcnt(7)
    v_mfma_f32_32x32x16_bf16 v[112:127], v[56:59], v[168:171], v[112:127]
    v_mul_f32 v79, v79, v87
    v_exp_f32 v76, v76
    v_exp_f32 v77, v77
    v_exp_f32_e64 v78, v78
    v_exp_f32 v79, v79
    s_waitcnt lgkmcnt(4)
    s_mov_b64 exec, 1
    ds_add_u32 v5, v9 offset:48
    s_mov_b64 exec, -1
    ds_read_b64_tr_b16 v[52:53], v10 offset:20480
    ds_read_b64_tr_b16 v[54:55], v10 offset:20992
    v_mfma_f32_32x32x16_bf16 v[112:127], v[40:43], v[172:175], v[112:127]
    v_fma_f32 v76, v76, v19, v19
    v_fma_f32 v77, v77, v19, v19
    v_fma_f32 v78, v78, v19, v19
    v_fma_f32 v79, v79, v19, v19
    v_rcp_f32_e64 v76, v76
    v_rcp_f32 v77, v77
    s_add_u32 m0, s11, 49152
    s_nop 0
    buffer_load_dwordx4 v2, s[56:59], s9 offen lds
    ds_read_b64_tr_b16 v[56:57], v10 offset:22528
    ds_read_b64_tr_b16 v[58:59], v10 offset:23040
    s_waitcnt lgkmcnt(7)
    v_mfma_f32_32x32x16_bf16 v[112:127], v[44:47], v[176:179], v[112:127]
    v_rcp_f32 v78, v78
    v_rcp_f32 v79, v79
    v_mul_f32 v84, v84, v76
    v_mul_f32 v85, v85, v77
    v_mul_f32 v86, v86, v78
    v_mul_f32 v87, v87, v79
    v_mov_b32 v23, s97
    s_waitcnt vmcnt(1)
    buffer_store_dword v23, off, s[48:51], s19 offset:0 sc1
    s_add_u32 m0, s11, 49152
    s_nop 0
    buffer_load_dwordx4 v3, s[56:59], s9 offen offset:1024 lds
    s_add_u32 s9, s9, 14336
    s_cmp_eq_u32 s9, s13
    s_cselect_b32 s9, s12, s9
    ds_read_b64_tr_b16 v[40:41], v10 offset:24576
    ds_read_b64_tr_b16 v[42:43], v10 offset:25088
    s_waitcnt lgkmcnt(7)
    v_mfma_f32_32x32x16_bf16 v[112:127], v[48:51], v[180:183], v[112:127]
    v_mul_f32 v72, v88, v88
    v_mul_f32 v73, v89, v89
    v_mul_f32 v74, v90, v90
    v_mul_f32_e64 v75, v91, v91
    v_fma_f32 v72, v72, v21, v20
    s_add_u32 m0, s11, 73728
    s_nop 0
    buffer_load_dwordx4 v2, s[56:59], s9 offen lds
    ds_read_b64_tr_b16 v[44:45], v10 offset:26624
    ds_read_b64_tr_b16 v[46:47], v10 offset:27136
    s_waitcnt lgkmcnt(6)
    v_mfma_f32_32x32x16_bf16 v[112:127], v[52:55], v[184:187], v[112:127]
    v_fma_f32 v73, v73, v21, v20
    v_fma_f32 v74, v74, v21, v20
    v_fma_f32 v75, v75, v21, v20
    v_mul_f32 v72, v72, v88
    v_mul_f32 v73, v73, v89
    v_mul_f32 v74, v74, v90
    s_add_u32 m0, s11, 73728
    s_nop 0
    buffer_load_dwordx4 v3, s[56:59], s9 offen offset:1024 lds
    s_add_u32 s9, s9, 14336
    s_cmp_eq_u32 s9, s13
    s_cselect_b32 s9, s12, s9
    ds_read_b64_tr_b16 v[48:49], v11 offset:26624
    ds_read_b64_tr_b16 v[50:51], v11 offset:27136
    s_waitcnt lgkmcnt(6)
    v_mfma_f32_32x32x16_bf16 v[112:127], v[56:59], v[188:191], v[112:127]
    v_mul_f32 v75, v75, v91
    v_exp_f32 v72, v72
    v_exp_f32 v73, v73
    v_exp_f32 v74, v74
    v_exp_f32 v75, v75
    s_add_u32 m0, s11, 143360
    s_nop 0
    buffer_load_dwordx4 v2, s[56:59], s9 offen lds
    ds_read_b64_tr_b16 v[52:53], v10 offset:28672
    ds_read_b64_tr_b16 v[54:55], v10 offset:29184
    s_waitcnt lgkmcnt(6)
    v_mfma_f32_32x32x16_bf16 v[112:127], v[40:43], v[192:195], v[112:127]
    v_fma_f32 v72, v72, v19, v19
    v_fma_f32 v73, v73, v19, v19
    v_fma_f32 v74, v74, v19, v19
    v_fma_f32 v75, v75, v19, v19
    v_rcp_f32_e64 v72, v72
    v_rcp_f32 v73, v73
    s_add_u32 m0, s11, 143360
    s_nop 0
    buffer_load_dwordx4 v3, s[56:59], s9 offen offset:1024 lds
    s_add_u32 s9, s9, 14336
    s_cmp_eq_u32 s9, s13
    s_cselect_b32 s9, s12, s9
    ds_read_b64_tr_b16 v[56:57], v11 offset:28672
    ds_read_b64_tr_b16 v[58:59], v11 offset:29184
    s_waitcnt lgkmcnt(6)
    v_mfma_f32_32x32x16_bf16 v[112:127], v[44:47], v[196:199], v[112:127]
    v_rcp_f32 v74, v74
    v_rcp_f32 v75, v75
    v_mul_f32 v88, v88, v72
    v_mul_f32 v89, v89, v73
    v_mul_f32 v90, v90, v74
    v_mul_f32 v91, v91, v75
    v_lshrrev_b32 v150, 5, v0
    v_bfe_u32 v151, v0, 2, 2
    v_lshl_add_u32 v144, v150, 3, v151
    v_lshlrev_b32_e64 v144, 7, v144
    v_lshrrev_b32 v151, 1, v151
    s_add_u32 m0, s11, 40960
    s_nop 0
    buffer_load_dwordx4 v2, s[56:59], s9 offen lds
    ds_read_b64_tr_b16 v[40:41], v10 offset:30720
    ds_read_b64_tr_b16 v[42:43], v10 offset:31232
    s_waitcnt lgkmcnt(6)
    v_mfma_f32_32x32x16_bf16 v[128:143], v[48:51], v[196:199], v[128:143]
    v_mul_f32 v76, v92, v92
    v_mul_f32 v77, v93, v93
    v_mul_f32 v78, v94, v94
    v_mul_f32_e64 v79, v95, v95
    v_fma_f32 v76, v76, v21, v20
    v_lshl_add_u32 v144, v151, 6, v144
    v_bfe_u32 v151, v0, 4, 1
    v_lshl_add_u32 v144, v151, 5, v144
    v_and_b32_e64 v151, 1, v0
    v_lshl_add_u32 v144, v151, 4, v144
    v_bfe_u32 v151, v0, 1, 1
    s_add_u32 m0, s11, 40960
    s_nop 0
    buffer_load_dwordx4 v3, s[56:59], s9 offen offset:1024 lds
    s_add_u32 s9, s9, 14336
    s_cmp_eq_u32 s9, s13
    s_cselect_b32 s9, s12, s9
    ds_read_b64_tr_b16 v[44:45], v11 offset:30720
    ds_read_b64_tr_b16 v[46:47], v11 offset:31232
    s_waitcnt lgkmcnt(6)
    v_mfma_f32_32x32x16_bf16 v[112:127], v[52:55], v[200:203], v[112:127]
    v_fma_f32 v77, v77, v21, v20
    v_fma_f32 v78, v78, v21, v20
    v_fma_f32 v79, v79, v21, v20
    v_mul_f32 v76, v76, v92
    v_mul_f32 v77, v77, v93
    v_mul_f32_e64 v78, v78, v94
    v_lshl_add_u32 v144, v151, 3, v144
    s_lshr_b32 s34, s14, 1
    s_lshl_b32 s34, s34, 6
    v_xor_b32_e64 v144, s34, v144
    s_lshl_b32 s34, s14, 11
    s_add_u32 s34, s34, 0
    ds_read_b64_tr_b16 v[48:49], v12 offset:0
    ds_read_b64_tr_b16 v[50:51], v12 offset:512
    s_waitcnt lgkmcnt(6)
    v_mfma_f32_32x32x16_bf16 v[128:143], v[56:59], v[200:203], v[128:143]
    v_mul_f32 v79, v79, v95
    v_exp_f32 v76, v76
    v_exp_f32 v77, v77
    v_exp_f32 v78, v78
    v_exp_f32 v79, v79
    v_add_u32 v144, s34, v144
    v_xor_b32 v145, 64, v144
    v_add_u32 v146, 0x10000, v144
    v_add_u32 v147, 0x10000, v145
    v_add_u32 v148, 0x20000, v144
    v_add_u32 v149, 0x20000, v145
    ds_read_b64_tr_b16 v[52:53], v14 offset:0
    ds_read_b64_tr_b16 v[54:55], v14 offset:512
    s_nop 0
    s_waitcnt lgkmcnt(6)
    v_mfma_f32_32x32x16_bf16 v[112:127], v[40:43], v[204:207], v[112:127]
    v_fma_f32 v76, v76, v19, v19
    v_fma_f32 v77, v77, v19, v19
    v_fma_f32 v78, v78, v19, v19
    v_fma_f32 v79, v79, v19, v19
    v_rcp_f32 v76, v76
    v_rcp_f32 v77, v77
    s_lshl_b32 s76, s4, 3
    s_add_u32 s76, s76, s5
    v_min_u32 v23, 12, v0
    v_lshlrev_b32 v23, 7, v23
    s_mul_i32 s77, s76, 1568
    buffer_load_dword v192, v23, s[60:63], s77 offen
    ds_read_b64_tr_b16 v[56:57], v12 offset:2048
    ds_read_b64_tr_b16 v[58:59], v12 offset:2560
    s_waitcnt lgkmcnt(6)
    v_mfma_f32_32x32x16_bf16 v[128:143], v[44:47], v[204:207], v[128:143]
    v_rcp_f32 v78, v78
    v_rcp_f32 v79, v79
    v_mul_f32 v92, v92, v76
    v_mul_f32 v93, v93, v77
    v_mul_f32 v94, v94, v78
    v_mul_f32_e64 v95, v95, v79
    ds_read_b64_tr_b16 v[40:41], v14 offset:2048
    ds_read_b64_tr_b16 v[42:43], v14 offset:2560
    s_waitcnt lgkmcnt(6)
    v_mfma_f32_32x32x16_bf16 v[112:127], v[48:51], v[208:211], v[112:127]
    v_mul_f32 v72, v96, v96
    v_mul_f32 v73, v97, v97
    v_mul_f32 v74, v98, v98
    v_mul_f32 v75, v99, v99
    v_fma_f32 v72, v72, v21, v20
    ds_read_b64_tr_b16 v[44:45], v12 offset:4096
    ds_read_b64_tr_b16 v[46:47], v12 offset:4608
    s_waitcnt lgkmcnt(6)
    v_mfma_f32_32x32x16_bf16 v[128:143], v[52:55], v[208:211], v[128:143]
    v_fma_f32 v73, v73, v21, v20
    v_fma_f32 v74, v74, v21, v20
    v_fma_f32 v75, v75, v21, v20
    v_mul_f32 v72, v72, v96
    v_mul_f32 v73, v73, v97
    v_mul_f32_e64 v74, v74, v98
    ds_read_b64_tr_b16 v[48:49], v14 offset:4096
    ds_read_b64_tr_b16 v[50:51], v14 offset:4608
    s_waitcnt lgkmcnt(6)
    v_mfma_f32_32x32x16_bf16 v[112:127], v[56:59], v[212:215], v[112:127]
    v_mul_f32 v75, v75, v99
    v_exp_f32 v72, v72
    v_exp_f32 v73, v73
    v_exp_f32_e64 v74, v74
    v_exp_f32 v75, v75
    ds_read_b64_tr_b16 v[52:53], v12 offset:6144
    ds_read_b64_tr_b16 v[54:55], v12 offset:6656
    s_waitcnt lgkmcnt(6)
    v_mfma_f32_32x32x16_bf16 v[128:143], v[40:43], v[212:215], v[128:143]
    v_fma_f32 v72, v72, v19, v19
    v_fma_f32 v73, v73, v19, v19
    v_fma_f32 v74, v74, v19, v19
    v_fma_f32 v75, v75, v19, v19
    v_rcp_f32 v72, v72
    v_rcp_f32 v73, v73
    ds_read_b64_tr_b16 v[56:57], v14 offset:6144
    ds_read_b64_tr_b16 v[58:59], v14 offset:6656
    s_waitcnt lgkmcnt(6)
    v_mfma_f32_32x32x16_bf16 v[112:127], v[44:47], v[216:219], v[112:127]
    v_rcp_f32 v74, v74
    v_rcp_f32 v75, v75
    v_mul_f32 v96, v96, v72
    v_mul_f32 v97, v97, v73
    v_mul_f32 v98, v98, v74
    v_mul_f32_e64 v99, v99, v75
    ds_read_b64_tr_b16 v[40:41], v12 offset:8192
    ds_read_b64_tr_b16 v[42:43], v12 offset:8704
    s_waitcnt lgkmcnt(6)
    v_mfma_f32_32x32x16_bf16 v[128:143], v[48:51], v[216:219], v[128:143]
    v_mul_f32 v76, v100, v100
    v_mul_f32 v77, v101, v101
    v_mul_f32 v78, v102, v102
    v_mul_f32 v79, v103, v103
    v_fma_f32 v76, v76, v21, v20
    ds_read_b64_tr_b16 v[44:45], v14 offset:8192
    ds_read_b64_tr_b16 v[46:47], v14 offset:8704
    s_waitcnt lgkmcnt(6)
    v_mfma_f32_32x32x16_bf16 v[112:127], v[52:55], v[220:223], v[112:127]
    v_fma_f32 v77, v77, v21, v20
    v_fma_f32 v78, v78, v21, v20
    v_fma_f32 v79, v79, v21, v20
    v_mul_f32 v76, v76, v100
    v_mul_f32 v77, v77, v101
    v_mul_f32_e64 v78, v78, v102
    ds_read_b64_tr_b16 v[48:49], v12 offset:10240
    ds_read_b64_tr_b16 v[50:51], v12 offset:10752
    s_waitcnt lgkmcnt(6)
    v_mfma_f32_32x32x16_bf16 v[128:143], v[56:59], v[220:223], v[128:143]
    v_mul_f32 v79, v79, v103
    v_exp_f32 v76, v76
    v_exp_f32 v77, v77
    v_exp_f32_e64 v78, v78
    v_exp_f32 v79, v79
    ds_read_b64_tr_b16 v[52:53], v14 offset:10240
    ds_read_b64_tr_b16 v[54:55], v14 offset:10752
    s_waitcnt lgkmcnt(6)
    v_mfma_f32_32x32x16_bf16 v[112:127], v[40:43], v[224:227], v[112:127]
    v_fma_f32 v76, v76, v19, v19
    v_fma_f32 v77, v77, v19, v19
    v_fma_f32 v78, v78, v19, v19
    v_fma_f32 v79, v79, v19, v19
    v_rcp_f32 v76, v76
    v_rcp_f32 v77, v77
    ds_read_b64_tr_b16 v[56:57], v12 offset:12288
    ds_read_b64_tr_b16 v[58:59], v12 offset:12800
    s_waitcnt lgkmcnt(6)
    v_mfma_f32_32x32x16_bf16 v[128:143], v[44:47], v[224:227], v[128:143]
    v_rcp_f32 v78, v78
    v_rcp_f32 v79, v79
    v_mul_f32 v100, v100, v76
    v_mul_f32 v101, v101, v77
    v_mul_f32 v102, v102, v78
    v_mul_f32_e64 v103, v103, v79
    ds_read_b64_tr_b16 v[40:41], v14 offset:12288
    ds_read_b64_tr_b16 v[42:43], v14 offset:12800
    s_waitcnt lgkmcnt(6)
    v_mfma_f32_32x32x16_bf16 v[112:127], v[48:51], v[228:231], v[112:127]
    s_mov_b32 s76, 200000
L_ll8:
    ds_read_b32 v23, v5 offset:48
    s_waitcnt lgkmcnt(0)
    v_readfirstlane_b32 s77, v23
    s_nop 0
    s_cmp_eq_u32 s77, 8
    s_cbranch_scc1 L_lk8
    s_sleep 1
    s_sub_u32 s76, s76, 1
    s_cbranch_scc0 L_ll8
L_lk8:
    ds_read_b128 v[216:219], v16 offset:2048
    ds_read_b128 v[220:223], v16 offset:2560
    s_waitcnt vmcnt(7)
    ds_read_b64_tr_b16 v[152:153], v144 offset:49152
    ds_read_b64_tr_b16 v[154:155], v144 offset:49664
    ds_read_b64_tr_b16 v[156:157], v145 offset:49152
    ds_read_b64_tr_b16 v[158:159], v145 offset:49664
    ds_read_b64_tr_b16 v[44:45], v12 offset:14336
    ds_read_b64_tr_b16 v[46:47], v12 offset:14848
    v_mfma_f32_32x32x16_bf16 v[128:143], v[52:55], v[228:231], v[128:143]
    v_mul_f32 v72, v104, v104
    v_mul_f32 v73, v105, v105
    v_mul_f32 v74, v106, v106
    v_mul_f32 v75, v107, v107
    v_fma_f32 v72, v72, v21, v20
    v_fma_f32 v73, v73, v21, v20
    s_waitcnt lgkmcnt(2)
    s_add_u32 m0, s11, 49152
    s_nop 0
    buffer_load_dwordx4 v2, s[56:59], s9 offen lds
    ds_read_b64_tr_b16 v[48:49], v14 offset:14336
    ds_read_b64_tr_b16 v[50:51], v14 offset:14848
    v_mfma_f32_32x32x16_bf16 v[112:127], v[56:59], v[232:235], v[112:127]
    v_fma_f32 v74, v74, v21, v20
    v_fma_f32 v75, v75, v21, v20
    v_mul_f32 v72, v72, v104
    v_mul_f32 v73, v73, v105
    v_mul_f32 v74, v74, v106
    v_mul_f32 v75, v75, v107
    v_exp_f32 v72, v72
    s_waitcnt vmcnt(6)
    ds_read_b64_tr_b16 v[160:161], v146 offset:8192
    ds_read_b64_tr_b16 v[162:163], v146 offset:8704
    ds_read_b64_tr_b16 v[164:165], v147 offset:8192
    ds_read_b64_tr_b16 v[166:167], v147 offset:8704
    s_add_u32 m0, s11, 49152
    s_nop 0
    s_nop 0
    buffer_load_dwordx4 v3, s[56:59], s9 offen offset:1024 lds
    s_add_u32 s9, s9, 14336
    s_cmp_eq_u32 s9, s13
    s_cselect_b32 s9, s12, s9
    ds_read_b64_tr_b16 v[52:53], v10 offset:32768
    ds_read_b64_tr_b16 v[54:55], v10 offset:33280
    v_mfma_f32_32x32x16_bf16 v[128:143], v[40:43], v[232:235], v[128:143]
    v_exp_f32 v73, v73
    v_add_f32 v216, v216, v217
    v_add_f32 v218, v218, v219
    v_add_f32 v216, v216, v218
    v_cvt_pk_bf16_f32 v217, v216, v216
    v_and_b32 v217, 0xffff0000, v217
    s_waitcnt lgkmcnt(2)
    s_add_u32 m0, s11, 73728
    s_nop 0
    buffer_load_dwordx4 v2, s[56:59], s9 offen lds
    ds_read_b64_tr_b16 v[56:57], v11 offset:32768
    ds_read_b64_tr_b16 v[58:59], v11 offset:33280
    v_mfma_f32_32x32x16_bf16 v[112:127], v[44:47], v[236:239], v[112:127]
    v_sub_f32_e64 v217, v216, v217
    v_cvt_pk_bf16_f32 v32, v216, v217
    v_cvt_pk_bf16_f32 v33, v216, v217
    v_add_f32 v220, v220, v221
    v_add_f32 v222, v222, v223
    v_add_f32 v220, v220, v222
    s_waitcnt vmcnt(6)
    ds_read_b64_tr_b16 v[168:169], v148 offset:12288
    ds_read_b64_tr_b16 v[170:171], v148 offset:12800
    ds_read_b64_tr_b16 v[172:173], v149 offset:12288
    ds_read_b64_tr_b16 v[174:175], v149 offset:12800
    s_add_u32 m0, s11, 73728
    s_nop 0
    s_nop 0
    buffer_load_dwordx4 v3, s[56:59], s9 offen offset:1024 lds
    s_add_u32 s9, s9, 14336
    s_cmp_eq_u32 s9, s13
    s_cselect_b32 s9, s12, s9
    ds_read_b64_tr_b16 v[40:41], v10 offset:34816
    ds_read_b64_tr_b16 v[42:43], v10 offset:35328
    v_mfma_f32_32x32x16_bf16 v[128:143], v[48:51], v[236:239], v[128:143]
    v_cvt_pk_bf16_f32 v221, v220, v220
    v_and_b32 v221, 0xffff0000, v221
    v_sub_f32 v221, v220, v221
    v_cvt_pk_bf16_f32 v36, v220, v221
    v_cvt_pk_bf16_f32 v37, v220, v221
    v_mfma_f32_32x32x16_bf16 v[112:127], v[32:35], v[28:31], v[112:127]
    s_nop 0
    v_mfma_f32_32x32x16_bf16 v[128:143], v[36:39], v[28:31], v[128:143]
    s_waitcnt lgkmcnt(2)
    s_add_u32 m0, s11, 143360
    s_nop 0
    buffer_load_dwordx4 v2, s[56:59], s9 offen lds
    ds_read_b64_tr_b16 v[44:45], v11 offset:34816
    ds_read_b64_tr_b16 v[46:47], v11 offset:35328
    v_mfma_f32_32x32x16_bf16 v[112:127], v[52:55], v[240:243], v[112:127]
    v_exp_f32 v74, v74
    v_exp_f32 v75, v75
    v_fma_f32 v72, v72, v19, v19
    v_fma_f32 v73, v73, v19, v19
    v_fma_f32 v74, v74, v19, v19
    v_fma_f32 v75, v75, v19, v19
    v_rcp_f32 v72, v72
    s_waitcnt vmcnt(6)
    ds_read_b64_tr_b16 v[176:177], v144 offset:40960
    ds_read_b64_tr_b16 v[178:179], v144 offset:41472
    ds_read_b64_tr_b16 v[180:181], v145 offset:40960
    ds_read_b64_tr_b16 v[182:183], v145 offset:41472
    s_add_u32 m0, s11, 143360
    s_nop 0
    s_nop 0
    buffer_load_dwordx4 v3, s[56:59], s9 offen offset:1024 lds
    s_add_u32 s9, s9, 14336
    s_cmp_eq_u32 s9, s13
    s_cselect_b32 s9, s12, s9
    ds_read_b64_tr_b16 v[48:49], v10 offset:36864
    ds_read_b64_tr_b16 v[50:51], v10 offset:37376
    v_mfma_f32_32x32x16_bf16 v[128:143], v[56:59], v[240:243], v[128:143]
    v_rcp_f32 v73, v73
    v_rcp_f32 v74, v74
    v_rcp_f32 v75, v75
    v_mul_f32 v104, v104, v72
    v_mul_f32 v105, v105, v73
    v_mul_f32 v106, v106, v74
    v_mul_f32_e64 v107, v107, v75
    s_waitcnt lgkmcnt(2)
    s_add_u32 m0, s11, 40960
    s_nop 0
    buffer_load_dwordx4 v2, s[56:59], s9 offen lds
    ds_read_b64_tr_b16 v[52:53], v11 offset:36864
    ds_read_b64_tr_b16 v[54:55], v11 offset:37376
    v_mfma_f32_32x32x16_bf16 v[112:127], v[40:43], v[244:247], v[112:127]
    v_mul_f32 v76, v108, v108
    v_mul_f32 v77, v109, v109
    v_mul_f32 v78, v110, v110
    v_mul_f32 v79, v111, v111
    v_fma_f32 v76, v76, v21, v20
    v_fma_f32 v77, v77, v21, v20
    v_fma_f32 v78, v78, v21, v20
    s_add_u32 m0, s11, 40960
    s_nop 0
    s_nop 0
    buffer_load_dwordx4 v3, s[56:59], s9 offen offset:1024 lds
    s_add_u32 s9, s9, 14336
    s_cmp_eq_u32 s9, s13
    s_cselect_b32 s9, s12, s9
    ds_read_b64_tr_b16 v[56:57], v10 offset:38912
    ds_read_b64_tr_b16 v[58:59], v10 offset:39424
    v_mfma_f32_32x32x16_bf16 v[128:143], v[44:47], v[244:247], v[128:143]
    v_fma_f32 v79, v79, v21, v20
    v_mul_f32 v76, v76, v108
    v_mul_f32 v77, v77, v109
    v_mul_f32 v78, v78, v110
    v_mul_f32 v79, v79, v111
    v_exp_f32 v76, v76
    v_exp_f32 v77, v77
    ds_read_b64_tr_b16 v[40:41], v11 offset:38912
    ds_read_b64_tr_b16 v[42:43], v11 offset:39424
    s_waitcnt lgkmcnt(6)
    v_mfma_f32_32x32x16_bf16 v[112:127], v[48:51], v[248:251], v[112:127]
    v_exp_f32 v78, v78
    v_exp_f32_e64 v79, v79
    v_fma_f32 v76, v76, v19, v19
    v_fma_f32 v77, v77, v19, v19
    v_fma_f32 v78, v78, v19, v19
    v_fma_f32 v79, v79, v19, v19
    v_rcp_f32 v76, v76
    s_waitcnt lgkmcnt(4)
    v_mfma_f32_32x32x16_bf16 v[128:143], v[52:55], v[248:251], v[128:143]
    s_waitcnt lgkmcnt(0)
    s_mov_b64 exec, 1
    ds_add_u32 v5, v9 offset:80
    s_mov_b64 exec, -1
    v_rcp_f32 v77, v77
    v_rcp_f32 v78, v78
    v_rcp_f32 v79, v79
    v_mul_f32 v108, v108, v76
    v_mul_f32 v109, v109, v77
    v_mul_f32 v110, v110, v78
    v_mul_f32 v111, v111, v79
    v_mfma_f32_32x32x16_bf16 v[112:127], v[56:59], v[252:255], v[112:127]
    v_mfma_f32_32x32x16_bf16 v[128:143], v[40:43], v[252:255], v[128:143]
    s_lshl_b32 s99, s8, 7
    s_lshl_b32 s34, s7, 2
    s_add_u32 s99, s99, s34
    s_add_u32 s99, s99, 18956288
    s_nop 6
    v_mul_f32 v80, v80, v112
    v_mul_f32 v81, v81, v113
    v_mul_f32 v82, v82, v114
    v_mul_f32 v83, v83, v115
    v_mul_f32 v84, v84, v116
    v_mul_f32 v85, v85, v117
    v_mul_f32 v86, v86, v118
    v_mul_f32 v87, v87, v119
    v_cvt_pk_bf16_f32 v80, v80, v81
    v_cvt_pk_bf16_f32 v81, v82, v83
    v_cvt_pk_bf16_f32 v82, v84, v85
    v_cvt_pk_bf16_f32 v83, v86, v87
    buffer_store_dwordx4 v[80:83], v1, s[48:51], s18 offen offset:0 sc1
    v_mul_f32 v88, v88, v120
    v_mul_f32 v89, v89, v121
    v_mul_f32 v90, v90, v122
    v_mul_f32 v91, v91, v123
    v_mul_f32 v92, v92, v124
    v_mul_f32 v93, v93, v125
    v_mul_f32 v94, v94, v126
    v_mul_f32 v95, v95, v127
    v_cvt_pk_bf16_f32 v88, v88, v89
    v_cvt_pk_bf16_f32 v89, v90, v91
    v_cvt_pk_bf16_f32 v90, v92, v93
    v_cvt_pk_bf16_f32 v91, v94, v95
    buffer_store_dwordx4 v[88:91], v1, s[48:51], s18 offen offset:1024 sc1
    v_mul_f32 v96, v96, v128
    v_mul_f32 v97, v97, v129
    v_mul_f32 v98, v98, v130
    v_mul_f32 v99, v99, v131
    v_mul_f32 v100, v100, v132
    v_mul_f32 v101, v101, v133
    v_mul_f32 v102, v102, v134
    v_mul_f32 v103, v103, v135
    v_cvt_pk_bf16_f32 v96, v96, v97
    v_cvt_pk_bf16_f32 v97, v98, v99
    v_cvt_pk_bf16_f32 v98, v100, v101
    v_cvt_pk_bf16_f32 v99, v102, v103
    buffer_store_dwordx4 v[96:99], v1, s[48:51], s18 offen offset:2048 sc1
    v_mul_f32 v104, v104, v136
    v_mul_f32 v105, v105, v137
    v_mul_f32 v106, v106, v138
    v_mul_f32 v107, v107, v139
    v_mul_f32 v108, v108, v140
    v_mul_f32 v109, v109, v141
    v_mul_f32 v110, v110, v142
    v_mul_f32 v111, v111, v143
    v_cvt_pk_bf16_f32 v104, v104, v105
    v_cvt_pk_bf16_f32 v105, v106, v107
    v_cvt_pk_bf16_f32 v106, v108, v109
    v_cvt_pk_bf16_f32 v107, v110, v111
    buffer_store_dwordx4 v[104:107], v1, s[48:51], s18 offen offset:3072 sc1
    s_branch L_gemm
L_a_A2:
    s_sub_u32 s19, s7, 16
    s_mul_i32 s10, s5, 28672
    s_lshl_b32 s34, s7, 7
    s_add_u32 s10, s10, s34
    s_lshl_b32 s12, s5, 10
    s_mov_b32 s34, s19
    s_and_b32 s25, s34, 1
    s_mul_i32 s33, s34, 56
    s_add_u32 s11, s11, s33
    s_lshl_b32 s33, s25, 3
    s_nop 0
    s_sub_u32 s11, s11, s33
    s_mul_i32 s34, s90, 229376
    s_add_u32 m0, s12, 0
    s_add_u32 s34, s34, s10
    buffer_load_dwordx4 v4, s[36:39], s34 offen lds
    s_mul_i32 s34, s90, 172032
    s_add_u32 m0, s13, 0
    s_add_u32 s34, s34, s11
    s_mov_b64 exec, s[74:75]
    buffer_load_dwordx4 v5, s[44:47], s34 offen lds
    s_mov_b64 exec, -1
    s_load_dwordx2 s[48:49], s[0:1], 72
    s_load_dwordx2 s[40:41], s[0:1], 40
    s_load_dwordx2 s[56:57], s[0:1], 48
    s_load_dwordx2 s[60:61], s[0:1], 16
    s_load_dwordx2 s[64:65], s[0:1], 56
    v_lshlrev_b32 v1, 4, v0
    s_cmp_eq_u32 s15, 0
    s_cbranch_scc1 L_nosrA2
    v_and_b32 v137, 31, v0
    v_cmp_gt_u32 vcc, 28, v137
    v_lshrrev_b32 v136, 5, v0
    v_mul_u32_u24 v136, 896, v136
    v_lshl_add_u32 v136, v137, 5, v136
    v_mov_b32 v137, 0x7fffff00
    v_cndmask_b32 v136, v137, v136, vcc
    s_lshl_b32 s98, s6, 8
    s_lshl_b32 s34, s7, 3
    s_add_u32 s98, s98, s34
    s_lshl_b32 s34, s14, 1
    s_add_u32 s98, s98, s34
    s_mul_i32 s33, s98, 896
    buffer_load_dwordx4 v[80:83], v136, s[52:55], s33 offen
    buffer_load_dwordx4 v[84:87], v136, s[52:55], s33 offen offset:16
L_nosrA2:
    s_add_u32 s91, s90, 1
    s_cmp_ge_u32 s91, 7
    s_cselect_b32 s34, 7, 0
    s_sub_u32 s91, s91, s34
    s_add_u32 s92, s90, 2
    s_cmp_ge_u32 s92, 7
    s_cselect_b32 s34, 7, 0
    s_sub_u32 s92, s92, s34
    s_add_u32 s93, s90, 3
    s_cmp_ge_u32 s93, 7
    s_cselect_b32 s34, 7, 0
    s_sub_u32 s93, s93, s34
    s_add_u32 s94, s90, 4
    s_cmp_ge_u32 s94, 7
    s_cselect_b32 s34, 7, 0
    s_sub_u32 s94, s94, s34
    s_add_u32 s95, s90, 5
    s_cmp_ge_u32 s95, 7
    s_cselect_b32 s34, 7, 0
    s_sub_u32 s95, s95, s34
    s_add_u32 s96, s90, 6
    s_cmp_ge_u32 s96, 7
    s_cselect_b32 s34, 7, 0
    s_sub_u32 s96, s96, s34
    s_mov_b32 s70, 256
    s_mov_b32 s71, 0x00020000
    s_mov_b32 s50, 19922944
    s_mov_b32 s51, 0x00020000
    s_mov_b32 s42, 1605632
    s_mov_b32 s43, 0x00020000
    s_mov_b32 s58, 1605632
    s_mov_b32 s59, 0x00020000
    s_mov_b32 s62, 401408
    s_mov_b32 s63, 0x00020000
    s_mov_b32 s66, 1835008
    s_mov_b32 s67, 0x00020000
    v_and_b32_e64 v6, 31, v0
    v_bfe_u32 v7, v0, 1, 3
    v_lshrrev_b32 v17, 5, v0
    v_xor_b32 v7, v7, v17
    v_lshlrev_b32_e64 v7, 4, v7
    v_lshl_add_u32 v6, v6, 7, v7
    v_add_u32 v6, s17, v6
    v_xor_b32 v7, 32, v6
    v_xor_b32_e64 v8, 64, v6
    v_xor_b32 v9, 96, v6
    v_and_b32_e64 v18, 3, v12
    v_lshl_add_u32 v17, v17, 3, v18
    v_bfe_u32 v19, v0, 4, 1
    v_lshl_add_u32 v20, v19, 2, v13
    v_and_b32 v21, 1, v13
    v_lshlrev_b32 v21, 1, v21
    v_lshl_add_u32 v21, v19, 2, v21
    v_lshrrev_b32 v22, 1, v13
    v_add_u32 v21, v21, v22
    v_lshlrev_b32 v21, 3, v21
    v_lshrrev_b32 v18, 1, v18
    v_lshl_add_u32 v10, v18, 6, v21
    v_lshl_add_u32 v10, v17, 7, v10
    v_xor_b32 v11, 64, v10
    s_lshl_b32 s34, s15, 6
    s_lshl_b32 s35, s14, 11
    v_xor_b32 v13, s34, v10
    v_add_u32 v13, s35, v13
    v_add_u32 v12, s25, v20
    v_and_b32 v12, 7, v12
    v_lshlrev_b32 v12, 3, v12
    v_lshl_add_u32 v12, v17, 6, v12
    v_add_u32 v12, 57344, v12
    s_mul_i32 s34, s14, 1024
    s_mul_i32 s35, s15, 4096
    s_add_u32 s34, s34, s35
    v_add_u32 v14, s34, v12
    v_bfe_u32 v19, v0, 2, 1
    v_bfe_u32 v20, v0, 4, 1
    v_xor_b32 v19, v19, v20
    v_and_b32 v20, 3, v0
    v_or_b32 v19, v19, v20
    v_cmp_eq_u32 vcc, 0, v19
    v_mov_b32 v20, 0x3f803f80
    v_and_b32 v19, 31, v0
    v_cndmask_b32 v24, 0, v20, vcc
    v_cmp_eq_u32 vcc, 28, v19
    v_mov_b32 v25, v24
    v_mov_b32 v26, v24
    v_cndmask_b32 v17, 0, v20, vcc
    v_mov_b32 v27, v24
    v_lshlrev_b32 v16, 4, v19
    v_add_u32 v16, 151552, v16
    s_lshl_b32 s34, s14, 2
    s_lshl_b32 s35, s15, 9
    s_add_u32 s34, s34, s35
    v_add_u32 v15, s34, v16
    s_mov_b32 s72, 0
    s_mov_b32 s73, -1
    v_mov_b32 v30, 0
    v_mov_b32 v31, 0
    v_mov_b32 v34, 0
    v_mov_b32 v35, 0
    v_mov_b32_e64 v38, 0
    v_mov_b32 v22, 156672
    v_add_u32_e64 v22, v22, v1
    v_mov_b32 v39, 0
    ds_write_b32 v22, v30
    s_add_u32 s34, s19, 0
    s_lshr_b32 s35, s34, 4
    s_and_b32 s34, s34, 15
    s_lshl_b32 s20, s35, 21
    s_lshl_b32 s34, s34, 17
    s_add_u32 s20, s20, s34
    s_lshl_b32 s34, s8, 11
    s_add_u32 s20, s20, s34
    s_add_u32 s20, s20, 2097152
    s_cmp_eq_u32 s35, 0
    s_cselect_b32 s26, 0x3f80, 0
    s_lshl_b32 s19, s19, 8
    s_lshl_b32 s34, s8, 2
    s_add_u32 s19, s19, s34
    s_add_u32 s19, s19, 18939904
    s_lshl_b32 s18, s7, 12
    s_mul_i32 s34, s8, 114688
    s_add_u32 s18, s18, s34
    s_add_u32 s18, s18, 8388608
    s_cmp_eq_u32 s15, 0
    s_cbranch_scc1 L_x0b9
    s_lshl_b32 s32, s90, 7
    s_add_u32 m0, s17, 0
    s_add_u32 s32, s32, s16
    buffer_load_dwordx4 v2, s[52:55], s32 offen lds
    s_add_u32 m0, s17, 1024
    s_add_u32 s32, s32, 7168
    buffer_load_dwordx4 v3, s[52:55], s32 offen lds
    s_add_u32 m0, s17, 2048
    s_add_u32 s32, s32, 7168
    buffer_load_dwordx4 v2, s[52:55], s32 offen lds
    s_add_u32 m0, s17, 3072
    s_add_u32 s32, s32, 7168
    buffer_load_dwordx4 v3, s[52:55], s32 offen lds
L_x0b9:
    s_mul_i32 s34, s91, 229376
    s_add_u32 m0, s12, 8192
    s_add_u32 s34, s34, s10
    buffer_load_dwordx4 v4, s[36:39], s34 offen lds
    s_mul_i32 s34, s91, 172032
    s_add_u32 m0, s13, 4096
    s_add_u32 s34, s34, s11
    s_mov_b64 exec, s[74:75]
    buffer_load_dwordx4 v5, s[44:47], s34 offen lds
    s_mov_b64 exec, -1
    s_cmp_eq_u32 s15, 0
    s_cbranch_scc1 L_x0b10
    s_waitcnt vmcnt(8) lgkmcnt(0)
    s_branch L_x0c10
L_x0b10:
    s_waitcnt vmcnt(2) lgkmcnt(0)
L_x0c10:
    s_barrier
    s_cmp_eq_u32 s15, 0
    s_cbranch_scc1 L_st11
    s_waitcnt vmcnt(6)
    v_lshlrev_b32 v96, 16, v80
    v_and_b32 v97, 0xffff0000, v80
    v_lshlrev_b32_e64 v98, 16, v81
    v_and_b32 v99, 0xffff0000, v81
    v_lshlrev_b32_e64 v100, 16, v82
    v_and_b32 v101, 0xffff0000, v82
    v_lshlrev_b32_e64 v102, 16, v83
    v_and_b32 v103, 0xffff0000, v83
    v_lshlrev_b32_e64 v104, 16, v84
    v_and_b32 v105, 0xffff0000, v84
    v_lshlrev_b32_e64 v106, 16, v85
    v_and_b32 v107, 0xffff0000, v85
    v_lshlrev_b32_e64 v108, 16, v86
    v_and_b32 v109, 0xffff0000, v86
    v_lshlrev_b32_e64 v110, 16, v87
    v_and_b32 v111, 0xffff0000, v87
    v_add_f32 v128, v96, v97
    v_mul_f32 v129, v96, v96
    v_fmac_f32 v129, v97, v97
    v_add_f32 v128, v128, v98
    v_fmac_f32 v129, v98, v98
    v_add_f32 v128, v128, v99
    v_fmac_f32 v129, v99, v99
    v_add_f32 v128, v128, v100
    v_fmac_f32 v129, v100, v100
    v_add_f32 v128, v128, v101
    v_fmac_f32 v129, v101, v101
    v_add_f32 v128, v128, v102
    v_fmac_f32 v129, v102, v102
    v_add_f32 v128, v128, v103
    v_fmac_f32 v129, v103, v103
    v_add_f32 v128, v128, v104
    v_fmac_f32 v129, v104, v104
    v_add_f32 v128, v128, v105
    v_fmac_f32 v129, v105, v105
    v_add_f32 v128, v128, v106
    v_fmac_f32 v129, v106, v106
    v_add_f32 v128, v128, v107
    v_fmac_f32 v129, v107, v107
    v_add_f32 v128, v128, v108
    v_fmac_f32 v129, v108, v108
    v_add_f32 v128, v128, v109
    v_fmac_f32 v129, v109, v109
    v_add_f32 v128, v128, v110
    v_fmac_f32 v129, v110, v110
    v_add_f32 v128, v128, v111
    v_fmac_f32 v129, v111, v111
    s_nop 0
    v_add_f32_dpp v128, v128, v128 quad_perm:[1,0,3,2] row_mask:0xf bank_mask:0xf
    v_add_f32_dpp v129, v129, v129 quad_perm:[1,0,3,2] row_mask:0xf bank_mask:0xf
    s_nop 0
    v_add_f32_dpp v128, v128, v128 quad_perm:[2,3,0,1] row_mask:0xf bank_mask:0xf
    v_add_f32_dpp v129, v129, v129 quad_perm:[2,3,0,1] row_mask:0xf bank_mask:0xf
    s_nop 0
    v_add_f32_dpp v128, v128, v128 row_half_mirror row_mask:0xf bank_mask:0xf
    v_add_f32_dpp v129, v129, v129 row_half_mirror row_mask:0xf bank_mask:0xf
    s_nop 0
    v_add_f32_dpp v128, v128, v128 row_mirror row_mask:0xf bank_mask:0xf
    v_add_f32_dpp v129, v129, v129 row_mirror row_mask:0xf bank_mask:0xf
    v_mov_b32 v130, v128
    v_mov_b32_e64 v131, v129
    s_mov_b32 s76, 0x3b124925
    v_permlane16_swap_b32 v128, v130
    v_permlane16_swap_b32 v129, v131
    v_add_f32 v128, v128, v130
    v_add_f32 v129, v129, v131
    v_mul_f32 v128, s76, v128
    v_mul_f32 v129, s76, v129
    v_fma_f32 v129, -v128, v128, v129
    v_max_f32_e64 v129, 0, v129
    v_add_f32 v129, 0x3727c5ac, v129
    s_lshl_b32 s98, s98, 4
    s_add_u32 s98, s98, 18874368
L_st11:
    s_waitcnt vmcnt(2)
    ds_read_b128 v[144:147], v6 offset:0
    ds_read_b128 v[148:151], v7 offset:0
    ds_read_b128 v[152:155], v8 offset:0
    ds_read_b128 v[156:159], v9 offset:0
    ds_read_b64_tr_b16 v[40:41], v10 offset:0
    ds_read_b64_tr_b16 v[42:43], v10 offset:512
    ds_read_b64_tr_b16 v[44:45], v11 offset:0
    ds_read_b64_tr_b16 v[46:47], v11 offset:512
    ds_read_b64_tr_b16 v[48:49], v12 offset:0
    ds_read_b64_tr_b16 v[50:51], v12 offset:256
    s_waitcnt lgkmcnt(0)
    v_mfma_f32_32x32x16_bf16 v[80:95], v[40:43], v[144:147], 0
    s_lshl_b32 s32, s91, 7
    s_add_u32 m0, s17, 32768
    s_nop 0
    s_add_u32 s32, s32, s16
    buffer_load_dwordx4 v2, s[52:55], s32 offen lds
    ds_read_b64_tr_b16 v[52:53], v10 offset:2048
    ds_read_b64_tr_b16 v[54:55], v10 offset:2560
    v_mfma_f32_32x32x16_bf16 v[96:111], v[44:47], v[144:147], 0
    s_add_u32 m0, s17, 33792
    s_add_u32 s32, s32, 7168
    buffer_load_dwordx4 v3, s[52:55], s32 offen lds
    ds_read_b64_tr_b16 v[56:57], v11 offset:2048
    ds_read_b64_tr_b16 v[58:59], v11 offset:2560
    v_mfma_f32_32x32x16_bf16 v[112:127], v[48:51], v[144:147], 0
    s_add_u32 m0, s17, 34816
    s_add_u32 s32, s32, 7168
    buffer_load_dwordx4 v2, s[52:55], s32 offen lds
    ds_read_b64_tr_b16 v[60:61], v12 offset:1024
    ds_read_b64_tr_b16 v[62:63], v12 offset:1280
    ds_read_b64_tr_b16 v[72:73], v13 offset:0
    ds_read_b64_tr_b16 v[74:75], v13 offset:512
    s_nop 0
    s_waitcnt lgkmcnt(2)
    v_mfma_f32_32x32x16_bf16 v[80:95], v[52:55], v[148:151], v[80:95]
    s_add_u32 m0, s17, 35840
    s_add_u32 s32, s32, 7168
    buffer_load_dwordx4 v3, s[52:55], s32 offen lds
    ds_read_b64_tr_b16 v[40:41], v10 offset:4096
    ds_read_b64_tr_b16 v[42:43], v10 offset:4608
    v_mfma_f32_32x32x16_bf16 v[96:111], v[56:59], v[148:151], v[96:111]
    s_mul_i32 s34, s92, 229376
    s_add_u32 m0, s12, 16384
    s_add_u32 s34, s34, s10
    buffer_load_dwordx4 v4, s[36:39], s34 offen lds
    s_mul_i32 s34, s92, 172032
    ds_read_b64_tr_b16 v[44:45], v11 offset:4096
    ds_read_b64_tr_b16 v[46:47], v11 offset:4608
    s_waitcnt lgkmcnt(4)
    v_mfma_f32_16x16x32_bf16 v[64:67], v[24:27], v[72:75], 0
    v_mfma_f32_32x32x16_bf16 v[112:127], v[60:63], v[148:151], v[112:127]
    s_add_u32 m0, s13, 8192
    s_add_u32 s34, s34, s11
    s_mov_b64 exec, s[74:75]
    buffer_load_dwordx4 v5, s[44:47], s34 offen lds
    s_nop 0
    s_mov_b64 exec, -1
    ds_read_b64_tr_b16 v[48:49], v12 offset:2048
    ds_read_b64_tr_b16 v[50:51], v12 offset:2304
    s_waitcnt lgkmcnt(0)
    v_mfma_f32_32x32x16_bf16 v[80:95], v[40:43], v[152:155], v[80:95]
    s_lshl_b32 s32, s92, 7
    s_add_u32 m0, s17, 0
    s_add_u32 s32, s32, s16
    buffer_load_dwordx4 v2, s[52:55], s32 offen lds
    s_add_u32 m0, s17, 1024
    s_add_u32 s32, s32, 7168
    buffer_load_dwordx4 v3, s[52:55], s32 offen lds
    s_add_u32 m0, s17, 2048
    s_add_u32 s32, s32, 7168
    buffer_load_dwordx4 v2, s[52:55], s32 offen lds
    s_add_u32 m0, s17, 3072
    s_add_u32 s32, s32, 7168
    buffer_load_dwordx4 v3, s[52:55], s32 offen lds
    ds_read_b64_tr_b16 v[52:53], v10 offset:6144
    ds_read_b64_tr_b16 v[54:55], v10 offset:6656
    v_mfma_f32_32x32x16_bf16 v[96:111], v[44:47], v[152:155], v[96:111]
    ds_read_b64_tr_b16 v[56:57], v11 offset:6144
    ds_read_b64_tr_b16 v[58:59], v11 offset:6656
    v_mfma_f32_32x32x16_bf16 v[112:127], v[48:51], v[152:155], v[112:127]
    ds_read_b64_tr_b16 v[60:61], v12 offset:3072
    ds_read_b64_tr_b16 v[62:63], v12 offset:3328
    s_waitcnt vmcnt(10)
    s_barrier
    s_waitcnt lgkmcnt(0)
    v_mfma_f32_32x32x16_bf16 v[80:95], v[52:55], v[156:159], v[80:95]
    s_waitcnt vmcnt(6)
    ds_read_b128 v[160:163], v6 offset:32768
    ds_read_b128 v[164:167], v7 offset:32768
    v_mfma_f32_32x32x16_bf16 v[96:111], v[56:59], v[156:159], v[96:111]
    ds_read_b128 v[168:171], v8 offset:32768
    ds_read_b128 v[172:175], v9 offset:32768
    ds_read_b64_tr_b16 v[40:41], v10 offset:8192
    ds_read_b64_tr_b16 v[42:43], v10 offset:8704
    v_mfma_f32_32x32x16_bf16 v[112:127], v[60:63], v[156:159], v[112:127]
    s_lshl_b32 s78, s2, 3
    s_add_u32 s78, s78, s5
    v_min_u32 v23, 6, v0
    v_lshlrev_b32 v23, 7, v23
    s_mul_i32 s79, s78, 784
    buffer_load_dword v143, v23, s[40:43], s79 offen
    s_lshr_b32 s79, s78, 2
    s_mul_i32 s79, s79, 3584
    s_and_b32 s78, s78, 3
    s_lshl_b32 s78, s78, 7
    s_add_u32 s79, s79, s78
    s_add_u32 s79, s79, 3072
    buffer_load_dword v143, off, s[36:39], s79
    ds_read_b64_tr_b16 v[44:45], v11 offset:8192
    ds_read_b64_tr_b16 v[46:47], v11 offset:8704
    ds_read_b64_tr_b16 v[48:49], v12 offset:4096
    ds_read_b64_tr_b16 v[50:51], v12 offset:4352
    s_waitcnt lgkmcnt(0)
    v_mfma_f32_32x32x16_bf16 v[80:95], v[40:43], v[160:163], v[80:95]
    s_mul_i32 s34, s93, 229376
    s_add_u32 m0, s12, 24576
    s_add_u32 s34, s34, s10
    buffer_load_dwordx4 v4, s[36:39], s34 offen lds
    s_mul_i32 s34, s93, 172032
    ds_read_b64_tr_b16 v[52:53], v10 offset:10240
    ds_read_b64_tr_b16 v[54:55], v10 offset:10752
    v_mfma_f32_32x32x16_bf16 v[96:111], v[44:47], v[160:163], v[96:111]
    ds_read_b64_tr_b16 v[56:57], v11 offset:10240
    ds_read_b64_tr_b16 v[58:59], v11 offset:10752
    v_mfma_f32_32x32x16_bf16 v[112:127], v[48:51], v[160:163], v[112:127]
    s_add_u32 m0, s13, 12288
    s_add_u32 s34, s34, s11
    s_mov_b64 exec, s[74:75]
    buffer_load_dwordx4 v5, s[44:47], s34 offen lds
    s_mov_b64 exec, -1
    ds_read_b64_tr_b16 v[60:61], v12 offset:5120
    ds_read_b64_tr_b16 v[62:63], v12 offset:5376
    ds_read_b64_tr_b16 v[72:73], v13 offset:8192
    ds_read_b64_tr_b16 v[74:75], v13 offset:8704
    ds_read_b64_tr_b16 v[76:77], v14 offset:0
    ds_read_b64_tr_b16 v[78:79], v14 offset:256
    s_waitcnt lgkmcnt(4)
    v_mfma_f32_32x32x16_bf16 v[80:95], v[52:55], v[164:167], v[80:95]
    buffer_load_dword v138, off, s[68:71], 0 sc1
    ds_read_b64_tr_b16 v[40:41], v10 offset:12288
    ds_read_b64_tr_b16 v[42:43], v10 offset:12800
    v_mfma_f32_32x32x16_bf16 v[96:111], v[56:59], v[164:167], v[96:111]
    s_lshl_b32 s32, s93, 7
    s_add_u32 m0, s17, 32768
    s_add_u32 s32, s32, s16
    buffer_load_dwordx4 v2, s[52:55], s32 offen lds
    s_add_u32 m0, s17, 33792
    s_add_u32 s32, s32, 7168
    buffer_load_dwordx4 v3, s[52:55], s32 offen lds
    s_add_u32 m0, s17, 34816
    s_add_u32 s32, s32, 7168
    buffer_load_dwordx4 v2, s[52:55], s32 offen lds
    s_add_u32 m0, s17, 35840
    s_add_u32 s32, s32, 7168
    buffer_load_dwordx4 v3, s[52:55], s32 offen lds
    ds_read_b64_tr_b16 v[44:45], v11 offset:12288
    ds_read_b64_tr_b16 v[46:47], v11 offset:12800
    s_nop 0
    s_waitcnt lgkmcnt(6)
    v_mfma_f32_16x16x32_bf16 v[64:67], v[24:27], v[72:75], v[64:67]
    v_mfma_f32_32x32x16_bf16 v[112:127], v[60:63], v[164:167], v[112:127]
    ds_read_b64_tr_b16 v[48:49], v12 offset:6144
    ds_read_b64_tr_b16 v[50:51], v12 offset:6400
    s_waitcnt lgkmcnt(6)
    v_mfma_f32_16x16x32_bf16 v[68:71], v[24:27], v[76:79], 0
    s_waitcnt lgkmcnt(0)
    v_mfma_f32_32x32x16_bf16 v[80:95], v[40:43], v[168:171], v[80:95]
    ds_read_b64_tr_b16 v[52:53], v10 offset:14336
    ds_read_b64_tr_b16 v[54:55], v10 offset:14848
    v_mfma_f32_32x32x16_bf16 v[96:111], v[44:47], v[168:171], v[96:111]
    ds_read_b64_tr_b16 v[56:57], v11 offset:14336
    ds_read_b64_tr_b16 v[58:59], v11 offset:14848
    v_mfma_f32_32x32x16_bf16 v[112:127], v[48:51], v[168:171], v[112:127]
    ds_read_b64_tr_b16 v[60:61], v12 offset:7168
    ds_read_b64_tr_b16 v[62:63], v12 offset:7424
    s_waitcnt vmcnt(13)
    s_barrier
    s_waitcnt lgkmcnt(0)
    v_mfma_f32_32x32x16_bf16 v[80:95], v[52:55], v[172:175], v[80:95]
    s_waitcnt vmcnt(9)
    ds_read_b128 v[176:179], v6 offset:0
    ds_read_b128 v[180:183], v7 offset:0
    v_mfma_f32_32x32x16_bf16 v[96:111], v[56:59], v[172:175], v[96:111]
    ds_read_b128 v[184:187], v8 offset:0
    ds_read_b128 v[188:191], v9 offset:0
    ds_read_b64_tr_b16 v[40:41], v10 offset:16384
    ds_read_b64_tr_b16 v[42:43], v10 offset:16896
    v_mfma_f32_32x32x16_bf16 v[112:127], v[60:63], v[172:175], v[112:127]
    ds_read_b64_tr_b16 v[44:45], v11 offset:16384
    ds_read_b64_tr_b16 v[46:47], v11 offset:16896
    ds_read_b64_tr_b16 v[48:49], v12 offset:8192
    ds_read_b64_tr_b16 v[50:51], v12 offset:8448
    s_waitcnt lgkmcnt(0)
    v_mfma_f32_32x32x16_bf16 v[80:95], v[40:43], v[176:179], v[80:95]
    s_mul_i32 s34, s94, 229376
    s_add_u32 m0, s12, 32768
    s_add_u32 s34, s34, s10
    buffer_load_dwordx4 v4, s[36:39], s34 offen lds
    s_mul_i32 s34, s94, 172032
    ds_read_b64_tr_b16 v[52:53], v10 offset:18432
    ds_read_b64_tr_b16 v[54:55], v10 offset:18944
    v_mfma_f32_32x32x16_bf16 v[96:111], v[44:47], v[176:179], v[96:111]
    ds_read_b64_tr_b16 v[56:57], v11 offset:18432
    ds_read_b64_tr_b16 v[58:59], v11 offset:18944
    v_mfma_f32_32x32x16_bf16 v[112:127], v[48:51], v[176:179], v[112:127]
    s_add_u32 m0, s13, 16384
    s_add_u32 s34, s34, s11
    s_mov_b64 exec, s[74:75]
    buffer_load_dwordx4 v5, s[44:47], s34 offen lds
    s_mov_b64 exec, -1
    ds_read_b64_tr_b16 v[60:61], v12 offset:9216
    ds_read_b64_tr_b16 v[62:63], v12 offset:9472
    ds_read_b64_tr_b16 v[72:73], v13 offset:16384
    ds_read_b64_tr_b16 v[74:75], v13 offset:16896
    s_waitcnt lgkmcnt(2)
    v_mfma_f32_32x32x16_bf16 v[80:95], v[52:55], v[180:183], v[80:95]
    ds_read_b64_tr_b16 v[40:41], v10 offset:20480
    ds_read_b64_tr_b16 v[42:43], v10 offset:20992
    v_mfma_f32_32x32x16_bf16 v[96:111], v[56:59], v[180:183], v[96:111]
    s_lshl_b32 s32, s94, 7
    s_add_u32 m0, s17, 0
    s_nop 0
    s_add_u32 s32, s32, s16
    buffer_load_dwordx4 v2, s[52:55], s32 offen lds
    s_add_u32 m0, s17, 1024
    s_add_u32 s32, s32, 7168
    buffer_load_dwordx4 v3, s[52:55], s32 offen lds
    s_add_u32 m0, s17, 2048
    s_add_u32 s32, s32, 7168
    buffer_load_dwordx4 v2, s[52:55], s32 offen lds
    s_add_u32 m0, s17, 3072
    s_add_u32 s32, s32, 7168
    buffer_load_dwordx4 v3, s[52:55], s32 offen lds
    ds_read_b64_tr_b16 v[44:45], v11 offset:20480
    ds_read_b64_tr_b16 v[46:47], v11 offset:20992
    s_waitcnt lgkmcnt(4)
    v_mfma_f32_16x16x32_bf16 v[64:67], v[24:27], v[72:75], v[64:67]
    v_mfma_f32_32x32x16_bf16 v[112:127], v[60:63], v[180:183], v[112:127]
    s_waitcnt vmcnt(10)
    v_readfirstlane_b32 s97, v138
    s_nop 0
    s_cmp_lg_u32 s97, 0
    s_cbranch_scc1 L_nok12
    s_mov_b32 s76, 200000
L_nlp12:
    s_sleep 1
    buffer_load_dword v138, off, s[68:71], 0 sc1
    s_waitcnt vmcnt(0)
    v_readfirstlane_b32 s97, v138
    s_nop 0
    s_cmp_lg_u32 s97, 0
    s_cbranch_scc1 L_nok12
    s_sub_u32 s76, s76, 1
    s_cbranch_scc0 L_nlp12
L_nok12:
    s_cmp_eq_u32 s15, 0
    s_cbranch_scc1 L_nos12
    v_lshrrev_b32 v136, 5, v0
    v_lshlrev_b32 v136, 4, v136
    v_mov_b32_e64 v130, s97
    v_mov_b32 v131, s97
    buffer_store_dwordx4 v[128:131], v136, s[48:51], s98 offen sc1
L_nos12:
    ds_read_b64_tr_b16 v[48:49], v12 offset:10240
    ds_read_b64_tr_b16 v[50:51], v12 offset:10496
    s_waitcnt lgkmcnt(0)
    v_mfma_f32_32x32x16_bf16 v[80:95], v[40:43], v[184:187], v[80:95]
    ds_read_b64_tr_b16 v[52:53], v10 offset:22528
    ds_read_b64_tr_b16 v[54:55], v10 offset:23040
    v_mfma_f32_32x32x16_bf16 v[96:111], v[44:47], v[184:187], v[96:111]
    ds_read_b64_tr_b16 v[56:57], v11 offset:22528
    ds_read_b64_tr_b16 v[58:59], v11 offset:23040
    v_mfma_f32_32x32x16_bf16 v[112:127], v[48:51], v[184:187], v[112:127]
    ds_read_b64_tr_b16 v[60:61], v12 offset:11264
    ds_read_b64_tr_b16 v[62:63], v12 offset:11520
    s_barrier
    s_waitcnt lgkmcnt(0)
    v_mfma_f32_32x32x16_bf16 v[80:95], v[52:55], v[188:191], v[80:95]
    s_nop 0
    s_waitcnt vmcnt(6)
    ds_read_b128 v[192:195], v6 offset:32768
    ds_read_b128 v[196:199], v7 offset:32768
    v_mfma_f32_32x32x16_bf16 v[96:111], v[56:59], v[188:191], v[96:111]
    ds_read_b128 v[200:203], v8 offset:32768
    ds_read_b128 v[204:207], v9 offset:32768
    ds_read_b64_tr_b16 v[40:41], v10 offset:24576
    ds_read_b64_tr_b16 v[42:43], v10 offset:25088
    v_mfma_f32_32x32x16_bf16 v[112:127], v[60:63], v[188:191], v[112:127]
    ds_read_b64_tr_b16 v[44:45], v11 offset:24576
    ds_read_b64_tr_b16 v[46:47], v11 offset:25088
    ds_read_b64_tr_b16 v[48:49], v12 offset:12288
    ds_read_b64_tr_b16 v[50:51], v12 offset:12544
    s_waitcnt lgkmcnt(0)
    v_mfma_f32_32x32x16_bf16 v[80:95], v[40:43], v[192:195], v[80:95]
    s_mul_i32 s34, s95, 229376
    s_add_u32 m0, s12, 40960
    s_add_u32 s34, s34, s10
    buffer_load_dwordx4 v4, s[36:39], s34 offen lds
    s_mul_i32 s34, s95, 172032
    ds_read_b64_tr_b16 v[52:53], v10 offset:26624
    ds_read_b64_tr_b16 v[54:55], v10 offset:27136
    v_mfma_f32_32x32x16_bf16 v[96:111], v[44:47], v[192:195], v[96:111]
    ds_read_b64_tr_b16 v[56:57], v11 offset:26624
    ds_read_b64_tr_b16 v[58:59], v11 offset:27136
    v_mfma_f32_32x32x16_bf16 v[112:127], v[48:51], v[192:195], v[112:127]
    s_add_u32 m0, s13, 20480
    s_add_u32 s34, s34, s11
    s_mov_b64 exec, s[74:75]
    buffer_load_dwordx4 v5, s[44:47], s34 offen lds
    s_mov_b64 exec, -1
    ds_read_b64_tr_b16 v[60:61], v12 offset:13312
    ds_read_b64_tr_b16 v[62:63], v12 offset:13568
    ds_read_b64_tr_b16 v[72:73], v13 offset:24576
    ds_read_b64_tr_b16 v[74:75], v13 offset:25088
    ds_read_b64_tr_b16 v[76:77], v14 offset:8192
    ds_read_b64_tr_b16 v[78:79], v14 offset:8448
    s_waitcnt lgkmcnt(4)
    v_mfma_f32_32x32x16_bf16 v[80:95], v[52:55], v[196:199], v[80:95]
    ds_read_b64_tr_b16 v[40:41], v10 offset:28672
    ds_read_b64_tr_b16 v[42:43], v10 offset:29184
    v_mfma_f32_32x32x16_bf16 v[96:111], v[56:59], v[196:199], v[96:111]
    s_lshl_b32 s32, s95, 7
    s_add_u32 m0, s17, 32768
    s_add_u32 s32, s32, s16
    buffer_load_dwordx4 v2, s[52:55], s32 offen lds
    s_add_u32 m0, s17, 33792
    s_add_u32 s32, s32, 7168
    buffer_load_dwordx4 v3, s[52:55], s32 offen lds
    s_add_u32 m0, s17, 34816
    s_add_u32 s32, s32, 7168
    buffer_load_dwordx4 v2, s[52:55], s32 offen lds
    s_add_u32 m0, s17, 35840
    s_add_u32 s32, s32, 7168
    buffer_load_dwordx4 v3, s[52:55], s32 offen lds
    ds_read_b64_tr_b16 v[44:45], v11 offset:28672
    ds_read_b64_tr_b16 v[46:47], v11 offset:29184
    s_nop 0
    s_waitcnt lgkmcnt(6)
    v_mfma_f32_16x16x32_bf16 v[64:67], v[24:27], v[72:75], v[64:67]
    v_mfma_f32_32x32x16_bf16 v[112:127], v[60:63], v[196:199], v[112:127]
    ds_read_b64_tr_b16 v[48:49], v12 offset:14336
    ds_read_b64_tr_b16 v[50:51], v12 offset:14592
    s_waitcnt lgkmcnt(6)
    v_mfma_f32_16x16x32_bf16 v[68:71], v[24:27], v[76:79], v[68:71]
    s_waitcnt lgkmcnt(0)
    v_mfma_f32_32x32x16_bf16 v[80:95], v[40:43], v[200:203], v[80:95]
    ds_read_b64_tr_b16 v[52:53], v10 offset:30720
    ds_read_b64_tr_b16 v[54:55], v10 offset:31232
    v_mfma_f32_32x32x16_bf16 v[96:111], v[44:47], v[200:203], v[96:111]
    ds_read_b64_tr_b16 v[56:57], v11 offset:30720
    ds_read_b64_tr_b16 v[58:59], v11 offset:31232
    v_mfma_f32_32x32x16_bf16 v[112:127], v[48:51], v[200:203], v[112:127]
    ds_read_b64_tr_b16 v[60:61], v12 offset:15360
    ds_read_b64_tr_b16 v[62:63], v12 offset:15616
    s_waitcnt vmcnt(10)
    s_barrier
    s_waitcnt lgkmcnt(0)
    v_mfma_f32_32x32x16_bf16 v[80:95], v[52:55], v[204:207], v[80:95]
    s_waitcnt vmcnt(6)
    ds_read_b128 v[208:211], v6 offset:0
    ds_read_b128 v[212:215], v7 offset:0
    v_mfma_f32_32x32x16_bf16 v[96:111], v[56:59], v[204:207], v[96:111]
    ds_read_b128 v[216:219], v8 offset:0
    ds_read_b128 v[220:223], v9 offset:0
    ds_read_b64_tr_b16 v[40:41], v10 offset:32768
    ds_read_b64_tr_b16 v[42:43], v10 offset:33280
    v_mfma_f32_32x32x16_bf16 v[112:127], v[60:63], v[204:207], v[112:127]
    ds_read_b64_tr_b16 v[44:45], v11 offset:32768
    ds_read_b64_tr_b16 v[46:47], v11 offset:33280
    ds_read_b64_tr_b16 v[48:49], v12 offset:16384
    ds_read_b64_tr_b16 v[50:51], v12 offset:16640
    s_waitcnt lgkmcnt(0)
    v_mfma_f32_32x32x16_bf16 v[80:95], v[40:43], v[208:211], v[80:95]
    s_mul_i32 s34, s96, 229376
    s_add_u32 m0, s12, 49152
    s_add_u32 s34, s34, s10
    buffer_load_dwordx4 v4, s[36:39], s34 offen lds
    s_mul_i32 s34, s96, 172032
    ds_read_b64_tr_b16 v[52:53], v10 offset:34816
    ds_read_b64_tr_b16 v[54:55], v10 offset:35328
    v_mfma_f32_32x32x16_bf16 v[96:111], v[44:47], v[208:211], v[96:111]
    ds_read_b64_tr_b16 v[56:57], v11 offset:34816
    ds_read_b64_tr_b16 v[58:59], v11 offset:35328
    v_mfma_f32_32x32x16_bf16 v[112:127], v[48:51], v[208:211], v[112:127]
    s_add_u32 m0, s13, 24576
    s_add_u32 s34, s34, s11
    s_mov_b64 exec, s[74:75]
    buffer_load_dwordx4 v5, s[44:47], s34 offen lds
    s_mov_b64 exec, -1
    ds_read_b64_tr_b16 v[60:61], v12 offset:17408
    ds_read_b64_tr_b16 v[62:63], v12 offset:17664
    ds_read_b64_tr_b16 v[72:73], v13 offset:32768
    ds_read_b64_tr_b16 v[74:75], v13 offset:33280
    s_waitcnt lgkmcnt(2)
    v_mfma_f32_32x32x16_bf16 v[80:95], v[52:55], v[212:215], v[80:95]
    ds_read_b64_tr_b16 v[40:41], v10 offset:36864
    ds_read_b64_tr_b16 v[42:43], v10 offset:37376
    v_mfma_f32_32x32x16_bf16 v[96:111], v[56:59], v[212:215], v[96:111]
    s_lshl_b32 s32, s96, 7
    s_add_u32 m0, s17, 0
    s_nop 0
    s_add_u32 s32, s32, s16
    buffer_load_dwordx4 v2, s[52:55], s32 offen lds
    s_add_u32 m0, s17, 1024
    s_add_u32 s32, s32, 7168
    buffer_load_dwordx4 v3, s[52:55], s32 offen lds
    s_add_u32 m0, s17, 2048
    s_add_u32 s32, s32, 7168
    buffer_load_dwordx4 v2, s[52:55], s32 offen lds
    s_add_u32 m0, s17, 3072
    s_add_u32 s32, s32, 7168
    buffer_load_dwordx4 v3, s[52:55], s32 offen lds
    ds_read_b64_tr_b16 v[44:45], v11 offset:36864
    ds_read_b64_tr_b16 v[46:47], v11 offset:37376
    s_waitcnt lgkmcnt(4)
    v_mfma_f32_16x16x32_bf16 v[64:67], v[24:27], v[72:75], v[64:67]
    v_mfma_f32_32x32x16_bf16 v[112:127], v[60:63], v[212:215], v[112:127]
    ds_read_b64_tr_b16 v[48:49], v12 offset:18432
    ds_read_b64_tr_b16 v[50:51], v12 offset:18688
    s_waitcnt lgkmcnt(0)
    v_mfma_f32_32x32x16_bf16 v[80:95], v[40:43], v[216:219], v[80:95]
    ds_read_b64_tr_b16 v[52:53], v10 offset:38912
    ds_read_b64_tr_b16 v[54:55], v10 offset:39424
    v_mfma_f32_32x32x16_bf16 v[96:111], v[44:47], v[216:219], v[96:111]
    v_mov_b32 v5, 156672
    ds_read_b64_tr_b16 v[56:57], v11 offset:38912
    ds_read_b64_tr_b16 v[58:59], v11 offset:39424
    v_mfma_f32_32x32x16_bf16 v[112:127], v[48:51], v[216:219], v[112:127]
    s_mul_i32 s34, s90, 229376
    s_add_u32 m0, s12, 0
    s_add_u32 s34, s34, s10
    buffer_load_dwordx4 v4, s[40:43], s34 offen lds
    ds_read_b64_tr_b16 v[60:61], v12 offset:19456
    ds_read_b64_tr_b16 v[62:63], v12 offset:19712
    s_waitcnt vmcnt(11)
    s_barrier
    s_waitcnt lgkmcnt(0)
    v_mfma_f32_32x32x16_bf16 v[80:95], v[52:55], v[220:223], v[80:95]
    s_waitcnt vmcnt(7)
    ds_read_b128 v[224:227], v6 offset:32768
    ds_read_b128 v[228:231], v7 offset:32768
    v_mfma_f32_32x32x16_bf16 v[96:111], v[56:59], v[220:223], v[96:111]
    s_mul_i32 s34, s91, 229376
    s_add_u32 m0, s12, 8192
    s_nop 0
    s_add_u32 s34, s34, s10
    buffer_load_dwordx4 v4, s[40:43], s34 offen lds
    ds_read_b128 v[232:235], v8 offset:32768
    ds_read_b128 v[236:239], v9 offset:32768
    ds_read_b64_tr_b16 v[40:41], v10 offset:40960
    ds_read_b64_tr_b16 v[42:43], v10 offset:41472
    v_mfma_f32_32x32x16_bf16 v[112:127], v[60:63], v[220:223], v[112:127]
    v_and_b32_e64 v22, 31, v0
    v_lshlrev_b32 v22, 4, v22
    s_lshl_b32 s99, s8, 9
    s_add_u32 s99, s99, 18874368
    buffer_load_dwordx4 v[18:21], v22, s[48:51], s99 offen sc1
    ds_read_b64_tr_b16 v[44:45], v11 offset:40960
    ds_read_b64_tr_b16 v[46:47], v11 offset:41472
    ds_read_b64_tr_b16 v[48:49], v12 offset:20480
    ds_read_b64_tr_b16 v[50:51], v12 offset:20736
    s_waitcnt lgkmcnt(0)
    v_mfma_f32_32x32x16_bf16 v[80:95], v[40:43], v[224:227], v[80:95]
    s_mul_i32 s34, s92, 229376
    s_add_u32 m0, s12, 16384
    s_add_u32 s34, s34, s10
    buffer_load_dwordx4 v4, s[40:43], s34 offen lds
    ds_read_b64_tr_b16 v[52:53], v10 offset:43008
    ds_read_b64_tr_b16 v[54:55], v10 offset:43520
    v_mfma_f32_32x32x16_bf16 v[96:111], v[44:47], v[224:227], v[96:111]
    ds_read_b64_tr_b16 v[56:57], v11 offset:43008
    ds_read_b64_tr_b16 v[58:59], v11 offset:43520
    v_mfma_f32_32x32x16_bf16 v[112:127], v[48:51], v[224:227], v[112:127]
    s_mul_i32 s34, s93, 229376
    s_add_u32 m0, s12, 24576
    s_add_u32 s34, s34, s10
    buffer_load_dwordx4 v4, s[40:43], s34 offen lds
    ds_read_b64_tr_b16 v[60:61], v12 offset:21504
    ds_read_b64_tr_b16 v[62:63], v12 offset:21760
    ds_read_b64_tr_b16 v[72:73], v13 offset:40960
    ds_read_b64_tr_b16 v[74:75], v13 offset:41472
    ds_read_b64_tr_b16 v[76:77], v14 offset:16384
    ds_read_b64_tr_b16 v[78:79], v14 offset:16640
    s_waitcnt lgkmcnt(4)
    v_mfma_f32_32x32x16_bf16 v[80:95], v[52:55], v[228:231], v[80:95]
    ds_read_b64_tr_b16 v[40:41], v10 offset:45056
    ds_read_b64_tr_b16 v[42:43], v10 offset:45568
    v_mfma_f32_32x32x16_bf16 v[96:111], v[56:59], v[228:231], v[96:111]
    s_mul_i32 s34, s94, 229376
    s_add_u32 m0, s12, 57344
    s_add_u32 s34, s34, s10
    buffer_load_dwordx4 v4, s[40:43], s34 offen lds
    ds_read_b64_tr_b16 v[44:45], v11 offset:45056
    ds_read_b64_tr_b16 v[46:47], v11 offset:45568
    s_waitcnt lgkmcnt(6)
    v_mfma_f32_16x16x32_bf16 v[64:67], v[24:27], v[72:75], v[64:67]
    v_mfma_f32_32x32x16_bf16 v[112:127], v[60:63], v[228:231], v[112:127]
    ds_read_b64_tr_b16 v[48:49], v12 offset:22528
    ds_read_b64_tr_b16 v[50:51], v12 offset:22784
    s_waitcnt lgkmcnt(6)
    v_mfma_f32_16x16x32_bf16 v[68:71], v[24:27], v[76:79], v[68:71]
    s_waitcnt lgkmcnt(0)
    v_mfma_f32_32x32x16_bf16 v[80:95], v[40:43], v[232:235], v[80:95]
    s_mul_i32 s34, s95, 229376
    s_add_u32 m0, s12, 65536
    s_nop 0
    s_add_u32 s34, s34, s10
    buffer_load_dwordx4 v4, s[40:43], s34 offen lds
    ds_read_b64_tr_b16 v[52:53], v10 offset:47104
    ds_read_b64_tr_b16 v[54:55], v10 offset:47616
    v_mfma_f32_32x32x16_bf16 v[96:111], v[44:47], v[232:235], v[96:111]
    ds_read_b64_tr_b16 v[56:57], v11 offset:47104
    ds_read_b64_tr_b16 v[58:59], v11 offset:47616
    v_mfma_f32_32x32x16_bf16 v[112:127], v[48:51], v[232:235], v[112:127]
    s_mul_i32 s34, s96, 229376
    s_add_u32 m0, s12, 32768
    s_nop 0
    s_add_u32 s34, s34, s10
    buffer_load_dwordx4 v4, s[40:43], s34 offen lds
    ds_read_b64_tr_b16 v[60:61], v12 offset:23552
    ds_read_b64_tr_b16 v[62:63], v12 offset:23808
    s_waitcnt vmcnt(12)
    s_barrier
    s_waitcnt lgkmcnt(0)
    v_mfma_f32_32x32x16_bf16 v[80:95], v[52:55], v[236:239], v[80:95]
    s_waitcnt vmcnt(8)
    ds_read_b128 v[240:243], v6 offset:0
    ds_read_b128 v[244:247], v7 offset:0
    v_mfma_f32_32x32x16_bf16 v[96:111], v[56:59], v[236:239], v[96:111]
    ds_read_b128 v[248:251], v8 offset:0
    ds_read_b128 v[252:255], v9 offset:0
    ds_read_b64_tr_b16 v[40:41], v10 offset:49152
    ds_read_b64_tr_b16 v[42:43], v10 offset:49664
    v_mfma_f32_32x32x16_bf16 v[112:127], v[60:63], v[236:239], v[112:127]
    ds_read_b64_tr_b16 v[44:45], v11 offset:49152
    ds_read_b64_tr_b16 v[46:47], v11 offset:49664
    ds_read_b64_tr_b16 v[48:49], v12 offset:24576
    ds_read_b64_tr_b16 v[50:51], v12 offset:24832
    s_waitcnt lgkmcnt(0)
    v_mfma_f32_32x32x16_bf16 v[80:95], v[40:43], v[240:243], v[80:95]
    s_waitcnt vmcnt(5)
    ds_read_b64_tr_b16 v[52:53], v10 offset:51200
    ds_read_b64_tr_b16 v[54:55], v10 offset:51712
    v_mfma_f32_32x32x16_bf16 v[96:111], v[44:47], v[240:243], v[96:111]
    v_cmp_ne_u32 vcc, s97, v20
    s_cbranch_vccz L_ok13
    s_mov_b32 s76, 200000
L_lp13:
    s_sleep 6
    buffer_load_dwordx4 v[18:21], v22, s[48:51], s99 offen sc1
    s_waitcnt vmcnt(0)
    v_cmp_ne_u32 vcc, s97, v20
    s_cbranch_vccz L_ok13
    s_sub_u32 s76, s76, 1
    s_cbranch_scc0 L_lp13
L_ok13:
    v_rsq_f32_e64 v22, v19
    ds_read_b64_tr_b16 v[56:57], v11 offset:51200
    ds_read_b64_tr_b16 v[58:59], v11 offset:51712
    v_mfma_f32_32x32x16_bf16 v[112:127], v[48:51], v[240:243], v[112:127]
    v_cvt_pk_bf16_f32 v28, -v18, -v18
    v_and_b32 v23, 0xffff0000, v28
    ds_read_b64_tr_b16 v[60:61], v12 offset:25600
    ds_read_b64_tr_b16 v[62:63], v12 offset:25856
    ds_read_b64_tr_b16 v[72:73], v13 offset:49152
    ds_read_b64_tr_b16 v[74:75], v13 offset:49664
    ds_read_b64_tr_b16 v[76:77], v14 offset:24576
    ds_read_b64_tr_b16 v[78:79], v14 offset:24832
    s_nop 0
    s_waitcnt lgkmcnt(4)
    v_mfma_f32_32x32x16_bf16 v[80:95], v[52:55], v[244:247], v[80:95]
    v_sub_f32 v23, -v18, v23
    v_cvt_pk_bf16_f32 v29, v23, v23
    ds_read_b64_tr_b16 v[40:41], v10 offset:53248
    ds_read_b64_tr_b16 v[42:43], v10 offset:53760
    v_mfma_f32_32x32x16_bf16 v[96:111], v[56:59], v[244:247], v[96:111]
    s_lshl_b32 s78, s2, 3
    s_add_u32 s78, s78, s5
    v_min_u32 v7, 6, v0
    v_lshlrev_b32 v7, 7, v7
    s_mul_i32 s79, s78, 784
    buffer_load_dword v6, v7, s[56:59], s79 offen
    s_mul_i32 s79, s78, 196
    v_min_u32 v7, 128, v7
    buffer_load_dword v6, v7, s[60:63], s79 offen
    v_cndmask_b32 v28, v28, 0, s[72:73]
    v_cndmask_b32 v29, v29, 0, s[72:73]
    ds_read_b64_tr_b16 v[44:45], v11 offset:53248
    ds_read_b64_tr_b16 v[46:47], v11 offset:53760
    s_waitcnt lgkmcnt(6)
    v_mfma_f32_16x16x32_bf16 v[64:67], v[24:27], v[72:75], v[64:67]
    v_mfma_f32_32x32x16_bf16 v[112:127], v[60:63], v[244:247], v[112:127]
    v_mov_b32 v18, v22
    v_mul_f32 v20, 0xc0135761, v22
    ds_read_b64_tr_b16 v[48:49], v12 offset:26624
    ds_read_b64_tr_b16 v[50:51], v12 offset:26880
    s_waitcnt lgkmcnt(6)
    s_cmp_lg_u32 s15, 0
    s_cbranch_scc1 L_sk14
    v_mfma_f32_16x16x32_bf16 v[68:71], v[24:27], v[76:79], v[68:71]
L_sk14:
    s_waitcnt lgkmcnt(0)
    v_mfma_f32_32x32x16_bf16 v[80:95], v[40:43], v[248:251], v[80:95]
    v_mul_f32 v21, 0xbdd2d3e8, v22
    v_mul_f32_e64 v23, v22, v22
    ds_read_b64_tr_b16 v[52:53], v10 offset:55296
    ds_read_b64_tr_b16 v[54:55], v10 offset:55808
    v_mfma_f32_32x32x16_bf16 v[96:111], v[44:47], v[248:251], v[96:111]
    v_mul_f32 v21, v21, v23
    v_mov_b32 v9, 1
    ds_read_b64_tr_b16 v[56:57], v11 offset:55296
    ds_read_b64_tr_b16 v[58:59], v11 offset:55808
    v_mfma_f32_32x32x16_bf16 v[112:127], v[48:51], v[248:251], v[112:127]
    ds_read_b64_tr_b16 v[60:61], v12 offset:27648
    ds_read_b64_tr_b16 v[62:63], v12 offset:27904
    ds_write_b32 v15, v64
    ds_write_b32 v15, v68 offset:1024
    s_waitcnt lgkmcnt(2)
    v_mfma_f32_32x32x16_bf16 v[112:127], v[60:63], v[252:255], v[112:127]
    v_add_u32 v12, 57344, v10
    v_add_u32 v14, 57344, v11
    v_add_u32 v7, 57344, v13
    s_waitcnt vmcnt(2) lgkmcnt(0)
    s_barrier
    s_setprio 2
    s_cmp_lg_u32 s15, 0
    s_cbranch_scc1 L_p1g_A2
    ds_read_b128 v[72:75], v16 offset:1024
    ds_read_b128 v[76:79], v16 offset:1536
    ds_read_b64_tr_b16 v[40:41], v11 offset:0
    ds_read_b64_tr_b16 v[42:43], v11 offset:512
    ds_read_b64_tr_b16 v[44:45], v11 offset:2048
    ds_read_b64_tr_b16 v[46:47], v11 offset:2560
    ds_read_b64_tr_b16 v[48:49], v11 offset:4096
    ds_read_b64_tr_b16 v[50:51], v11 offset:4608
    v_mfma_f32_32x32x16_bf16 v[80:95], v[52:55], v[252:255], v[80:95]
    v_mfma_f32_32x32x16_bf16 v[96:111], v[56:59], v[252:255], v[96:111]
    ds_read_b64_tr_b16 v[52:53], v11 offset:6144
    ds_read_b64_tr_b16 v[54:55], v11 offset:6656
    s_waitcnt lgkmcnt(6)
    v_mfma_f32_32x32x16_bf16 v[128:143], v[40:43], v[144:147], 0
    v_add_f32 v72, v72, v76
    v_add_f32 v73, v73, v77
    v_add_f32 v74, v74, v78
    v_add_f32_e64 v75, v75, v79
    ds_read_b64_tr_b16 v[56:57], v11 offset:8192
    ds_read_b64_tr_b16 v[58:59], v11 offset:8704
    ds_read_b64_tr_b16 v[60:61], v13 offset:0
    ds_read_b64_tr_b16 v[62:63], v13 offset:512
    s_waitcnt lgkmcnt(8)
    v_mfma_f32_32x32x16_bf16 v[128:143], v[44:47], v[148:151], v[128:143]
    v_add_f32 v72, v72, v73
    v_add_f32 v74, v74, v75
    v_add_f32 v72, v72, v74
    v_cvt_pk_bf16_f32 v73, v72, v72
    v_and_b32 v73, 0xffff0000, v73
    v_sub_f32 v73, v72, v73
    ds_read_b64_tr_b16 v[40:41], v11 offset:10240
    ds_read_b64_tr_b16 v[42:43], v11 offset:10752
    s_waitcnt lgkmcnt(8)
    v_mfma_f32_32x32x16_bf16 v[128:143], v[48:51], v[152:155], v[128:143]
    v_cvt_pk_bf16_f32 v32, v72, v73
    v_cvt_pk_bf16_f32 v33, v72, v73
    ds_read_b128 v[72:75], v16 offset:0
    ds_read_b128 v[76:79], v16 offset:512
    v_mfma_f32_32x32x16_bf16 v[112:127], v[32:35], v[28:31], v[112:127]
    s_nop 0
    s_waitcnt lgkmcnt(4)
    v_mfma_f32_16x16x32_bf16 v[64:67], v[24:27], v[60:63], 0
    ds_read_b64_tr_b16 v[44:45], v11 offset:12288
    ds_read_b64_tr_b16 v[46:47], v11 offset:12800
    ds_read_b64_tr_b16 v[60:61], v13 offset:8192
    ds_read_b64_tr_b16 v[62:63], v13 offset:8704
    v_mfma_f32_32x32x16_bf16 v[128:143], v[52:55], v[156:159], v[128:143]
    s_waitcnt lgkmcnt(5)
    v_add_f32 v72, v72, v73
    v_add_f32 v74, v74, v75
    v_add_f32 v72, v72, v74
    v_cvt_pk_bf16_f32 v73, v72, v72
    v_and_b32 v73, 0xffff0000, v73
    ds_read_b64_tr_b16 v[48:49], v11 offset:14336
    ds_read_b64_tr_b16 v[50:51], v11 offset:14848
    v_mfma_f32_32x32x16_bf16 v[128:143], v[56:59], v[160:163], v[128:143]
    v_sub_f32_e64 v73, v72, v73
    v_cvt_pk_bf16_f32 v36, v72, v73
    v_cvt_pk_bf16_f32 v37, v72, v73
    s_nop 1
    v_mfma_f32_32x32x16_bf16 v[80:95], v[36:39], v[28:31], v[80:95]
    s_waitcnt lgkmcnt(2)
    v_mfma_f32_16x16x32_bf16 v[64:67], v[24:27], v[60:63], v[64:67]
    ds_read_b64_tr_b16 v[52:53], v11 offset:16384
    ds_read_b64_tr_b16 v[54:55], v11 offset:16896
    ds_read_b64_tr_b16 v[60:61], v13 offset:16384
    ds_read_b64_tr_b16 v[62:63], v13 offset:16896
    v_mfma_f32_32x32x16_bf16 v[128:143], v[40:43], v[164:167], v[128:143]
    v_add_f32 v76, v76, v77
    v_add_f32 v78, v78, v79
    v_add_f32_e64 v76, v76, v78
    v_cvt_pk_bf16_f32 v77, v76, v76
    v_and_b32 v77, 0xffff0000, v77
    v_sub_f32_e64 v77, v76, v77
    ds_read_b64_tr_b16 v[56:57], v11 offset:18432
    ds_read_b64_tr_b16 v[58:59], v11 offset:18944
    v_mfma_f32_32x32x16_bf16 v[128:143], v[44:47], v[168:171], v[128:143]
    v_cvt_pk_bf16_f32 v32, v76, v77
    v_cvt_pk_bf16_f32 v33, v76, v77
    s_nop 1
    v_mfma_f32_32x32x16_bf16 v[96:111], v[32:35], v[28:31], v[96:111]
    v_mul_f32 v112, v112, v18
    v_mul_f32 v113, v113, v18
    s_waitcnt lgkmcnt(2)
    v_mfma_f32_16x16x32_bf16 v[64:67], v[24:27], v[60:63], v[64:67]
    ds_read_b64_tr_b16 v[40:41], v11 offset:20480
    ds_read_b64_tr_b16 v[42:43], v11 offset:20992
    ds_read_b64_tr_b16 v[60:61], v13 offset:24576
    ds_read_b64_tr_b16 v[62:63], v13 offset:25088
    v_mfma_f32_32x32x16_bf16 v[128:143], v[48:51], v[172:175], v[128:143]
    v_mul_f32 v114, v114, v18
    v_mul_f32 v115, v115, v18
    v_mul_f32 v116, v116, v18
    v_mul_f32 v117, v117, v18
    v_mul_f32 v118, v118, v18
    v_mul_f32 v119, v119, v18
    ds_read_b64_tr_b16 v[44:45], v11 offset:22528
    ds_read_b64_tr_b16 v[46:47], v11 offset:23040
    v_mfma_f32_32x32x16_bf16 v[128:143], v[52:55], v[176:179], v[128:143]
    v_mul_f32 v120, v120, v18
    v_mul_f32 v121, v121, v18
    v_mul_f32 v122, v122, v18
    v_mul_f32 v123, v123, v18
    v_mul_f32 v124, v124, v18
    s_waitcnt lgkmcnt(2)
    v_mfma_f32_16x16x32_bf16 v[64:67], v[24:27], v[60:63], v[64:67]
    ds_read_b64_tr_b16 v[48:49], v11 offset:24576
    ds_read_b64_tr_b16 v[50:51], v11 offset:25088
    ds_read_b64_tr_b16 v[60:61], v7 offset:0
    ds_read_b64_tr_b16 v[62:63], v7 offset:512
    v_mfma_f32_32x32x16_bf16 v[128:143], v[56:59], v[180:183], v[128:143]
    v_mul_f32 v125, v125, v18
    v_mul_f32 v126, v126, v18
    v_mul_f32_e64 v127, v127, v18
    v_cvt_pk_bf16_f32 v112, v112, v113
    v_cvt_pk_bf16_f32 v113, v114, v115
    v_cvt_pk_bf16_f32 v114, v116, v117
    ds_read_b64_tr_b16 v[52:53], v10 offset:0
    ds_read_b64_tr_b16 v[54:55], v10 offset:512
    v_mfma_f32_32x32x16_bf16 v[128:143], v[40:43], v[184:187], v[128:143]
    v_cvt_pk_bf16_f32 v115, v118, v119
    v_cvt_pk_bf16_f32 v116, v120, v121
    v_cvt_pk_bf16_f32 v117, v122, v123
    v_cvt_pk_bf16_f32 v118, v124, v125
    v_cvt_pk_bf16_f32 v119, v126, v127
    s_nop 0
    s_waitcnt lgkmcnt(2)
    v_mfma_f32_16x16x32_bf16 v[64:67], v[24:27], v[60:63], v[64:67]
    ds_read_b64_tr_b16 v[56:57], v10 offset:2048
    ds_read_b64_tr_b16 v[58:59], v10 offset:2560
    ds_read_b64_tr_b16 v[60:61], v7 offset:8192
    ds_read_b64_tr_b16 v[62:63], v7 offset:8704
    v_mfma_f32_32x32x16_bf16 v[128:143], v[44:47], v[188:191], v[128:143]
    v_mov_b32_e64 v120, s26
    v_cndmask_b32 v119, v119, 0, s[72:73]
    v_cndmask_b32 v118, v118, v120, s[72:73]
    buffer_store_dwordx4 v[112:115], v1, s[48:51], s20 offen sc1
    buffer_store_dwordx4 v[116:119], v1, s[48:51], s20 offen offset:1024 sc1
    s_setprio 0
    ds_read_b64_tr_b16 v[40:41], v10 offset:4096
    ds_read_b64_tr_b16 v[42:43], v10 offset:4608
    v_mfma_f32_32x32x16_bf16 v[128:143], v[48:51], v[192:195], v[128:143]
    v_mul_f32 v72, v80, v80
    v_mul_f32 v73, v81, v81
    v_mul_f32 v74, v82, v82
    v_mul_f32 v75, v83, v83
    v_fma_f32 v72, v72, v21, v20
    s_waitcnt lgkmcnt(2)
    v_mfma_f32_16x16x32_bf16 v[64:67], v[24:27], v[60:63], v[64:67]
    ds_read_b64_tr_b16 v[44:45], v10 offset:6144
    ds_read_b64_tr_b16 v[46:47], v10 offset:6656
    ds_read_b64_tr_b16 v[60:61], v13 offset:32768
    ds_read_b64_tr_b16 v[62:63], v13 offset:33280
    v_mfma_f32_32x32x16_bf16 v[112:127], v[52:55], v[144:147], 0
    v_fma_f32 v73, v73, v21, v20
    v_fma_f32 v74, v74, v21, v20
    v_fma_f32 v75, v75, v21, v20
    v_mul_f32 v72, v72, v80
    v_mul_f32 v73, v73, v81
    v_mul_f32_e64 v74, v74, v82
    ds_read_b64_tr_b16 v[48:49], v10 offset:8192
    ds_read_b64_tr_b16 v[50:51], v10 offset:8704
    v_mfma_f32_32x32x16_bf16 v[112:127], v[56:59], v[148:151], v[112:127]
    v_mul_f32 v75, v75, v83
    v_exp_f32 v72, v72
    v_exp_f32 v73, v73
    v_exp_f32 v74, v74
    v_exp_f32 v75, v75
    s_waitcnt lgkmcnt(2)
    v_mfma_f32_16x16x32_bf16 v[64:67], v[24:27], v[60:63], v[64:67]
    ds_read_b64_tr_b16 v[52:53], v10 offset:10240
    ds_read_b64_tr_b16 v[54:55], v10 offset:10752
    v_mfma_f32_32x32x16_bf16 v[112:127], v[40:43], v[152:155], v[112:127]
    v_fma_f32 v72, v72, v19, v19
    v_fma_f32 v73, v73, v19, v19
    v_fma_f32 v74, v74, v19, v19
    v_fma_f32 v75, v75, v19, v19
    v_rcp_f32 v72, v72
    v_rcp_f32 v73, v73
    ds_read_b64_tr_b16 v[56:57], v10 offset:12288
    ds_read_b64_tr_b16 v[58:59], v10 offset:12800
    v_mfma_f32_32x32x16_bf16 v[112:127], v[44:47], v[156:159], v[112:127]
    v_rcp_f32 v74, v74
    v_rcp_f32 v75, v75
    v_mul_f32 v80, v80, v72
    v_mul_f32 v81, v81, v73
    v_mul_f32 v82, v82, v74
    v_mul_f32 v83, v83, v75
    ds_read_b64_tr_b16 v[40:41], v10 offset:14336
    ds_read_b64_tr_b16 v[42:43], v10 offset:14848
    s_waitcnt lgkmcnt(6)
    v_mfma_f32_32x32x16_bf16 v[112:127], v[48:51], v[160:163], v[112:127]
    v_mul_f32 v76, v84, v84
    v_mul_f32 v77, v85, v85
    v_mul_f32 v78, v86, v86
    v_mul_f32 v79, v87, v87
    v_fma_f32 v76, v76, v21, v20
    ds_write_b32 v15, v64 offset:2048
    ds_read_b64_tr_b16 v[44:45], v10 offset:16384
    ds_read_b64_tr_b16 v[46:47], v10 offset:16896
    s_waitcnt lgkmcnt(7)
    v_mfma_f32_32x32x16_bf16 v[112:127], v[52:55], v[164:167], v[112:127]
    v_fma_f32 v77, v77, v21, v20
    v_fma_f32 v78, v78, v21, v20
    v_fma_f32 v79, v79, v21, v20
    v_mul_f32 v76, v76, v84
    v_mul_f32 v77, v77, v85
    v_mul_f32_e64 v78, v78, v86
    ds_read_b64_tr_b16 v[48:49], v10 offset:18432
    ds_read_b64_tr_b16 v[50:51], v10 offset:18944
    s_waitcnt lgkmcnt(7)
    v_mfma_f32_32x32x16_bf16 v[112:127], v[56:59], v[168:171], v[112:127]
    v_mul_f32 v79, v79, v87
    v_exp_f32 v76, v76
    v_exp_f32 v77, v77
    v_exp_f32_e64 v78, v78
    v_exp_f32 v79, v79
    s_waitcnt lgkmcnt(4)
    s_mov_b64 exec, 1
    ds_add_u32 v5, v9 offset:48
    s_mov_b64 exec, -1
    ds_read_b64_tr_b16 v[52:53], v10 offset:20480
    ds_read_b64_tr_b16 v[54:55], v10 offset:20992
    v_mfma_f32_32x32x16_bf16 v[112:127], v[40:43], v[172:175], v[112:127]
    v_fma_f32 v76, v76, v19, v19
    v_fma_f32 v77, v77, v19, v19
    v_fma_f32 v78, v78, v19, v19
    v_fma_f32 v79, v79, v19, v19
    v_rcp_f32 v76, v76
    v_rcp_f32 v77, v77
    ds_read_b64_tr_b16 v[56:57], v10 offset:22528
    ds_read_b64_tr_b16 v[58:59], v10 offset:23040
    s_waitcnt lgkmcnt(7)
    v_mfma_f32_32x32x16_bf16 v[112:127], v[44:47], v[176:179], v[112:127]
    v_rcp_f32 v78, v78
    v_rcp_f32 v79, v79
    v_mul_f32 v84, v84, v76
    v_mul_f32 v85, v85, v77
    v_mul_f32 v86, v86, v78
    v_mul_f32_e64 v87, v87, v79
    v_mov_b32 v23, s97
    s_waitcnt vmcnt(0)
    buffer_store_dword v23, off, s[48:51], s19 offset:0 sc1
    ds_read_b64_tr_b16 v[40:41], v10 offset:24576
    ds_read_b64_tr_b16 v[42:43], v10 offset:25088
    s_waitcnt lgkmcnt(7)
    v_mfma_f32_32x32x16_bf16 v[112:127], v[48:51], v[180:183], v[112:127]
    v_mul_f32 v72, v88, v88
    v_mul_f32 v73, v89, v89
    v_mul_f32 v74, v90, v90
    v_mul_f32 v75, v91, v91
    v_fma_f32 v72, v72, v21, v20
    ds_read_b64_tr_b16 v[44:45], v10 offset:26624
    ds_read_b64_tr_b16 v[46:47], v10 offset:27136
    s_waitcnt lgkmcnt(6)
    v_mfma_f32_32x32x16_bf16 v[112:127], v[52:55], v[184:187], v[112:127]
    v_fma_f32 v73, v73, v21, v20
    v_fma_f32 v74, v74, v21, v20
    v_fma_f32 v75, v75, v21, v20
    v_mul_f32 v72, v72, v88
    v_mul_f32 v73, v73, v89
    v_mul_f32_e64 v74, v74, v90
    ds_read_b64_tr_b16 v[48:49], v11 offset:26624
    ds_read_b64_tr_b16 v[50:51], v11 offset:27136
    s_waitcnt lgkmcnt(6)
    v_mfma_f32_32x32x16_bf16 v[112:127], v[56:59], v[188:191], v[112:127]
    v_mul_f32 v75, v75, v91
    v_exp_f32 v72, v72
    v_exp_f32 v73, v73
    v_exp_f32_e64 v74, v74
    v_exp_f32 v75, v75
    ds_read_b64_tr_b16 v[52:53], v10 offset:28672
    ds_read_b64_tr_b16 v[54:55], v10 offset:29184
    s_waitcnt lgkmcnt(6)
    v_mfma_f32_32x32x16_bf16 v[112:127], v[40:43], v[192:195], v[112:127]
    v_fma_f32 v72, v72, v19, v19
    v_fma_f32 v73, v73, v19, v19
    v_fma_f32 v74, v74, v19, v19
    v_fma_f32 v75, v75, v19, v19
    v_rcp_f32 v72, v72
    v_rcp_f32 v73, v73
    ds_read_b64_tr_b16 v[56:57], v11 offset:28672
    ds_read_b64_tr_b16 v[58:59], v11 offset:29184
    s_waitcnt lgkmcnt(6)
    v_mfma_f32_32x32x16_bf16 v[112:127], v[44:47], v[196:199], v[112:127]
    v_rcp_f32 v74, v74
    v_rcp_f32 v75, v75
    v_mul_f32 v88, v88, v72
    v_mul_f32 v89, v89, v73
    v_mul_f32 v90, v90, v74
    v_mul_f32_e64 v91, v91, v75
    ds_read_b64_tr_b16 v[40:41], v10 offset:30720
    ds_read_b64_tr_b16 v[42:43], v10 offset:31232
    s_waitcnt lgkmcnt(6)
    v_mfma_f32_32x32x16_bf16 v[128:143], v[48:51], v[196:199], v[128:143]
    v_mul_f32 v76, v92, v92
    v_mul_f32 v77, v93, v93
    v_mul_f32 v78, v94, v94
    v_mul_f32 v79, v95, v95
    v_fma_f32 v76, v76, v21, v20
    ds_read_b64_tr_b16 v[44:45], v11 offset:30720
    ds_read_b64_tr_b16 v[46:47], v11 offset:31232
    s_waitcnt lgkmcnt(6)
    v_mfma_f32_32x32x16_bf16 v[112:127], v[52:55], v[200:203], v[112:127]
    v_fma_f32 v77, v77, v21, v20
    v_fma_f32 v78, v78, v21, v20
    v_fma_f32 v79, v79, v21, v20
    v_mul_f32 v76, v76, v92
    v_mul_f32 v77, v77, v93
    v_mul_f32_e64 v78, v78, v94
    ds_read_b64_tr_b16 v[48:49], v12 offset:0
    ds_read_b64_tr_b16 v[50:51], v12 offset:512
    s_waitcnt lgkmcnt(6)
    v_mfma_f32_32x32x16_bf16 v[128:143], v[56:59], v[200:203], v[128:143]
    v_mul_f32 v79, v79, v95
    v_exp_f32 v76, v76
    v_exp_f32 v77, v77
    v_exp_f32_e64 v78, v78
    v_exp_f32 v79, v79
    ds_read_b64_tr_b16 v[52:53], v14 offset:0
    ds_read_b64_tr_b16 v[54:55], v14 offset:512
    s_waitcnt lgkmcnt(6)
    v_mfma_f32_32x32x16_bf16 v[112:127], v[40:43], v[204:207], v[112:127]
    v_fma_f32 v76, v76, v19, v19
    v_fma_f32 v77, v77, v19, v19
    v_fma_f32 v78, v78, v19, v19
    v_fma_f32 v79, v79, v19, v19
    v_rcp_f32 v76, v76
    v_rcp_f32 v77, v77
    s_lshl_b32 s76, s4, 3
    s_add_u32 s76, s76, s5
    v_min_u32 v23, 12, v0
    v_lshlrev_b32 v23, 7, v23
    s_mul_i32 s77, s76, 1568
    buffer_load_dword v151, v23, s[60:63], s77 offen
    ds_read_b64_tr_b16 v[56:57], v12 offset:2048
    ds_read_b64_tr_b16 v[58:59], v12 offset:2560
    s_waitcnt lgkmcnt(6)
    v_mfma_f32_32x32x16_bf16 v[128:143], v[44:47], v[204:207], v[128:143]
    v_rcp_f32 v78, v78
    v_rcp_f32 v79, v79
    v_mul_f32 v92, v92, v76
    v_mul_f32 v93, v93, v77
    v_mul_f32 v94, v94, v78
    v_mul_f32_e64 v95, v95, v79
    ds_read_b64_tr_b16 v[40:41], v14 offset:2048
    ds_read_b64_tr_b16 v[42:43], v14 offset:2560
    s_waitcnt lgkmcnt(6)
    v_mfma_f32_32x32x16_bf16 v[112:127], v[48:51], v[208:211], v[112:127]
    v_mul_f32 v72, v96, v96
    v_mul_f32 v73, v97, v97
    v_mul_f32 v74, v98, v98
    v_mul_f32 v75, v99, v99
    v_fma_f32 v72, v72, v21, v20
    ds_read_b64_tr_b16 v[44:45], v12 offset:4096
    ds_read_b64_tr_b16 v[46:47], v12 offset:4608
    s_waitcnt lgkmcnt(6)
    v_mfma_f32_32x32x16_bf16 v[128:143], v[52:55], v[208:211], v[128:143]
    v_fma_f32 v73, v73, v21, v20
    v_fma_f32 v74, v74, v21, v20
    v_fma_f32 v75, v75, v21, v20
    v_mul_f32 v72, v72, v96
    v_mul_f32 v73, v73, v97
    v_mul_f32_e64 v74, v74, v98
    ds_read_b64_tr_b16 v[48:49], v14 offset:4096
    ds_read_b64_tr_b16 v[50:51], v14 offset:4608
    s_waitcnt lgkmcnt(6)
    v_mfma_f32_32x32x16_bf16 v[112:127], v[56:59], v[212:215], v[112:127]
    v_mul_f32 v75, v75, v99
    v_exp_f32 v72, v72
    v_exp_f32 v73, v73
    v_exp_f32_e64 v74, v74
    v_exp_f32 v75, v75
    ds_read_b64_tr_b16 v[52:53], v12 offset:6144
    ds_read_b64_tr_b16 v[54:55], v12 offset:6656
    s_waitcnt lgkmcnt(6)
    v_mfma_f32_32x32x16_bf16 v[128:143], v[40:43], v[212:215], v[128:143]
    v_fma_f32 v72, v72, v19, v19
    v_fma_f32 v73, v73, v19, v19
    v_fma_f32 v74, v74, v19, v19
    v_fma_f32 v75, v75, v19, v19
    v_rcp_f32 v72, v72
    v_rcp_f32 v73, v73
    ds_read_b64_tr_b16 v[56:57], v14 offset:6144
    ds_read_b64_tr_b16 v[58:59], v14 offset:6656
    s_waitcnt lgkmcnt(6)
    v_mfma_f32_32x32x16_bf16 v[112:127], v[44:47], v[216:219], v[112:127]
    v_rcp_f32 v74, v74
    v_rcp_f32 v75, v75
    v_mul_f32 v96, v96, v72
    v_mul_f32 v97, v97, v73
    v_mul_f32 v98, v98, v74
    v_mul_f32_e64 v99, v99, v75
    ds_read_b64_tr_b16 v[40:41], v12 offset:8192
    ds_read_b64_tr_b16 v[42:43], v12 offset:8704
    s_waitcnt lgkmcnt(6)
    v_mfma_f32_32x32x16_bf16 v[128:143], v[48:51], v[216:219], v[128:143]
    v_mul_f32 v76, v100, v100
    v_mul_f32 v77, v101, v101
    v_mul_f32 v78, v102, v102
    v_mul_f32 v79, v103, v103
    v_fma_f32 v76, v76, v21, v20
    ds_read_b64_tr_b16 v[44:45], v14 offset:8192
    ds_read_b64_tr_b16 v[46:47], v14 offset:8704
    s_waitcnt lgkmcnt(6)
    v_mfma_f32_32x32x16_bf16 v[112:127], v[52:55], v[220:223], v[112:127]
    v_fma_f32 v77, v77, v21, v20
    v_fma_f32 v78, v78, v21, v20
    v_fma_f32 v79, v79, v21, v20
    v_mul_f32 v76, v76, v100
    v_mul_f32 v77, v77, v101
    v_mul_f32_e64 v78, v78, v102
    ds_read_b64_tr_b16 v[48:49], v12 offset:10240
    ds_read_b64_tr_b16 v[50:51], v12 offset:10752
    s_waitcnt lgkmcnt(6)
    v_mfma_f32_32x32x16_bf16 v[128:143], v[56:59], v[220:223], v[128:143]
    v_mul_f32 v79, v79, v103
    v_exp_f32 v76, v76
    v_exp_f32 v77, v77
    v_exp_f32_e64 v78, v78
    v_exp_f32 v79, v79
    ds_read_b64_tr_b16 v[52:53], v14 offset:10240
    ds_read_b64_tr_b16 v[54:55], v14 offset:10752
    s_waitcnt lgkmcnt(6)
    v_mfma_f32_32x32x16_bf16 v[112:127], v[40:43], v[224:227], v[112:127]
    v_fma_f32 v76, v76, v19, v19
    v_fma_f32 v77, v77, v19, v19
    v_fma_f32 v78, v78, v19, v19
    v_fma_f32 v79, v79, v19, v19
    v_rcp_f32 v76, v76
    v_rcp_f32 v77, v77
    ds_read_b64_tr_b16 v[56:57], v12 offset:12288
    ds_read_b64_tr_b16 v[58:59], v12 offset:12800
    s_waitcnt lgkmcnt(6)
    v_mfma_f32_32x32x16_bf16 v[128:143], v[44:47], v[224:227], v[128:143]
    v_rcp_f32 v78, v78
    v_rcp_f32 v79, v79
    v_mul_f32 v100, v100, v76
    v_mul_f32 v101, v101, v77
    v_mul_f32 v102, v102, v78
    v_mul_f32 v103, v103, v79
    ds_read_b64_tr_b16 v[40:41], v14 offset:12288
    ds_read_b64_tr_b16 v[42:43], v14 offset:12800
    s_waitcnt lgkmcnt(6)
    v_mfma_f32_32x32x16_bf16 v[112:127], v[48:51], v[228:231], v[112:127]
    s_mov_b32 s76, 200000
L_ll15:
    ds_read_b32 v23, v5 offset:48
    s_waitcnt lgkmcnt(0)
    v_readfirstlane_b32 s77, v23
    s_nop 0
    s_cmp_eq_u32 s77, 8
    s_cbranch_scc1 L_lk15
    s_sleep 1
    s_sub_u32 s76, s76, 1
    s_cbranch_scc0 L_ll15
L_lk15:
    ds_read_b128 v[216:219], v16 offset:2048
    ds_read_b128 v[220:223], v16 offset:2560
    ds_read_b64_tr_b16 v[44:45], v12 offset:14336
    ds_read_b64_tr_b16 v[46:47], v12 offset:14848
    v_mfma_f32_32x32x16_bf16 v[128:143], v[52:55], v[228:231], v[128:143]
    v_mul_f32 v72, v104, v104
    v_mul_f32 v73, v105, v105
    v_mul_f32 v74, v106, v106
    v_mul_f32 v75, v107, v107
    v_fma_f32 v72, v72, v21, v20
    v_fma_f32 v73, v73, v21, v20
    ds_read_b64_tr_b16 v[48:49], v14 offset:14336
    ds_read_b64_tr_b16 v[50:51], v14 offset:14848
    v_mfma_f32_32x32x16_bf16 v[112:127], v[56:59], v[232:235], v[112:127]
    v_fma_f32 v74, v74, v21, v20
    v_fma_f32 v75, v75, v21, v20
    v_mul_f32 v72, v72, v104
    v_mul_f32 v73, v73, v105
    v_mul_f32 v74, v74, v106
    v_mul_f32 v75, v75, v107
    v_exp_f32 v72, v72
    s_lshr_b32 s16, s4, 4
    s_lshl_b32 s34, s3, 1
    s_add_u32 s16, s16, s34
    s_and_b32 s17, s4, 15
    s_lshl_b32 s21, s17, 2
    ds_read_b64_tr_b16 v[52:53], v10 offset:32768
    ds_read_b64_tr_b16 v[54:55], v10 offset:33280
    v_mfma_f32_32x32x16_bf16 v[128:143], v[40:43], v[232:235], v[128:143]
    v_exp_f32 v73, v73
    s_waitcnt lgkmcnt(7)
    v_add_f32 v216, v216, v217
    v_add_f32 v218, v218, v219
    v_add_f32_e64 v216, v216, v218
    v_cvt_pk_bf16_f32 v217, v216, v216
    v_and_b32 v217, 0xffff0000, v217
    s_mul_i32 s20, s14, 3
    s_add_u32 s20, s20, s21
    s_add_u32 s22, s21, s14
    v_and_b32 v152, 7, v0
    v_cmp_lt_u32 vcc, 2, v152
    ds_read_b64_tr_b16 v[56:57], v11 offset:32768
    ds_read_b64_tr_b16 v[58:59], v11 offset:33280
    s_waitcnt lgkmcnt(6)
    v_mfma_f32_32x32x16_bf16 v[112:127], v[44:47], v[236:239], v[112:127]
    v_sub_f32_e64 v217, v216, v217
    v_cvt_pk_bf16_f32 v32, v216, v217
    v_cvt_pk_bf16_f32 v33, v216, v217
    v_add_f32 v220, v220, v221
    v_add_f32 v222, v222, v223
    v_add_f32 v220, v220, v222
    v_subrev_u32 v153, 3, v152
    v_mov_b32 v154, 1024
    v_cndmask_b32_e64 v153, v152, v153, vcc
    v_mov_b32 v155, 2048
    v_cndmask_b32 v154, v154, v155, vcc
    ds_read_b64_tr_b16 v[40:41], v10 offset:34816
    ds_read_b64_tr_b16 v[42:43], v10 offset:35328
    s_waitcnt lgkmcnt(6)
    v_mfma_f32_32x32x16_bf16 v[128:143], v[48:51], v[236:239], v[128:143]
    v_cvt_pk_bf16_f32 v221, v220, v220
    v_and_b32 v221, 0xffff0000, v221
    v_sub_f32_e64 v221, v220, v221
    v_cvt_pk_bf16_f32 v36, v220, v221
    v_cvt_pk_bf16_f32 v37, v220, v221
    v_mfma_f32_32x32x16_bf16 v[112:127], v[32:35], v[28:31], v[112:127]
    s_nop 0
    v_mfma_f32_32x32x16_bf16 v[128:143], v[36:39], v[28:31], v[128:143]
    v_add_u32 v153, s20, v153
    v_subrev_u32 v153, 8, v153
    v_max_i32 v153, 0, v153
    v_add_u32 v153, v153, v154
    v_cmp_lt_u32 vcc, 5, v152
    ds_read_b64_tr_b16 v[44:45], v11 offset:34816
    ds_read_b64_tr_b16 v[46:47], v11 offset:35328
    s_waitcnt lgkmcnt(6)
    v_mfma_f32_32x32x16_bf16 v[112:127], v[52:55], v[240:243], v[112:127]
    v_exp_f32 v74, v74
    v_exp_f32_e64 v75, v75
    v_fma_f32 v72, v72, v19, v19
    v_fma_f32 v73, v73, v19, v19
    v_fma_f32 v74, v74, v19, v19
    v_fma_f32 v75, v75, v19, v19
    v_rcp_f32 v72, v72
    v_mov_b32 v154, s22
    s_lshl_b32 s23, s16, 8
    v_cndmask_b32 v153, v153, v154, vcc
    v_lshlrev_b32_e64 v3, 2, v153
    s_add_u32 s23, s23, 18939904
    ds_read_b64_tr_b16 v[48:49], v10 offset:36864
    ds_read_b64_tr_b16 v[50:51], v10 offset:37376
    s_waitcnt lgkmcnt(6)
    v_mfma_f32_32x32x16_bf16 v[128:143], v[56:59], v[240:243], v[128:143]
    v_rcp_f32 v73, v73
    v_rcp_f32 v74, v74
    v_rcp_f32 v75, v75
    v_mul_f32 v104, v104, v72
    v_mul_f32 v105, v105, v73
    v_mul_f32 v106, v106, v74
    v_mul_f32 v107, v107, v75
    s_mul_i32 s21, s14, 12288
    s_add_u32 s21, s21, 86016
    s_lshl_b32 s24, s16, 17
    s_mov_b32 s25, 0
    buffer_load_dword v6, v3, s[48:51], s23 offen sc1
    ds_read_b64_tr_b16 v[52:53], v11 offset:36864
    ds_read_b64_tr_b16 v[54:55], v11 offset:37376
    s_waitcnt lgkmcnt(6)
    v_mfma_f32_32x32x16_bf16 v[112:127], v[40:43], v[244:247], v[112:127]
    v_mul_f32 v76, v108, v108
    v_mul_f32 v77, v109, v109
    v_mul_f32 v78, v110, v110
    v_mul_f32_e64 v79, v111, v111
    v_fma_f32 v76, v76, v21, v20
    v_fma_f32 v77, v77, v21, v20
    v_fma_f32 v78, v78, v21, v20
    ds_read_b64_tr_b16 v[56:57], v10 offset:38912
    ds_read_b64_tr_b16 v[58:59], v10 offset:39424
    s_waitcnt lgkmcnt(6)
    v_mfma_f32_32x32x16_bf16 v[128:143], v[44:47], v[244:247], v[128:143]
    v_fma_f32 v79, v79, v21, v20
    v_mul_f32 v76, v76, v108
    v_mul_f32 v77, v77, v109
    v_mul_f32 v78, v78, v110
    v_mul_f32 v79, v79, v111
    v_exp_f32 v76, v76
    v_exp_f32_e64 v77, v77
    ds_read_b64_tr_b16 v[40:41], v11 offset:38912
    ds_read_b64_tr_b16 v[42:43], v11 offset:39424
    s_waitcnt lgkmcnt(6)
    v_mfma_f32_32x32x16_bf16 v[112:127], v[48:51], v[248:251], v[112:127]
    v_exp_f32 v78, v78
    v_exp_f32_e64 v79, v79
    v_fma_f32 v76, v76, v19, v19
    v_fma_f32 v77, v77, v19, v19
    v_fma_f32 v78, v78, v19, v19
    v_fma_f32 v79, v79, v19, v19
    v_rcp_f32 v76, v76
    s_waitcnt lgkmcnt(4)
    v_mfma_f32_32x32x16_bf16 v[128:143], v[52:55], v[248:251], v[128:143]
    s_waitcnt lgkmcnt(0)
    s_mov_b64 exec, 1
    ds_add_u32 v5, v9 offset:80
    s_mov_b64 exec, -1
    v_rcp_f32 v77, v77
    v_rcp_f32 v78, v78
    v_rcp_f32 v79, v79
    v_mul_f32 v108, v108, v76
    v_mul_f32 v109, v109, v77
    v_mul_f32 v110, v110, v78
    v_mul_f32 v111, v111, v79
    v_mfma_f32_32x32x16_bf16 v[112:127], v[56:59], v[252:255], v[112:127]
    v_mfma_f32_32x32x16_bf16 v[128:143], v[40:43], v[252:255], v[128:143]
    s_lshl_b32 s99, s8, 7
    s_lshl_b32 s34, s7, 2
    s_add_u32 s99, s99, s34
    s_add_u32 s99, s99, 18956288
    s_nop 6
    v_mul_f32 v80, v80, v112
    v_mul_f32 v81, v81, v113
    v_mul_f32 v82, v82, v114
    v_mul_f32 v83, v83, v115
    v_mul_f32 v84, v84, v116
    v_mul_f32 v85, v85, v117
    v_mul_f32 v86, v86, v118
    v_mul_f32 v87, v87, v119
    v_cvt_pk_bf16_f32 v80, v80, v81
    v_cvt_pk_bf16_f32 v81, v82, v83
    v_cvt_pk_bf16_f32 v82, v84, v85
    v_cvt_pk_bf16_f32 v83, v86, v87
    buffer_store_dwordx4 v[80:83], v1, s[48:51], s18 offen offset:0 sc1
    v_mul_f32 v88, v88, v120
    v_mul_f32 v89, v89, v121
    v_mul_f32 v90, v90, v122
    v_mul_f32 v91, v91, v123
    v_mul_f32 v92, v92, v124
    v_mul_f32 v93, v93, v125
    v_mul_f32 v94, v94, v126
    v_mul_f32 v95, v95, v127
    v_cvt_pk_bf16_f32 v88, v88, v89
    v_cvt_pk_bf16_f32 v89, v90, v91
    v_cvt_pk_bf16_f32 v90, v92, v93
    v_cvt_pk_bf16_f32 v91, v94, v95
    buffer_store_dwordx4 v[88:91], v1, s[48:51], s18 offen offset:1024 sc1
    v_mul_f32 v96, v96, v128
    v_mul_f32 v97, v97, v129
    v_mul_f32 v98, v98, v130
    v_mul_f32 v99, v99, v131
    v_mul_f32 v100, v100, v132
    v_mul_f32 v101, v101, v133
    v_mul_f32 v102, v102, v134
    v_mul_f32 v103, v103, v135
    v_cvt_pk_bf16_f32 v96, v96, v97
    v_cvt_pk_bf16_f32 v97, v98, v99
    v_cvt_pk_bf16_f32 v98, v100, v101
    v_cvt_pk_bf16_f32 v99, v102, v103
    buffer_store_dwordx4 v[96:99], v1, s[48:51], s18 offen offset:2048 sc1
    v_mul_f32 v104, v104, v136
    v_mul_f32 v105, v105, v137
    v_mul_f32 v106, v106, v138
    v_mul_f32 v107, v107, v139
    v_mul_f32 v108, v108, v140
    v_mul_f32 v109, v109, v141
    v_mul_f32 v110, v110, v142
    v_mul_f32 v111, v111, v143
    v_cvt_pk_bf16_f32 v104, v104, v105
    v_cvt_pk_bf16_f32 v105, v106, v107
    v_cvt_pk_bf16_f32 v106, v108, v109
    v_cvt_pk_bf16_f32 v107, v110, v111
    buffer_store_dwordx4 v[104:107], v1, s[48:51], s18 offen offset:3072 sc1
    s_waitcnt vmcnt(4)
    s_branch L_attn
L_p1g_A2:
    ds_read_b128 v[72:75], v16 offset:1024
    ds_read_b128 v[76:79], v16 offset:1536
    ds_read_b64_tr_b16 v[40:41], v11 offset:0
    ds_read_b64_tr_b16 v[42:43], v11 offset:512
    ds_read_b64_tr_b16 v[44:45], v11 offset:2048
    ds_read_b64_tr_b16 v[46:47], v11 offset:2560
    ds_read_b64_tr_b16 v[48:49], v11 offset:4096
    ds_read_b64_tr_b16 v[50:51], v11 offset:4608
    v_mfma_f32_32x32x16_bf16 v[80:95], v[52:55], v[252:255], v[80:95]
    v_mfma_f32_32x32x16_bf16 v[96:111], v[56:59], v[252:255], v[96:111]
    ds_read_b64_tr_b16 v[52:53], v11 offset:6144
    ds_read_b64_tr_b16 v[54:55], v11 offset:6656
    s_waitcnt lgkmcnt(6)
    v_mfma_f32_32x32x16_bf16 v[128:143], v[40:43], v[144:147], 0
    v_add_f32 v72, v72, v76
    v_add_f32 v73, v73, v77
    v_add_f32 v74, v74, v78
    v_add_f32_e64 v75, v75, v79
    ds_read_b64_tr_b16 v[56:57], v11 offset:8192
    ds_read_b64_tr_b16 v[58:59], v11 offset:8704
    ds_read_b64_tr_b16 v[60:61], v13 offset:0
    ds_read_b64_tr_b16 v[62:63], v13 offset:512
    s_waitcnt lgkmcnt(8)
    v_mfma_f32_32x32x16_bf16 v[128:143], v[44:47], v[148:151], v[128:143]
    v_add_f32 v72, v72, v73
    v_add_f32 v74, v74, v75
    v_add_f32 v72, v72, v74
    v_cvt_pk_bf16_f32 v73, v72, v72
    v_and_b32 v73, 0xffff0000, v73
    v_sub_f32 v73, v72, v73
    ds_read_b64_tr_b16 v[40:41], v11 offset:10240
    ds_read_b64_tr_b16 v[42:43], v11 offset:10752
    s_waitcnt lgkmcnt(8)
    v_mfma_f32_32x32x16_bf16 v[128:143], v[48:51], v[152:155], v[128:143]
    v_cvt_pk_bf16_f32 v32, v72, v73
    v_cvt_pk_bf16_f32 v33, v72, v73
    ds_read_b128 v[72:75], v16 offset:0
    ds_read_b128 v[76:79], v16 offset:512
    v_mfma_f32_32x32x16_bf16 v[112:127], v[32:35], v[28:31], v[112:127]
    s_nop 0
    s_waitcnt lgkmcnt(4)
    v_mfma_f32_16x16x32_bf16 v[64:67], v[24:27], v[60:63], 0
    ds_read_b64_tr_b16 v[44:45], v11 offset:12288
    ds_read_b64_tr_b16 v[46:47], v11 offset:12800
    ds_read_b64_tr_b16 v[60:61], v13 offset:8192
    ds_read_b64_tr_b16 v[62:63], v13 offset:8704
    v_mfma_f32_32x32x16_bf16 v[128:143], v[52:55], v[156:159], v[128:143]
    s_waitcnt lgkmcnt(5)
    v_add_f32 v72, v72, v73
    v_add_f32 v74, v74, v75
    v_add_f32 v72, v72, v74
    v_cvt_pk_bf16_f32 v73, v72, v72
    v_and_b32 v73, 0xffff0000, v73
    ds_read_b64_tr_b16 v[48:49], v11 offset:14336
    ds_read_b64_tr_b16 v[50:51], v11 offset:14848
    v_mfma_f32_32x32x16_bf16 v[128:143], v[56:59], v[160:163], v[128:143]
    v_sub_f32_e64 v73, v72, v73
    v_cvt_pk_bf16_f32 v36, v72, v73
    v_cvt_pk_bf16_f32 v37, v72, v73
    s_nop 1
    v_mfma_f32_32x32x16_bf16 v[80:95], v[36:39], v[28:31], v[80:95]
    s_waitcnt lgkmcnt(2)
    v_mfma_f32_16x16x32_bf16 v[64:67], v[24:27], v[60:63], v[64:67]
    ds_read_b64_tr_b16 v[52:53], v11 offset:16384
    ds_read_b64_tr_b16 v[54:55], v11 offset:16896
    ds_read_b64_tr_b16 v[60:61], v13 offset:16384
    ds_read_b64_tr_b16 v[62:63], v13 offset:16896
    v_mfma_f32_32x32x16_bf16 v[128:143], v[40:43], v[164:167], v[128:143]
    v_add_f32 v76, v76, v77
    v_add_f32 v78, v78, v79
    v_add_f32_e64 v76, v76, v78
    v_cvt_pk_bf16_f32 v77, v76, v76
    v_and_b32 v77, 0xffff0000, v77
    v_sub_f32_e64 v77, v76, v77
    ds_read_b64_tr_b16 v[56:57], v11 offset:18432
    ds_read_b64_tr_b16 v[58:59], v11 offset:18944
    v_mfma_f32_32x32x16_bf16 v[128:143], v[44:47], v[168:171], v[128:143]
    v_cvt_pk_bf16_f32 v32, v76, v77
    v_cvt_pk_bf16_f32 v33, v76, v77
    s_nop 1
    v_mfma_f32_32x32x16_bf16 v[96:111], v[32:35], v[28:31], v[96:111]
    v_mul_f32 v112, v112, v18
    v_mul_f32 v113, v113, v18
    s_waitcnt lgkmcnt(2)
    v_mfma_f32_16x16x32_bf16 v[64:67], v[24:27], v[60:63], v[64:67]
    ds_read_b64_tr_b16 v[40:41], v11 offset:20480
    ds_read_b64_tr_b16 v[42:43], v11 offset:20992
    ds_read_b64_tr_b16 v[60:61], v13 offset:24576
    ds_read_b64_tr_b16 v[62:63], v13 offset:25088
    v_mfma_f32_32x32x16_bf16 v[128:143], v[48:51], v[172:175], v[128:143]
    v_mul_f32 v114, v114, v18
    v_mul_f32 v115, v115, v18
    v_mul_f32 v116, v116, v18
    v_mul_f32 v117, v117, v18
    v_mul_f32 v118, v118, v18
    v_mul_f32 v119, v119, v18
    ds_read_b64_tr_b16 v[44:45], v11 offset:22528
    ds_read_b64_tr_b16 v[46:47], v11 offset:23040
    v_mfma_f32_32x32x16_bf16 v[128:143], v[52:55], v[176:179], v[128:143]
    v_mul_f32 v120, v120, v18
    v_mul_f32 v121, v121, v18
    v_mul_f32 v122, v122, v18
    v_mul_f32 v123, v123, v18
    v_mul_f32 v124, v124, v18
    s_waitcnt lgkmcnt(2)
    v_mfma_f32_16x16x32_bf16 v[64:67], v[24:27], v[60:63], v[64:67]
    ds_read_b64_tr_b16 v[48:49], v11 offset:24576
    ds_read_b64_tr_b16 v[50:51], v11 offset:25088
    ds_read_b64_tr_b16 v[60:61], v7 offset:0
    ds_read_b64_tr_b16 v[62:63], v7 offset:512
    v_mfma_f32_32x32x16_bf16 v[128:143], v[56:59], v[180:183], v[128:143]
    v_mul_f32 v125, v125, v18
    v_mul_f32 v126, v126, v18
    v_mul_f32_e64 v127, v127, v18
    v_cvt_pk_bf16_f32 v112, v112, v113
    v_cvt_pk_bf16_f32 v113, v114, v115
    v_cvt_pk_bf16_f32 v114, v116, v117
    ds_read_b64_tr_b16 v[52:53], v10 offset:0
    ds_read_b64_tr_b16 v[54:55], v10 offset:512
    v_mfma_f32_32x32x16_bf16 v[128:143], v[40:43], v[184:187], v[128:143]
    v_cvt_pk_bf16_f32 v115, v118, v119
    v_cvt_pk_bf16_f32 v116, v120, v121
    v_cvt_pk_bf16_f32 v117, v122, v123
    v_cvt_pk_bf16_f32 v118, v124, v125
    v_cvt_pk_bf16_f32 v119, v126, v127
    s_nop 0
    s_waitcnt lgkmcnt(2)
    v_mfma_f32_16x16x32_bf16 v[64:67], v[24:27], v[60:63], v[64:67]
    ds_read_b64_tr_b16 v[56:57], v10 offset:2048
    ds_read_b64_tr_b16 v[58:59], v10 offset:2560
    ds_read_b64_tr_b16 v[60:61], v7 offset:8192
    ds_read_b64_tr_b16 v[62:63], v7 offset:8704
    v_mfma_f32_32x32x16_bf16 v[128:143], v[44:47], v[188:191], v[128:143]
    v_mov_b32_e64 v120, s26
    v_cndmask_b32 v119, v119, 0, s[72:73]
    v_cndmask_b32 v118, v118, v120, s[72:73]
    buffer_store_dwordx4 v[112:115], v1, s[48:51], s20 offen sc1
    buffer_store_dwordx4 v[116:119], v1, s[48:51], s20 offen offset:1024 sc1
    s_setprio 2
    ds_read_b64_tr_b16 v[40:41], v10 offset:4096
    ds_read_b64_tr_b16 v[42:43], v10 offset:4608
    v_mfma_f32_32x32x16_bf16 v[128:143], v[48:51], v[192:195], v[128:143]
    v_mul_f32 v72, v80, v80
    v_mul_f32 v73, v81, v81
    v_mul_f32 v74, v82, v82
    v_mul_f32 v75, v83, v83
    v_fma_f32 v72, v72, v21, v20
    s_waitcnt lgkmcnt(2)
    v_mfma_f32_16x16x32_bf16 v[64:67], v[24:27], v[60:63], v[64:67]
    ds_read_b64_tr_b16 v[44:45], v10 offset:6144
    ds_read_b64_tr_b16 v[46:47], v10 offset:6656
    ds_read_b64_tr_b16 v[60:61], v13 offset:32768
    ds_read_b64_tr_b16 v[62:63], v13 offset:33280
    v_mfma_f32_32x32x16_bf16 v[112:127], v[52:55], v[144:147], 0
    v_fma_f32 v73, v73, v21, v20
    v_fma_f32 v74, v74, v21, v20
    v_fma_f32 v75, v75, v21, v20
    v_mul_f32 v72, v72, v80
    v_mul_f32 v73, v73, v81
    v_mul_f32_e64 v74, v74, v82
    ds_read_b64_tr_b16 v[48:49], v10 offset:8192
    ds_read_b64_tr_b16 v[50:51], v10 offset:8704
    v_mfma_f32_32x32x16_bf16 v[112:127], v[56:59], v[148:151], v[112:127]
    v_mul_f32 v75, v75, v83
    v_exp_f32 v72, v72
    v_exp_f32 v73, v73
    v_exp_f32 v74, v74
    v_exp_f32_e64 v75, v75
    s_min_u32 s34, s4, 27
    s_lshr_b32 s35, s34, 2
    s_and_b32 s34, s34, 3
    s_lshl_b32 s34, s34, 1
    s_add_u32 s34, s34, s35
    s_add_u32 s34, s34, s3
    s_mul_i32 s13, s34, 37
    s_waitcnt lgkmcnt(2)
    v_mfma_f32_16x16x32_bf16 v[64:67], v[24:27], v[60:63], v[64:67]
    ds_read_b64_tr_b16 v[52:53], v10 offset:10240
    ds_read_b64_tr_b16 v[54:55], v10 offset:10752
    v_mfma_f32_32x32x16_bf16 v[112:127], v[40:43], v[152:155], v[112:127]
    v_fma_f32 v72, v72, v19, v19
    v_fma_f32 v73, v73, v19, v19
    v_fma_f32 v74, v74, v19, v19
    v_fma_f32 v75, v75, v19, v19
    v_rcp_f32 v72, v72
    v_rcp_f32 v73, v73
    s_lshr_b32 s13, s13, 8
    s_mul_i32 s13, s13, 7
    s_sub_u32 s10, s34, s13
    s_lshl_b32 s10, s10, 2
    s_lshl_b32 s35, s35, 7
    s_mul_i32 s12, s14, 401408
    s_add_u32 s12, s12, s35
    ds_read_b64_tr_b16 v[56:57], v10 offset:12288
    ds_read_b64_tr_b16 v[58:59], v10 offset:12800
    v_mfma_f32_32x32x16_bf16 v[112:127], v[44:47], v[156:159], v[112:127]
    v_rcp_f32 v74, v74
    v_rcp_f32 v75, v75
    v_mul_f32 v80, v80, v72
    v_mul_f32 v81, v81, v73
    v_mul_f32 v82, v82, v74
    v_mul_f32 v83, v83, v75
    s_add_u32 s13, s12, 401408
    s_mul_i32 s9, s10, 14336
    s_add_u32 s9, s9, s12
    s_lshl_b32 s11, s14, 11
    s_cmp_lt_u32 s4, 28
    s_cselect_b32 s58, s58, 0
    v_and_b32_e64 v2, 7, v0
    ds_read_b64_tr_b16 v[40:41], v10 offset:14336
    ds_read_b64_tr_b16 v[42:43], v10 offset:14848
    s_waitcnt lgkmcnt(6)
    v_mfma_f32_32x32x16_bf16 v[112:127], v[48:51], v[160:163], v[112:127]
    v_mul_f32 v76, v84, v84
    v_mul_f32 v77, v85, v85
    v_mul_f32 v78, v86, v86
    v_mul_f32_e64 v79, v87, v87
    v_fma_f32 v76, v76, v21, v20
    v_bfe_u32 v3, v0, 4, 1
    v_lshlrev_b32 v3, 2, v3
    v_xor_b32 v2, v2, v3
    v_lshlrev_b32 v2, 4, v2
    v_lshrrev_b32 v3, 3, v0
    v_mul_u32_u24 v3, 896, v3
    v_add_u32 v2, v2, v3
    v_add_u32 v3, 6144, v2
    ds_write_b32 v15, v64 offset:2048
    ds_read_b64_tr_b16 v[44:45], v10 offset:16384
    ds_read_b64_tr_b16 v[46:47], v10 offset:16896
    s_waitcnt lgkmcnt(7)
    v_mfma_f32_32x32x16_bf16 v[112:127], v[52:55], v[164:167], v[112:127]
    v_fma_f32 v77, v77, v21, v20
    v_fma_f32 v78, v78, v21, v20
    v_fma_f32 v79, v79, v21, v20
    v_mul_f32 v76, v76, v84
    v_mul_f32 v77, v77, v85
    v_mul_f32_e64 v78, v78, v86
    ds_read_b64_tr_b16 v[48:49], v10 offset:18432
    ds_read_b64_tr_b16 v[50:51], v10 offset:18944
    s_waitcnt lgkmcnt(7)
    v_mfma_f32_32x32x16_bf16 v[112:127], v[56:59], v[168:171], v[112:127]
    v_mul_f32 v79, v79, v87
    v_exp_f32 v76, v76
    v_exp_f32 v77, v77
    v_exp_f32_e64 v78, v78
    v_exp_f32 v79, v79
    s_waitcnt lgkmcnt(4)
    s_mov_b64 exec, 1
    ds_add_u32 v5, v9 offset:48
    s_mov_b64 exec, -1
    ds_read_b64_tr_b16 v[52:53], v10 offset:20480
    ds_read_b64_tr_b16 v[54:55], v10 offset:20992
    v_mfma_f32_32x32x16_bf16 v[112:127], v[40:43], v[172:175], v[112:127]
    v_fma_f32 v76, v76, v19, v19
    v_fma_f32 v77, v77, v19, v19
    v_fma_f32 v78, v78, v19, v19
    v_fma_f32 v79, v79, v19, v19
    v_rcp_f32_e64 v76, v76
    v_rcp_f32 v77, v77
    s_add_u32 m0, s11, 49152
    s_nop 0
    buffer_load_dwordx4 v2, s[56:59], s9 offen lds
    ds_read_b64_tr_b16 v[56:57], v10 offset:22528
    ds_read_b64_tr_b16 v[58:59], v10 offset:23040
    s_waitcnt lgkmcnt(7)
    v_mfma_f32_32x32x16_bf16 v[112:127], v[44:47], v[176:179], v[112:127]
    v_rcp_f32 v78, v78
    v_rcp_f32 v79, v79
    v_mul_f32 v84, v84, v76
    v_mul_f32 v85, v85, v77
    v_mul_f32 v86, v86, v78
    v_mul_f32 v87, v87, v79
    v_mov_b32 v23, s97
    s_waitcnt vmcnt(1)
    buffer_store_dword v23, off, s[48:51], s19 offset:0 sc1
    s_add_u32 m0, s11, 49152
    s_nop 0
    buffer_load_dwordx4 v3, s[56:59], s9 offen offset:1024 lds
    s_add_u32 s9, s9, 14336
    s_cmp_eq_u32 s9, s13
    s_cselect_b32 s9, s12, s9
    ds_read_b64_tr_b16 v[40:41], v10 offset:24576
    ds_read_b64_tr_b16 v[42:43], v10 offset:25088
    s_waitcnt lgkmcnt(7)
    v_mfma_f32_32x32x16_bf16 v[112:127], v[48:51], v[180:183], v[112:127]
    v_mul_f32 v72, v88, v88
    v_mul_f32 v73, v89, v89
    v_mul_f32 v74, v90, v90
    v_mul_f32_e64 v75, v91, v91
    v_fma_f32 v72, v72, v21, v20
    s_add_u32 m0, s11, 73728
    s_nop 0
    buffer_load_dwordx4 v2, s[56:59], s9 offen lds
    ds_read_b64_tr_b16 v[44:45], v10 offset:26624
    ds_read_b64_tr_b16 v[46:47], v10 offset:27136
    s_waitcnt lgkmcnt(6)
    v_mfma_f32_32x32x16_bf16 v[112:127], v[52:55], v[184:187], v[112:127]
    v_fma_f32 v73, v73, v21, v20
    v_fma_f32 v74, v74, v21, v20
    v_fma_f32 v75, v75, v21, v20
    v_mul_f32 v72, v72, v88
    v_mul_f32 v73, v73, v89
    v_mul_f32 v74, v74, v90
    s_add_u32 m0, s11, 73728
    s_nop 0
    buffer_load_dwordx4 v3, s[56:59], s9 offen offset:1024 lds
    s_add_u32 s9, s9, 14336
    s_cmp_eq_u32 s9, s13
    s_cselect_b32 s9, s12, s9
    ds_read_b64_tr_b16 v[48:49], v11 offset:26624
    ds_read_b64_tr_b16 v[50:51], v11 offset:27136
    s_waitcnt lgkmcnt(6)
    v_mfma_f32_32x32x16_bf16 v[112:127], v[56:59], v[188:191], v[112:127]
    v_mul_f32 v75, v75, v91
    v_exp_f32 v72, v72
    v_exp_f32 v73, v73
    v_exp_f32 v74, v74
    v_exp_f32 v75, v75
    s_add_u32 m0, s11, 143360
    s_nop 0
    buffer_load_dwordx4 v2, s[56:59], s9 offen lds
    ds_read_b64_tr_b16 v[52:53], v10 offset:28672
    ds_read_b64_tr_b16 v[54:55], v10 offset:29184
    s_waitcnt lgkmcnt(6)
    v_mfma_f32_32x32x16_bf16 v[112:127], v[40:43], v[192:195], v[112:127]
    v_fma_f32 v72, v72, v19, v19
    v_fma_f32 v73, v73, v19, v19
    v_fma_f32 v74, v74, v19, v19
    v_fma_f32 v75, v75, v19, v19
    v_rcp_f32_e64 v72, v72
    v_rcp_f32 v73, v73
    s_add_u32 m0, s11, 143360
    s_nop 0
    buffer_load_dwordx4 v3, s[56:59], s9 offen offset:1024 lds
    s_add_u32 s9, s9, 14336
    s_cmp_eq_u32 s9, s13
    s_cselect_b32 s9, s12, s9
    ds_read_b64_tr_b16 v[56:57], v11 offset:28672
    ds_read_b64_tr_b16 v[58:59], v11 offset:29184
    s_waitcnt lgkmcnt(6)
    v_mfma_f32_32x32x16_bf16 v[112:127], v[44:47], v[196:199], v[112:127]
    v_rcp_f32 v74, v74
    v_rcp_f32 v75, v75
    v_mul_f32 v88, v88, v72
    v_mul_f32 v89, v89, v73
    v_mul_f32 v90, v90, v74
    v_mul_f32 v91, v91, v75
    v_lshrrev_b32 v150, 5, v0
    v_bfe_u32 v151, v0, 2, 2
    v_lshl_add_u32 v144, v150, 3, v151
    v_lshlrev_b32_e64 v144, 7, v144
    v_lshrrev_b32 v151, 1, v151
    s_add_u32 m0, s11, 40960
    s_nop 0
    buffer_load_dwordx4 v2, s[56:59], s9 offen lds
    ds_read_b64_tr_b16 v[40:41], v10 offset:30720
    ds_read_b64_tr_b16 v[42:43], v10 offset:31232
    s_waitcnt lgkmcnt(6)
    v_mfma_f32_32x32x16_bf16 v[128:143], v[48:51], v[196:199], v[128:143]
    v_mul_f32 v76, v92, v92
    v_mul_f32 v77, v93, v93
    v_mul_f32 v78, v94, v94
    v_mul_f32_e64 v79, v95, v95
    v_fma_f32 v76, v76, v21, v20
    v_lshl_add_u32 v144, v151, 6, v144
    v_bfe_u32 v151, v0, 4, 1
    v_lshl_add_u32 v144, v151, 5, v144
    v_and_b32_e64 v151, 1, v0
    v_lshl_add_u32 v144, v151, 4, v144
    v_bfe_u32 v151, v0, 1, 1
    s_add_u32 m0, s11, 40960
    s_nop 0
    buffer_load_dwordx4 v3, s[56:59], s9 offen offset:1024 lds
    s_add_u32 s9, s9, 14336
    s_cmp_eq_u32 s9, s13
    s_cselect_b32 s9, s12, s9
    ds_read_b64_tr_b16 v[44:45], v11 offset:30720
    ds_read_b64_tr_b16 v[46:47], v11 offset:31232
    s_waitcnt lgkmcnt(6)
    v_mfma_f32_32x32x16_bf16 v[112:127], v[52:55], v[200:203], v[112:127]
    v_fma_f32 v77, v77, v21, v20
    v_fma_f32 v78, v78, v21, v20
    v_fma_f32 v79, v79, v21, v20
    v_mul_f32 v76, v76, v92
    v_mul_f32 v77, v77, v93
    v_mul_f32_e64 v78, v78, v94
    v_lshl_add_u32 v144, v151, 3, v144
    s_lshr_b32 s34, s14, 1
    s_lshl_b32 s34, s34, 6
    v_xor_b32_e64 v144, s34, v144
    s_lshl_b32 s34, s14, 11
    s_add_u32 s34, s34, 0
    ds_read_b64_tr_b16 v[48:49], v12 offset:0
    ds_read_b64_tr_b16 v[50:51], v12 offset:512
    s_waitcnt lgkmcnt(6)
    v_mfma_f32_32x32x16_bf16 v[128:143], v[56:59], v[200:203], v[128:143]
    v_mul_f32 v79, v79, v95
    v_exp_f32 v76, v76
    v_exp_f32 v77, v77
    v_exp_f32 v78, v78
    v_exp_f32 v79, v79
    v_add_u32 v144, s34, v144
    v_xor_b32 v145, 64, v144
    v_add_u32 v146, 0x10000, v144
    v_add_u32 v147, 0x10000, v145
    v_add_u32 v148, 0x20000, v144
    v_add_u32 v149, 0x20000, v145
    ds_read_b64_tr_b16 v[52:53], v14 offset:0
    ds_read_b64_tr_b16 v[54:55], v14 offset:512
    s_nop 0
    s_waitcnt lgkmcnt(6)
    v_mfma_f32_32x32x16_bf16 v[112:127], v[40:43], v[204:207], v[112:127]
    v_fma_f32 v76, v76, v19, v19
    v_fma_f32 v77, v77, v19, v19
    v_fma_f32 v78, v78, v19, v19
    v_fma_f32 v79, v79, v19, v19
    v_rcp_f32 v76, v76
    v_rcp_f32 v77, v77
    s_lshl_b32 s76, s4, 3
    s_add_u32 s76, s76, s5
    v_min_u32 v23, 12, v0
    v_lshlrev_b32 v23, 7, v23
    s_mul_i32 s77, s76, 1568
    buffer_load_dword v192, v23, s[60:63], s77 offen
    ds_read_b64_tr_b16 v[56:57], v12 offset:2048
    ds_read_b64_tr_b16 v[58:59], v12 offset:2560
    s_waitcnt lgkmcnt(6)
    v_mfma_f32_32x32x16_bf16 v[128:143], v[44:47], v[204:207], v[128:143]
    v_rcp_f32 v78, v78
    v_rcp_f32 v79, v79
    v_mul_f32 v92, v92, v76
    v_mul_f32 v93, v93, v77
    v_mul_f32 v94, v94, v78
    v_mul_f32_e64 v95, v95, v79
    ds_read_b64_tr_b16 v[40:41], v14 offset:2048
    ds_read_b64_tr_b16 v[42:43], v14 offset:2560
    s_waitcnt lgkmcnt(6)
    v_mfma_f32_32x32x16_bf16 v[112:127], v[48:51], v[208:211], v[112:127]
    v_mul_f32 v72, v96, v96
    v_mul_f32 v73, v97, v97
    v_mul_f32 v74, v98, v98
    v_mul_f32 v75, v99, v99
    v_fma_f32 v72, v72, v21, v20
    ds_read_b64_tr_b16 v[44:45], v12 offset:4096
    ds_read_b64_tr_b16 v[46:47], v12 offset:4608
    s_waitcnt lgkmcnt(6)
    v_mfma_f32_32x32x16_bf16 v[128:143], v[52:55], v[208:211], v[128:143]
    v_fma_f32 v73, v73, v21, v20
    v_fma_f32 v74, v74, v21, v20
    v_fma_f32 v75, v75, v21, v20
    v_mul_f32 v72, v72, v96
    v_mul_f32 v73, v73, v97
    v_mul_f32_e64 v74, v74, v98
    ds_read_b64_tr_b16 v[48:49], v14 offset:4096
    ds_read_b64_tr_b16 v[50:51], v14 offset:4608
    s_waitcnt lgkmcnt(6)
    v_mfma_f32_32x32x16_bf16 v[112:127], v[56:59], v[212:215], v[112:127]
    v_mul_f32 v75, v75, v99
    v_exp_f32 v72, v72
    v_exp_f32 v73, v73
    v_exp_f32_e64 v74, v74
    v_exp_f32 v75, v75
    ds_read_b64_tr_b16 v[52:53], v12 offset:6144
    ds_read_b64_tr_b16 v[54:55], v12 offset:6656
    s_waitcnt lgkmcnt(6)
    v_mfma_f32_32x32x16_bf16 v[128:143], v[40:43], v[212:215], v[128:143]
    v_fma_f32 v72, v72, v19, v19
    v_fma_f32 v73, v73, v19, v19
    v_fma_f32 v74, v74, v19, v19
    v_fma_f32 v75, v75, v19, v19
    v_rcp_f32 v72, v72
    v_rcp_f32 v73, v73
    ds_read_b64_tr_b16 v[56:57], v14 offset:6144
    ds_read_b64_tr_b16 v[58:59], v14 offset:6656
    s_waitcnt lgkmcnt(6)
    v_mfma_f32_32x32x16_bf16 v[112:127], v[44:47], v[216:219], v[112:127]
    v_rcp_f32 v74, v74
    v_rcp_f32 v75, v75
    v_mul_f32 v96, v96, v72
    v_mul_f32 v97, v97, v73
    v_mul_f32 v98, v98, v74
    v_mul_f32_e64 v99, v99, v75
    ds_read_b64_tr_b16 v[40:41], v12 offset:8192
    ds_read_b64_tr_b16 v[42:43], v12 offset:8704
    s_waitcnt lgkmcnt(6)
    v_mfma_f32_32x32x16_bf16 v[128:143], v[48:51], v[216:219], v[128:143]
    v_mul_f32 v76, v100, v100
    v_mul_f32 v77, v101, v101
    v_mul_f32 v78, v102, v102
    v_mul_f32 v79, v103, v103
    v_fma_f32 v76, v76, v21, v20
    ds_read_b64_tr_b16 v[44:45], v14 offset:8192
    ds_read_b64_tr_b16 v[46:47], v14 offset:8704
    s_waitcnt lgkmcnt(6)
    v_mfma_f32_32x32x16_bf16 v[112:127], v[52:55], v[220:223], v[112:127]
    v_fma_f32 v77, v77, v21, v20
    v_fma_f32 v78, v78, v21, v20
    v_fma_f32 v79, v79, v21, v20
    v_mul_f32 v76, v76, v100
    v_mul_f32 v77, v77, v101
    v_mul_f32_e64 v78, v78, v102
    ds_read_b64_tr_b16 v[48:49], v12 offset:10240
    ds_read_b64_tr_b16 v[50:51], v12 offset:10752
    s_waitcnt lgkmcnt(6)
    v_mfma_f32_32x32x16_bf16 v[128:143], v[56:59], v[220:223], v[128:143]
    v_mul_f32 v79, v79, v103
    v_exp_f32 v76, v76
    v_exp_f32 v77, v77
    v_exp_f32_e64 v78, v78
    v_exp_f32 v79, v79
    ds_read_b64_tr_b16 v[52:53], v14 offset:10240
    ds_read_b64_tr_b16 v[54:55], v14 offset:10752
    s_waitcnt lgkmcnt(6)
    v_mfma_f32_32x32x16_bf16 v[112:127], v[40:43], v[224:227], v[112:127]
    v_fma_f32 v76, v76, v19, v19
    v_fma_f32 v77, v77, v19, v19
    v_fma_f32 v78, v78, v19, v19
    v_fma_f32 v79, v79, v19, v19
    v_rcp_f32 v76, v76
    v_rcp_f32 v77, v77
    ds_read_b64_tr_b16 v[56:57], v12 offset:12288
    ds_read_b64_tr_b16 v[58:59], v12 offset:12800
    s_waitcnt lgkmcnt(6)
    v_mfma_f32_32x32x16_bf16 v[128:143], v[44:47], v[224:227], v[128:143]
    v_rcp_f32 v78, v78
    v_rcp_f32 v79, v79
    v_mul_f32 v100, v100, v76
    v_mul_f32 v101, v101, v77
    v_mul_f32 v102, v102, v78
    v_mul_f32_e64 v103, v103, v79
    ds_read_b64_tr_b16 v[40:41], v14 offset:12288
    ds_read_b64_tr_b16 v[42:43], v14 offset:12800
    s_waitcnt lgkmcnt(6)
    v_mfma_f32_32x32x16_bf16 v[112:127], v[48:51], v[228:231], v[112:127]
    s_mov_b32 s76, 200000
L_ll16:
    ds_read_b32 v23, v5 offset:48
    s_waitcnt lgkmcnt(0)
    v_readfirstlane_b32 s77, v23
    s_nop 0
    s_cmp_eq_u32 s77, 8
    s_cbranch_scc1 L_lk16
    s_sleep 1
    s_sub_u32 s76, s76, 1
    s_cbranch_scc0 L_ll16
L_lk16:
    ds_read_b128 v[216:219], v16 offset:2048
    ds_read_b128 v[220:223], v16 offset:2560
    s_waitcnt vmcnt(7)
    ds_read_b64_tr_b16 v[152:153], v144 offset:49152
    ds_read_b64_tr_b16 v[154:155], v144 offset:49664
    ds_read_b64_tr_b16 v[156:157], v145 offset:49152
    ds_read_b64_tr_b16 v[158:159], v145 offset:49664
    ds_read_b64_tr_b16 v[44:45], v12 offset:14336
    ds_read_b64_tr_b16 v[46:47], v12 offset:14848
    v_mfma_f32_32x32x16_bf16 v[128:143], v[52:55], v[228:231], v[128:143]
    v_mul_f32 v72, v104, v104
    v_mul_f32 v73, v105, v105
    v_mul_f32 v74, v106, v106
    v_mul_f32 v75, v107, v107
    v_fma_f32 v72, v72, v21, v20
    v_fma_f32 v73, v73, v21, v20
    s_waitcnt lgkmcnt(2)
    s_add_u32 m0, s11, 49152
    s_nop 0
    buffer_load_dwordx4 v2, s[56:59], s9 offen lds
    ds_read_b64_tr_b16 v[48:49], v14 offset:14336
    ds_read_b64_tr_b16 v[50:51], v14 offset:14848
    v_mfma_f32_32x32x16_bf16 v[112:127], v[56:59], v[232:235], v[112:127]
    v_fma_f32 v74, v74, v21, v20
    v_fma_f32 v75, v75, v21, v20
    v_mul_f32 v72, v72, v104
    v_mul_f32 v73, v73, v105
    v_mul_f32 v74, v74, v106
    v_mul_f32 v75, v75, v107
    v_exp_f32 v72, v72
    s_waitcnt vmcnt(6)
    ds_read_b64_tr_b16 v[160:161], v146 offset:8192
    ds_read_b64_tr_b16 v[162:163], v146 offset:8704
    ds_read_b64_tr_b16 v[164:165], v147 offset:8192
    ds_read_b64_tr_b16 v[166:167], v147 offset:8704
    s_add_u32 m0, s11, 49152
    s_nop 0
    s_nop 0
    buffer_load_dwordx4 v3, s[56:59], s9 offen offset:1024 lds
    s_add_u32 s9, s9, 14336
    s_cmp_eq_u32 s9, s13
    s_cselect_b32 s9, s12, s9
    ds_read_b64_tr_b16 v[52:53], v10 offset:32768
    ds_read_b64_tr_b16 v[54:55], v10 offset:33280
    v_mfma_f32_32x32x16_bf16 v[128:143], v[40:43], v[232:235], v[128:143]
    v_exp_f32 v73, v73
    v_add_f32 v216, v216, v217
    v_add_f32 v218, v218, v219
    v_add_f32 v216, v216, v218
    v_cvt_pk_bf16_f32 v217, v216, v216
    v_and_b32 v217, 0xffff0000, v217
    s_waitcnt lgkmcnt(2)
    s_add_u32 m0, s11, 73728
    s_nop 0
    buffer_load_dwordx4 v2, s[56:59], s9 offen lds
    ds_read_b64_tr_b16 v[56:57], v11 offset:32768
    ds_read_b64_tr_b16 v[58:59], v11 offset:33280
    v_mfma_f32_32x32x16_bf16 v[112:127], v[44:47], v[236:239], v[112:127]
    v_sub_f32_e64 v217, v216, v217
    v_cvt_pk_bf16_f32 v32, v216, v217
    v_cvt_pk_bf16_f32 v33, v216, v217
    v_add_f32 v220, v220, v221
    v_add_f32 v222, v222, v223
    v_add_f32 v220, v220, v222
    s_waitcnt vmcnt(6)
    ds_read_b64_tr_b16 v[168:169], v148 offset:12288
    ds_read_b64_tr_b16 v[170:171], v148 offset:12800
    ds_read_b64_tr_b16 v[172:173], v149 offset:12288
    ds_read_b64_tr_b16 v[174:175], v149 offset:12800
    s_add_u32 m0, s11, 73728
    s_nop 0
    s_nop 0
    buffer_load_dwordx4 v3, s[56:59], s9 offen offset:1024 lds
    s_add_u32 s9, s9, 14336
    s_cmp_eq_u32 s9, s13
    s_cselect_b32 s9, s12, s9
    ds_read_b64_tr_b16 v[40:41], v10 offset:34816
    ds_read_b64_tr_b16 v[42:43], v10 offset:35328
    v_mfma_f32_32x32x16_bf16 v[128:143], v[48:51], v[236:239], v[128:143]
    v_cvt_pk_bf16_f32 v221, v220, v220
    v_and_b32 v221, 0xffff0000, v221
    v_sub_f32 v221, v220, v221
    v_cvt_pk_bf16_f32 v36, v220, v221
    v_cvt_pk_bf16_f32 v37, v220, v221
    v_mfma_f32_32x32x16_bf16 v[112:127], v[32:35], v[28:31], v[112:127]
    s_nop 0
    v_mfma_f32_32x32x16_bf16 v[128:143], v[36:39], v[28:31], v[128:143]
    s_waitcnt lgkmcnt(2)
    s_add_u32 m0, s11, 143360
    s_nop 0
    buffer_load_dwordx4 v2, s[56:59], s9 offen lds
    ds_read_b64_tr_b16 v[44:45], v11 offset:34816
    ds_read_b64_tr_b16 v[46:47], v11 offset:35328
    v_mfma_f32_32x32x16_bf16 v[112:127], v[52:55], v[240:243], v[112:127]
    v_exp_f32 v74, v74
    v_exp_f32 v75, v75
    v_fma_f32 v72, v72, v19, v19
    v_fma_f32 v73, v73, v19, v19
    v_fma_f32 v74, v74, v19, v19
    v_fma_f32 v75, v75, v19, v19
    v_rcp_f32 v72, v72
    s_waitcnt vmcnt(6)
    ds_read_b64_tr_b16 v[176:177], v144 offset:40960
    ds_read_b64_tr_b16 v[178:179], v144 offset:41472
    ds_read_b64_tr_b16 v[180:181], v145 offset:40960
    ds_read_b64_tr_b16 v[182:183], v145 offset:41472
    s_add_u32 m0, s11, 143360
    s_nop 0
    s_nop 0
    buffer_load_dwordx4 v3, s[56:59], s9 offen offset:1024 lds
    s_add_u32 s9, s9, 14336
    s_cmp_eq_u32 s9, s13
    s_cselect_b32 s9, s12, s9
    ds_read_b64_tr_b16 v[48:49], v10 offset:36864
    ds_read_b64_tr_b16 v[50:51], v10 offset:37376
    v_mfma_f32_32x32x16_bf16 v[128:143], v[56:59], v[240:243], v[128:143]
    v_rcp_f32 v73, v73
    v_rcp_f32 v74, v74
    v_rcp_f32 v75, v75
    v_mul_f32 v104, v104, v72
    v_mul_f32 v105, v105, v73
    v_mul_f32 v106, v106, v74
    v_mul_f32_e64 v107, v107, v75
    s_waitcnt lgkmcnt(2)
    s_add_u32 m0, s11, 40960
    s_nop 0
    buffer_load_dwordx4 v2, s[56:59], s9 offen lds
    ds_read_b64_tr_b16 v[52:53], v11 offset:36864
    ds_read_b64_tr_b16 v[54:55], v11 offset:37376
    v_mfma_f32_32x32x16_bf16 v[112:127], v[40:43], v[244:247], v[112:127]
    v_mul_f32 v76, v108, v108
    v_mul_f32 v77, v109, v109
    v_mul_f32 v78, v110, v110
    v_mul_f32 v79, v111, v111
    v_fma_f32 v76, v76, v21, v20
    v_fma_f32 v77, v77, v21, v20
    v_fma_f32 v78, v78, v21, v20
    s_add_u32 m0, s11, 40960
    s_nop 0
    s_nop 0
    buffer_load_dwordx4 v3, s[56:59], s9 offen offset:1024 lds
    s_add_u32 s9, s9, 14336
    s_cmp_eq_u32 s9, s13
    s_cselect_b32 s9, s12, s9
    ds_read_b64_tr_b16 v[56:57], v10 offset:38912
    ds_read_b64_tr_b16 v[58:59], v10 offset:39424
    v_mfma_f32_32x32x16_bf16 v[128:143], v[44:47], v[244:247], v[128:143]
    v_fma_f32 v79, v79, v21, v20
    v_mul_f32 v76, v76, v108
    v_mul_f32 v77, v77, v109
    v_mul_f32 v78, v78, v110
    v_mul_f32 v79, v79, v111
    v_exp_f32 v76, v76
    v_exp_f32 v77, v77
    ds_read_b64_tr_b16 v[40:41], v11 offset:38912
    ds_read_b64_tr_b16 v[42:43], v11 offset:39424
    s_waitcnt lgkmcnt(6)
    v_mfma_f32_32x32x16_bf16 v[112:127], v[48:51], v[248:251], v[112:127]
    v_exp_f32 v78, v78
    v_exp_f32_e64 v79, v79
    v_fma_f32 v76, v76, v19, v19
    v_fma_f32 v77, v77, v19, v19
    v_fma_f32 v78, v78, v19, v19
    v_fma_f32 v79, v79, v19, v19
    v_rcp_f32 v76, v76
    s_waitcnt lgkmcnt(4)
    v_mfma_f32_32x32x16_bf16 v[128:143], v[52:55], v[248:251], v[128:143]
    s_waitcnt lgkmcnt(0)
    s_mov_b64 exec, 1
    ds_add_u32 v5, v9 offset:80
    s_mov_b64 exec, -1
    v_rcp_f32 v77, v77
    v_rcp_f32 v78, v78
    v_rcp_f32 v79, v79
    v_mul_f32 v108, v108, v76
    v_mul_f32 v109, v109, v77
    v_mul_f32 v110, v110, v78
    v_mul_f32 v111, v111, v79
    v_mfma_f32_32x32x16_bf16 v[112:127], v[56:59], v[252:255], v[112:127]
    v_mfma_f32_32x32x16_bf16 v[128:143], v[40:43], v[252:255], v[128:143]
    s_lshl_b32 s99, s8, 7
    s_lshl_b32 s34, s7, 2
    s_add_u32 s99, s99, s34
    s_add_u32 s99, s99, 18956288
    s_nop 6
    v_mul_f32 v80, v80, v112
    v_mul_f32 v81, v81, v113
    v_mul_f32 v82, v82, v114
    v_mul_f32 v83, v83, v115
    v_mul_f32 v84, v84, v116
    v_mul_f32 v85, v85, v117
    v_mul_f32 v86, v86, v118
    v_mul_f32 v87, v87, v119
    v_cvt_pk_bf16_f32 v80, v80, v81
    v_cvt_pk_bf16_f32 v81, v82, v83
    v_cvt_pk_bf16_f32 v82, v84, v85
    v_cvt_pk_bf16_f32 v83, v86, v87
    buffer_store_dwordx4 v[80:83], v1, s[48:51], s18 offen offset:0 sc1
    v_mul_f32 v88, v88, v120
    v_mul_f32 v89, v89, v121
    v_mul_f32 v90, v90, v122
    v_mul_f32 v91, v91, v123
    v_mul_f32 v92, v92, v124
    v_mul_f32 v93, v93, v125
    v_mul_f32 v94, v94, v126
    v_mul_f32 v95, v95, v127
    v_cvt_pk_bf16_f32 v88, v88, v89
    v_cvt_pk_bf16_f32 v89, v90, v91
    v_cvt_pk_bf16_f32 v90, v92, v93
    v_cvt_pk_bf16_f32 v91, v94, v95
    buffer_store_dwordx4 v[88:91], v1, s[48:51], s18 offen offset:1024 sc1
    v_mul_f32 v96, v96, v128
    v_mul_f32 v97, v97, v129
    v_mul_f32 v98, v98, v130
    v_mul_f32 v99, v99, v131
    v_mul_f32 v100, v100, v132
    v_mul_f32 v101, v101, v133
    v_mul_f32 v102, v102, v134
    v_mul_f32 v103, v103, v135
    v_cvt_pk_bf16_f32 v96, v96, v97
    v_cvt_pk_bf16_f32 v97, v98, v99
    v_cvt_pk_bf16_f32 v98, v100, v101
    v_cvt_pk_bf16_f32 v99, v102, v103
    buffer_store_dwordx4 v[96:99], v1, s[48:51], s18 offen offset:2048 sc1
    v_mul_f32 v104, v104, v136
    v_mul_f32 v105, v105, v137
    v_mul_f32 v106, v106, v138
    v_mul_f32 v107, v107, v139
    v_mul_f32 v108, v108, v140
    v_mul_f32 v109, v109, v141
    v_mul_f32 v110, v110, v142
    v_mul_f32 v111, v111, v143
    v_cvt_pk_bf16_f32 v104, v104, v105
    v_cvt_pk_bf16_f32 v105, v106, v107
    v_cvt_pk_bf16_f32 v106, v108, v109
    v_cvt_pk_bf16_f32 v107, v110, v111
    buffer_store_dwordx4 v[104:107], v1, s[48:51], s18 offen offset:3072 sc1
    s_branch L_gemm
L_a_B:
    s_sub_u32 s19, s7, 24
    s_mul_i32 s19, s19, 3
    s_add_u32 s19, s19, 8
    s_mov_b32 s34, s19
    s_mov_b32 s10, 0
    s_and_b32 s23, s34, 1
    s_mul_i32 s33, s34, 56
    s_add_u32 s10, s10, s33
    s_lshl_b32 s33, s23, 3
    s_sub_u32 s10, s10, s33
    s_lshl_b32 s12, s5, 10
    s_lshl_b32 s13, s5, 9
    s_add_u32 s13, s13, 8192
    s_lshl_b32 s33, s5, 6
    s_lshl_b32 s34, s5, 5
    s_add_u32 s34, s34, 512
    v_add_u32 v10, s33, v0
    v_mul_u32_u24 v11, 5462, v10
    v_lshrrev_b32 v11, 16, v11
    v_mul_u32_u24 v14, 12, v11
    v_sub_u32 v10, v10, v14
    v_min_u32 v10, 10, v10
    v_mul_u32_u24 v11, 2688, v11
    v_lshl_add_u32 v5, v10, 4, v11
    v_add_u32_e64 v10, s34, v0
    v_mul_u32_u24 v11, 5462, v10
    v_lshrrev_b32 v11, 16, v11
    v_mul_u32_u24 v14, 12, v11
    v_sub_u32 v10, v10, v14
    v_min_u32 v10, 10, v10
    v_mul_u32_u24 v11, 2688, v11
    v_lshl_add_u32 v4, v10, 4, v11
    s_mul_i32 s34, s90, 172032
    s_add_u32 m0, s12, 0
    s_add_u32 s34, s34, s10
    buffer_load_dwordx4 v5, s[44:47], s34 offen lds
    s_add_u32 m0, s13, 0
    s_mov_b64 exec, s[74:75]
    buffer_load_dwordx4 v4, s[44:47], s34 offen lds
    s_nop 0
    s_mov_b64 exec, -1
    s_load_dwordx2 s[48:49], s[0:1], 72
    s_load_dwordx2 s[40:41], s[0:1], 40
    s_load_dwordx2 s[56:57], s[0:1], 48
    s_load_dwordx2 s[60:61], s[0:1], 16
    s_load_dwordx2 s[64:65], s[0:1], 56
    v_lshlrev_b32 v1, 4, v0
    s_cmp_eq_u32 s15, 0
    s_cbranch_scc1 L_nosrB
    v_and_b32 v137, 31, v0
    v_cmp_gt_u32 vcc, 28, v137
    v_lshrrev_b32 v136, 5, v0
    v_mul_u32_u24 v136, 896, v136
    v_lshl_add_u32 v136, v137, 5, v136
    v_mov_b32 v137, 0x7fffff00
    v_cndmask_b32 v136, v137, v136, vcc
    s_lshl_b32 s98, s6, 8
    s_lshl_b32 s34, s7, 3
    s_add_u32 s98, s98, s34
    s_lshl_b32 s34, s14, 1
    s_add_u32 s98, s98, s34
    s_mul_i32 s33, s98, 896
    buffer_load_dwordx4 v[80:83], v136, s[52:55], s33 offen
    buffer_load_dwordx4 v[84:87], v136, s[52:55], s33 offen offset:16
L_nosrB:
    s_add_u32 s91, s90, 1
    s_cmp_ge_u32 s91, 7
    s_cselect_b32 s34, 7, 0
    s_sub_u32 s91, s91, s34
    s_add_u32 s92, s90, 2
    s_cmp_ge_u32 s92, 7
    s_cselect_b32 s34, 7, 0
    s_sub_u32 s92, s92, s34
    s_add_u32 s93, s90, 3
    s_cmp_ge_u32 s93, 7
    s_cselect_b32 s34, 7, 0
    s_sub_u32 s93, s93, s34
    s_add_u32 s94, s90, 4
    s_cmp_ge_u32 s94, 7
    s_cselect_b32 s34, 7, 0
    s_sub_u32 s94, s94, s34
    s_add_u32 s95, s90, 5
    s_cmp_ge_u32 s95, 7
    s_cselect_b32 s34, 7, 0
    s_sub_u32 s95, s95, s34
    s_add_u32 s96, s90, 6
    s_cmp_ge_u32 s96, 7
    s_cselect_b32 s34, 7, 0
    s_sub_u32 s96, s96, s34
    s_mov_b32 s70, 256
    s_mov_b32 s71, 0x00020000
    s_mov_b32 s50, 19922944
    s_mov_b32 s51, 0x00020000
    s_mov_b32 s42, 1605632
    s_mov_b32 s43, 0x00020000
    s_mov_b32 s58, 1605632
    s_mov_b32 s59, 0x00020000
    s_mov_b32 s62, 401408
    s_mov_b32 s63, 0x00020000
    s_mov_b32 s66, 1835008
    s_mov_b32 s67, 0x00020000
    v_and_b32_e64 v6, 31, v0
    v_bfe_u32 v7, v0, 1, 3
    v_lshrrev_b32 v17, 5, v0
    v_xor_b32 v7, v7, v17
    v_lshlrev_b32_e64 v7, 4, v7
    v_lshl_add_u32 v6, v6, 7, v7
    v_add_u32 v6, s17, v6
    v_xor_b32 v7, 32, v6
    v_xor_b32_e64 v8, 64, v6
    v_xor_b32 v9, 96, v6
    v_and_b32_e64 v18, 3, v12
    v_lshl_add_u32 v17, v17, 3, v18
    v_bfe_u32 v19, v0, 4, 1
    v_lshl_add_u32 v20, v19, 2, v13
    v_and_b32 v21, 1, v13
    v_lshlrev_b32 v21, 1, v21
    v_lshl_add_u32 v21, v19, 2, v21
    v_lshrrev_b32 v22, 1, v13
    v_add_u32 v21, v21, v22
    v_lshlrev_b32 v21, 3, v21
    v_add_u32 v10, s23, v20
    v_lshlrev_b32_e64 v10, 3, v10
    v_mul_u32_u24 v11, 192, v17
    v_add_u32 v10, v10, v11
    v_add_u32 v11, 56, v10
    v_add_u32 v12, 112, v10
    s_mul_i32 s35, s14, 3072
    s_mul_i32 s34, s15, 56
    s_add_u32 s34, s34, s35
    v_add_u32_e64 v13, s34, v10
    v_lshl_add_u32 v39, v17, 6, v21
    s_mul_i32 s34, s14, 3072
    s_mul_i32 s35, s15, 12288
    s_add_u32 s34, s34, s35
    v_add_u32 v14, s34, v12
    v_bfe_u32 v19, v0, 2, 1
    v_bfe_u32 v20, v0, 4, 1
    v_xor_b32 v19, v19, v20
    v_and_b32 v20, 3, v0
    v_or_b32 v19, v19, v20
    v_cmp_eq_u32 vcc, 0, v19
    v_mov_b32 v20, 0x3f803f80
    v_and_b32 v19, 31, v0
    v_cndmask_b32 v24, 0, v20, vcc
    v_cmp_eq_u32 vcc, 28, v19
    v_mov_b32 v25, v24
    v_mov_b32 v26, v24
    v_cndmask_b32 v17, 0, v20, vcc
    v_mov_b32 v27, v24
    v_lshlrev_b32 v16, 4, v19
    v_add_u32 v16, 151552, v16
    s_lshl_b32 s34, s14, 2
    s_lshl_b32 s35, s15, 9
    s_add_u32 s34, s34, s35
    v_add_u32 v15, s34, v16
    s_mov_b32 s72, 0
    s_mov_b32 s73, -1
    v_mov_b32 v30, 0
    v_mov_b32 v31, 0
    v_mov_b32 v34, 0
    v_mov_b32 v35, 0
    v_mov_b32_e64 v38, 0
    v_mov_b32 v22, 156672
    v_add_u32_e64 v22, v22, v1
    ds_write_b32 v22, v30
    s_add_u32 s34, s19, 0
    s_lshr_b32 s35, s34, 4
    s_and_b32 s34, s34, 15
    s_lshl_b32 s20, s35, 21
    s_lshl_b32 s34, s34, 17
    s_add_u32 s20, s20, s34
    s_lshl_b32 s34, s8, 11
    s_add_u32 s20, s20, s34
    s_add_u32 s20, s20, 2097152
    s_cmp_eq_u32 s35, 0
    s_cselect_b32 s26, 0x3f80, 0
    s_add_u32 s34, s19, 1
    s_lshr_b32 s35, s34, 4
    s_and_b32 s34, s34, 15
    s_lshl_b32 s21, s35, 21
    s_lshl_b32 s34, s34, 17
    s_add_u32 s21, s21, s34
    s_lshl_b32 s34, s8, 11
    s_add_u32 s21, s21, s34
    s_add_u32 s21, s21, 2097152
    s_cmp_eq_u32 s35, 0
    s_cselect_b32 s27, 0x3f80, 0
    s_add_u32 s34, s19, 2
    s_lshr_b32 s35, s34, 4
    s_and_b32 s34, s34, 15
    s_lshl_b32 s22, s35, 21
    s_lshl_b32 s34, s34, 17
    s_add_u32 s22, s22, s34
    s_lshl_b32 s34, s8, 11
    s_add_u32 s22, s22, s34
    s_add_u32 s22, s22, 2097152
    s_cmp_eq_u32 s35, 0
    s_cselect_b32 s28, 0x3f80, 0
    s_lshl_b32 s19, s19, 8
    s_lshl_b32 s34, s8, 2
    s_add_u32 s19, s19, s34
    s_add_u32 s19, s19, 18939904
    s_sub_u32 s18, s7, 24
    s_lshl_b32 s18, s18, 11
    s_add_u32 s18, s18, 98304
    s_mul_i32 s34, s8, 114688
    s_add_u32 s18, s18, s34
    s_add_u32 s18, s18, 8388608
    s_cmp_eq_u32 s15, 0
    s_cbranch_scc1 L_x0b17
    s_lshl_b32 s32, s90, 7
    s_add_u32 m0, s17, 0
    s_add_u32 s32, s32, s16
    buffer_load_dwordx4 v2, s[52:55], s32 offen lds
    s_add_u32 m0, s17, 1024
    s_add_u32 s32, s32, 7168
    buffer_load_dwordx4 v3, s[52:55], s32 offen lds
    s_add_u32 m0, s17, 2048
    s_add_u32 s32, s32, 7168
    buffer_load_dwordx4 v2, s[52:55], s32 offen lds
    s_add_u32 m0, s17, 3072
    s_add_u32 s32, s32, 7168
    buffer_load_dwordx4 v3, s[52:55], s32 offen lds
L_x0b17:
    s_mul_i32 s34, s91, 172032
    s_add_u32 m0, s12, 12288
    s_add_u32 s34, s34, s10
    buffer_load_dwordx4 v5, s[44:47], s34 offen lds
    s_add_u32 m0, s13, 12288
    s_mov_b64 exec, s[74:75]
    buffer_load_dwordx4 v4, s[44:47], s34 offen lds
    s_mov_b64 exec, -1
    s_cmp_eq_u32 s15, 0
    s_cbranch_scc1 L_x0b18
    s_waitcnt vmcnt(8) lgkmcnt(0)
    s_branch L_x0c18
L_x0b18:
    s_waitcnt vmcnt(2) lgkmcnt(0)
L_x0c18:
    s_barrier
    s_cmp_eq_u32 s15, 0
    s_cbranch_scc1 L_st19
    s_waitcnt vmcnt(6)
    v_lshlrev_b32_e64 v96, 16, v80
    v_and_b32 v97, 0xffff0000, v80
    v_lshlrev_b32_e64 v98, 16, v81
    v_and_b32 v99, 0xffff0000, v81
    v_lshlrev_b32_e64 v100, 16, v82
    v_and_b32 v101, 0xffff0000, v82
    v_lshlrev_b32_e64 v102, 16, v83
    v_and_b32 v103, 0xffff0000, v83
    v_lshlrev_b32_e64 v104, 16, v84
    v_and_b32 v105, 0xffff0000, v84
    v_lshlrev_b32_e64 v106, 16, v85
    v_and_b32 v107, 0xffff0000, v85
    v_lshlrev_b32_e64 v108, 16, v86
    v_and_b32 v109, 0xffff0000, v86
    v_lshlrev_b32_e64 v110, 16, v87
    v_and_b32 v111, 0xffff0000, v87
    v_add_f32 v128, v96, v97
    v_mul_f32 v129, v96, v96
    v_fmac_f32 v129, v97, v97
    v_add_f32 v128, v128, v98
    v_fmac_f32 v129, v98, v98
    v_add_f32 v128, v128, v99
    v_fmac_f32 v129, v99, v99
    v_add_f32 v128, v128, v100
    v_fmac_f32 v129, v100, v100
    v_add_f32 v128, v128, v101
    v_fmac_f32 v129, v101, v101
    v_add_f32 v128, v128, v102
    v_fmac_f32 v129, v102, v102
    v_add_f32 v128, v128, v103
    v_fmac_f32 v129, v103, v103
    v_add_f32 v128, v128, v104
    v_fmac_f32 v129, v104, v104
    v_add_f32 v128, v128, v105
    v_fmac_f32 v129, v105, v105
    v_add_f32 v128, v128, v106
    v_fmac_f32 v129, v106, v106
    v_add_f32 v128, v128, v107
    v_fmac_f32 v129, v107, v107
    v_add_f32 v128, v128, v108
    v_fmac_f32 v129, v108, v108
    v_add_f32 v128, v128, v109
    v_fmac_f32 v129, v109, v109
    v_add_f32 v128, v128, v110
    v_fmac_f32 v129, v110, v110
    v_add_f32 v128, v128, v111
    v_fmac_f32 v129, v111, v111
    s_nop 0
    v_add_f32_dpp v128, v128, v128 quad_perm:[1,0,3,2] row_mask:0xf bank_mask:0xf
    v_add_f32_dpp v129, v129, v129 quad_perm:[1,0,3,2] row_mask:0xf bank_mask:0xf
    s_nop 0
    v_add_f32_dpp v128, v128, v128 quad_perm:[2,3,0,1] row_mask:0xf bank_mask:0xf
    v_add_f32_dpp v129, v129, v129 quad_perm:[2,3,0,1] row_mask:0xf bank_mask:0xf
    s_nop 0
    v_add_f32_dpp v128, v128, v128 row_half_mirror row_mask:0xf bank_mask:0xf
    v_add_f32_dpp v129, v129, v129 row_half_mirror row_mask:0xf bank_mask:0xf
    s_nop 0
    v_add_f32_dpp v128, v128, v128 row_mirror row_mask:0xf bank_mask:0xf
    v_add_f32_dpp v129, v129, v129 row_mirror row_mask:0xf bank_mask:0xf
    v_mov_b32 v130, v128
    v_mov_b32_e64 v131, v129
    s_mov_b32 s76, 0x3b124925
    v_permlane16_swap_b32 v128, v130
    v_permlane16_swap_b32 v129, v131
    v_add_f32 v128, v128, v130
    v_add_f32 v129, v129, v131
    v_mul_f32 v128, s76, v128
    v_mul_f32 v129, s76, v129
    v_fma_f32 v129, -v128, v128, v129
    v_max_f32_e64 v129, 0, v129
    v_add_f32 v129, 0x3727c5ac, v129
    s_lshl_b32 s98, s98, 4
    s_add_u32 s98, s98, 18874368
L_st19:
    s_waitcnt vmcnt(2)
    ds_read_b128 v[144:147], v6 offset:0
    ds_read_b128 v[148:151], v7 offset:0
    ds_read_b128 v[152:155], v8 offset:0
    ds_read_b128 v[156:159], v9 offset:0
    ds_read_b64_tr_b16 v[40:41], v10 offset:0
    ds_read_b64_tr_b16 v[42:43], v10 offset:768
    ds_read_b64_tr_b16 v[44:45], v11 offset:0
    ds_read_b64_tr_b16 v[46:47], v11 offset:768
    ds_read_b64_tr_b16 v[48:49], v12 offset:0
    ds_read_b64_tr_b16 v[50:51], v12 offset:768
    s_waitcnt lgkmcnt(0)
    v_mfma_f32_32x32x16_bf16 v[80:95], v[40:43], v[144:147], 0
    s_lshl_b32 s32, s91, 7
    s_add_u32 m0, s17, 32768
    s_nop 0
    s_add_u32 s32, s32, s16
    buffer_load_dwordx4 v2, s[52:55], s32 offen lds
    ds_read_b64_tr_b16 v[52:53], v10 offset:3072
    ds_read_b64_tr_b16 v[54:55], v10 offset:3840
    v_mfma_f32_32x32x16_bf16 v[96:111], v[44:47], v[144:147], 0
    s_add_u32 m0, s17, 33792
    s_add_u32 s32, s32, 7168
    buffer_load_dwordx4 v3, s[52:55], s32 offen lds
    ds_read_b64_tr_b16 v[56:57], v11 offset:3072
    ds_read_b64_tr_b16 v[58:59], v11 offset:3840
    v_mfma_f32_32x32x16_bf16 v[112:127], v[48:51], v[144:147], 0
    s_add_u32 m0, s17, 34816
    s_add_u32 s32, s32, 7168
    buffer_load_dwordx4 v2, s[52:55], s32 offen lds
    ds_read_b64_tr_b16 v[60:61], v12 offset:3072
    ds_read_b64_tr_b16 v[62:63], v12 offset:3840
    ds_read_b64_tr_b16 v[72:73], v13 offset:0
    ds_read_b64_tr_b16 v[74:75], v13 offset:768
    s_nop 0
    s_waitcnt lgkmcnt(2)
    v_mfma_f32_32x32x16_bf16 v[80:95], v[52:55], v[148:151], v[80:95]
    s_add_u32 m0, s17, 35840
    s_add_u32 s32, s32, 7168
    buffer_load_dwordx4 v3, s[52:55], s32 offen lds
    ds_read_b64_tr_b16 v[40:41], v10 offset:6144
    ds_read_b64_tr_b16 v[42:43], v10 offset:6912
    v_mfma_f32_32x32x16_bf16 v[96:111], v[56:59], v[148:151], v[96:111]
    s_mul_i32 s34, s92, 172032
    s_add_u32 m0, s12, 24576
    s_add_u32 s34, s34, s10
    buffer_load_dwordx4 v5, s[44:47], s34 offen lds
    ds_read_b64_tr_b16 v[44:45], v11 offset:6144
    ds_read_b64_tr_b16 v[46:47], v11 offset:6912
    s_waitcnt lgkmcnt(4)
    v_mfma_f32_16x16x32_bf16 v[64:67], v[24:27], v[72:75], 0
    v_mfma_f32_32x32x16_bf16 v[112:127], v[60:63], v[148:151], v[112:127]
    s_add_u32 m0, s13, 24576
    s_mov_b64 exec, s[74:75]
    buffer_load_dwordx4 v4, s[44:47], s34 offen lds
    s_mov_b64 exec, -1
    ds_read_b64_tr_b16 v[48:49], v12 offset:6144
    ds_read_b64_tr_b16 v[50:51], v12 offset:6912
    s_waitcnt lgkmcnt(0)
    v_mfma_f32_32x32x16_bf16 v[80:95], v[40:43], v[152:155], v[80:95]
    s_lshl_b32 s32, s92, 7
    s_add_u32 m0, s17, 0
    s_add_u32 s32, s32, s16
    buffer_load_dwordx4 v2, s[52:55], s32 offen lds
    s_add_u32 m0, s17, 1024
    s_add_u32 s32, s32, 7168
    buffer_load_dwordx4 v3, s[52:55], s32 offen lds
    s_add_u32 m0, s17, 2048
    s_add_u32 s32, s32, 7168
    buffer_load_dwordx4 v2, s[52:55], s32 offen lds
    s_add_u32 m0, s17, 3072
    s_add_u32 s32, s32, 7168
    buffer_load_dwordx4 v3, s[52:55], s32 offen lds
    ds_read_b64_tr_b16 v[52:53], v10 offset:9216
    ds_read_b64_tr_b16 v[54:55], v10 offset:9984
    v_mfma_f32_32x32x16_bf16 v[96:111], v[44:47], v[152:155], v[96:111]
    ds_read_b64_tr_b16 v[56:57], v11 offset:9216
    ds_read_b64_tr_b16 v[58:59], v11 offset:9984
    v_mfma_f32_32x32x16_bf16 v[112:127], v[48:51], v[152:155], v[112:127]
    ds_read_b64_tr_b16 v[60:61], v12 offset:9216
    ds_read_b64_tr_b16 v[62:63], v12 offset:9984
    s_waitcnt vmcnt(10)
    s_barrier
    s_waitcnt lgkmcnt(0)
    v_mfma_f32_32x32x16_bf16 v[80:95], v[52:55], v[156:159], v[80:95]
    s_waitcnt vmcnt(6)
    ds_read_b128 v[160:163], v6 offset:32768
    ds_read_b128 v[164:167], v7 offset:32768
    v_mfma_f32_32x32x16_bf16 v[96:111], v[56:59], v[156:159], v[96:111]
    ds_read_b128 v[168:171], v8 offset:32768
    ds_read_b128 v[172:175], v9 offset:32768
    ds_read_b64_tr_b16 v[40:41], v10 offset:12288
    ds_read_b64_tr_b16 v[42:43], v10 offset:13056
    v_mfma_f32_32x32x16_bf16 v[112:127], v[60:63], v[156:159], v[112:127]
    s_lshl_b32 s78, s2, 3
    s_add_u32 s78, s78, s5
    v_min_u32 v23, 6, v0
    v_lshlrev_b32 v23, 7, v23
    s_mul_i32 s79, s78, 784
    buffer_load_dword v143, v23, s[40:43], s79 offen
    s_lshr_b32 s79, s78, 2
    s_mul_i32 s79, s79, 3584
    s_and_b32 s78, s78, 3
    s_lshl_b32 s78, s78, 7
    s_add_u32 s79, s79, s78
    s_add_u32 s79, s79, 3072
    buffer_load_dword v143, off, s[36:39], s79
    ds_read_b64_tr_b16 v[44:45], v11 offset:12288
    ds_read_b64_tr_b16 v[46:47], v11 offset:13056
    ds_read_b64_tr_b16 v[48:49], v12 offset:12288
    ds_read_b64_tr_b16 v[50:51], v12 offset:13056
    s_waitcnt lgkmcnt(0)
    v_mfma_f32_32x32x16_bf16 v[80:95], v[40:43], v[160:163], v[80:95]
    s_mul_i32 s34, s93, 172032
    s_add_u32 m0, s12, 36864
    s_add_u32 s34, s34, s10
    buffer_load_dwordx4 v5, s[44:47], s34 offen lds
    ds_read_b64_tr_b16 v[52:53], v10 offset:15360
    ds_read_b64_tr_b16 v[54:55], v10 offset:16128
    v_mfma_f32_32x32x16_bf16 v[96:111], v[44:47], v[160:163], v[96:111]
    ds_read_b64_tr_b16 v[56:57], v11 offset:15360
    ds_read_b64_tr_b16 v[58:59], v11 offset:16128
    v_mfma_f32_32x32x16_bf16 v[112:127], v[48:51], v[160:163], v[112:127]
    s_add_u32 m0, s13, 36864
    s_mov_b64 exec, s[74:75]
    buffer_load_dwordx4 v4, s[44:47], s34 offen lds
    s_mov_b64 exec, -1
    ds_read_b64_tr_b16 v[60:61], v12 offset:15360
    ds_read_b64_tr_b16 v[62:63], v12 offset:16128
    ds_read_b64_tr_b16 v[72:73], v13 offset:12288
    ds_read_b64_tr_b16 v[74:75], v13 offset:13056
    ds_read_b64_tr_b16 v[76:77], v14 offset:0
    ds_read_b64_tr_b16 v[78:79], v14 offset:768
    s_nop 0
    s_waitcnt lgkmcnt(4)
    v_mfma_f32_32x32x16_bf16 v[80:95], v[52:55], v[164:167], v[80:95]
    buffer_load_dword v138, off, s[68:71], 0 sc1
    ds_read_b64_tr_b16 v[40:41], v10 offset:18432
    ds_read_b64_tr_b16 v[42:43], v10 offset:19200
    v_mfma_f32_32x32x16_bf16 v[96:111], v[56:59], v[164:167], v[96:111]
    s_lshl_b32 s32, s93, 7
    s_add_u32 m0, s17, 32768
    s_add_u32 s32, s32, s16
    buffer_load_dwordx4 v2, s[52:55], s32 offen lds
    s_add_u32 m0, s17, 33792
    s_add_u32 s32, s32, 7168
    buffer_load_dwordx4 v3, s[52:55], s32 offen lds
    s_add_u32 m0, s17, 34816
    s_add_u32 s32, s32, 7168
    buffer_load_dwordx4 v2, s[52:55], s32 offen lds
    s_add_u32 m0, s17, 35840
    s_add_u32 s32, s32, 7168
    buffer_load_dwordx4 v3, s[52:55], s32 offen lds
    ds_read_b64_tr_b16 v[44:45], v11 offset:18432
    ds_read_b64_tr_b16 v[46:47], v11 offset:19200
    s_nop 0
    s_waitcnt lgkmcnt(6)
    v_mfma_f32_16x16x32_bf16 v[64:67], v[24:27], v[72:75], v[64:67]
    v_mfma_f32_32x32x16_bf16 v[112:127], v[60:63], v[164:167], v[112:127]
    ds_read_b64_tr_b16 v[48:49], v12 offset:18432
    ds_read_b64_tr_b16 v[50:51], v12 offset:19200
    s_waitcnt lgkmcnt(6)
    v_mfma_f32_16x16x32_bf16 v[68:71], v[24:27], v[76:79], 0
    s_waitcnt lgkmcnt(0)
    v_mfma_f32_32x32x16_bf16 v[80:95], v[40:43], v[168:171], v[80:95]
    ds_read_b64_tr_b16 v[52:53], v10 offset:21504
    ds_read_b64_tr_b16 v[54:55], v10 offset:22272
    v_mfma_f32_32x32x16_bf16 v[96:111], v[44:47], v[168:171], v[96:111]
    ds_read_b64_tr_b16 v[56:57], v11 offset:21504
    ds_read_b64_tr_b16 v[58:59], v11 offset:22272
    v_mfma_f32_32x32x16_bf16 v[112:127], v[48:51], v[168:171], v[112:127]
    ds_read_b64_tr_b16 v[60:61], v12 offset:21504
    ds_read_b64_tr_b16 v[62:63], v12 offset:22272
    s_waitcnt vmcnt(13)
    s_barrier
    s_waitcnt lgkmcnt(0)
    v_mfma_f32_32x32x16_bf16 v[80:95], v[52:55], v[172:175], v[80:95]
    s_waitcnt vmcnt(9)
    ds_read_b128 v[176:179], v6 offset:0
    ds_read_b128 v[180:183], v7 offset:0
    v_mfma_f32_32x32x16_bf16 v[96:111], v[56:59], v[172:175], v[96:111]
    ds_read_b128 v[184:187], v8 offset:0
    ds_read_b128 v[188:191], v9 offset:0
    ds_read_b64_tr_b16 v[40:41], v10 offset:24576
    ds_read_b64_tr_b16 v[42:43], v10 offset:25344
    v_mfma_f32_32x32x16_bf16 v[112:127], v[60:63], v[172:175], v[112:127]
    ds_read_b64_tr_b16 v[44:45], v11 offset:24576
    ds_read_b64_tr_b16 v[46:47], v11 offset:25344
    ds_read_b64_tr_b16 v[48:49], v12 offset:24576
    ds_read_b64_tr_b16 v[50:51], v12 offset:25344
    s_waitcnt lgkmcnt(0)
    v_mfma_f32_32x32x16_bf16 v[80:95], v[40:43], v[176:179], v[80:95]
    s_mul_i32 s34, s94, 172032
    s_add_u32 m0, s12, 49152
    s_add_u32 s34, s34, s10
    buffer_load_dwordx4 v5, s[44:47], s34 offen lds
    ds_read_b64_tr_b16 v[52:53], v10 offset:27648
    ds_read_b64_tr_b16 v[54:55], v10 offset:28416
    v_mfma_f32_32x32x16_bf16 v[96:111], v[44:47], v[176:179], v[96:111]
    ds_read_b64_tr_b16 v[56:57], v11 offset:27648
    ds_read_b64_tr_b16 v[58:59], v11 offset:28416
    v_mfma_f32_32x32x16_bf16 v[112:127], v[48:51], v[176:179], v[112:127]
    s_add_u32 m0, s13, 49152
    s_mov_b64 exec, s[74:75]
    buffer_load_dwordx4 v4, s[44:47], s34 offen lds
    s_mov_b64 exec, -1
    ds_read_b64_tr_b16 v[60:61], v12 offset:27648
    ds_read_b64_tr_b16 v[62:63], v12 offset:28416
    ds_read_b64_tr_b16 v[72:73], v13 offset:24576
    ds_read_b64_tr_b16 v[74:75], v13 offset:25344
    s_waitcnt lgkmcnt(2)
    v_mfma_f32_32x32x16_bf16 v[80:95], v[52:55], v[180:183], v[80:95]
    ds_read_b64_tr_b16 v[40:41], v10 offset:30720
    ds_read_b64_tr_b16 v[42:43], v10 offset:31488
    v_mfma_f32_32x32x16_bf16 v[96:111], v[56:59], v[180:183], v[96:111]
    s_lshl_b32 s32, s94, 7
    s_add_u32 m0, s17, 0
    s_add_u32 s32, s32, s16
    buffer_load_dwordx4 v2, s[52:55], s32 offen lds
    s_add_u32 m0, s17, 1024
    s_add_u32 s32, s32, 7168
    buffer_load_dwordx4 v3, s[52:55], s32 offen lds
    s_add_u32 m0, s17, 2048
    s_add_u32 s32, s32, 7168
    buffer_load_dwordx4 v2, s[52:55], s32 offen lds
    s_add_u32 m0, s17, 3072
    s_add_u32 s32, s32, 7168
    buffer_load_dwordx4 v3, s[52:55], s32 offen lds
    ds_read_b64_tr_b16 v[44:45], v11 offset:30720
    ds_read_b64_tr_b16 v[46:47], v11 offset:31488
    s_waitcnt lgkmcnt(4)
    v_mfma_f32_16x16x32_bf16 v[64:67], v[24:27], v[72:75], v[64:67]
    v_mfma_f32_32x32x16_bf16 v[112:127], v[60:63], v[180:183], v[112:127]
    s_waitcnt vmcnt(10)
    v_readfirstlane_b32 s97, v138
    s_nop 0
    s_cmp_lg_u32 s97, 0
    s_cbranch_scc1 L_nok20
    s_mov_b32 s76, 200000
L_nlp20:
    s_sleep 1
    buffer_load_dword v138, off, s[68:71], 0 sc1
    s_waitcnt vmcnt(0)
    v_readfirstlane_b32 s97, v138
    s_nop 0
    s_cmp_lg_u32 s97, 0
    s_cbranch_scc1 L_nok20
    s_sub_u32 s76, s76, 1
    s_cbranch_scc0 L_nlp20
L_nok20:
    s_cmp_eq_u32 s15, 0
    s_cbranch_scc1 L_nos20
    v_lshrrev_b32 v136, 5, v0
    v_lshlrev_b32 v136, 4, v136
    v_mov_b32_e64 v130, s97
    v_mov_b32 v131, s97
    buffer_store_dwordx4 v[128:131], v136, s[48:51], s98 offen sc1
L_nos20:
    ds_read_b64_tr_b16 v[48:49], v12 offset:30720
    ds_read_b64_tr_b16 v[50:51], v12 offset:31488
    s_waitcnt lgkmcnt(0)
    v_mfma_f32_32x32x16_bf16 v[80:95], v[40:43], v[184:187], v[80:95]
    ds_read_b64_tr_b16 v[52:53], v10 offset:33792
    ds_read_b64_tr_b16 v[54:55], v10 offset:34560
    v_mfma_f32_32x32x16_bf16 v[96:111], v[44:47], v[184:187], v[96:111]
    ds_read_b64_tr_b16 v[56:57], v11 offset:33792
    ds_read_b64_tr_b16 v[58:59], v11 offset:34560
    v_mfma_f32_32x32x16_bf16 v[112:127], v[48:51], v[184:187], v[112:127]
    ds_read_b64_tr_b16 v[60:61], v12 offset:33792
    ds_read_b64_tr_b16 v[62:63], v12 offset:34560
    s_barrier
    s_waitcnt lgkmcnt(0)
    v_mfma_f32_32x32x16_bf16 v[80:95], v[52:55], v[188:191], v[80:95]
    s_nop 0
    s_waitcnt vmcnt(6)
    ds_read_b128 v[192:195], v6 offset:32768
    ds_read_b128 v[196:199], v7 offset:32768
    v_mfma_f32_32x32x16_bf16 v[96:111], v[56:59], v[188:191], v[96:111]
    ds_read_b128 v[200:203], v8 offset:32768
    ds_read_b128 v[204:207], v9 offset:32768
    ds_read_b64_tr_b16 v[40:41], v10 offset:36864
    ds_read_b64_tr_b16 v[42:43], v10 offset:37632
    v_mfma_f32_32x32x16_bf16 v[112:127], v[60:63], v[188:191], v[112:127]
    ds_read_b64_tr_b16 v[44:45], v11 offset:36864
    ds_read_b64_tr_b16 v[46:47], v11 offset:37632
    ds_read_b64_tr_b16 v[48:49], v12 offset:36864
    ds_read_b64_tr_b16 v[50:51], v12 offset:37632
    s_waitcnt lgkmcnt(0)
    v_mfma_f32_32x32x16_bf16 v[80:95], v[40:43], v[192:195], v[80:95]
    s_mul_i32 s34, s95, 172032
    s_add_u32 m0, s12, 61440
    s_add_u32 s34, s34, s10
    buffer_load_dwordx4 v5, s[44:47], s34 offen lds
    ds_read_b64_tr_b16 v[52:53], v10 offset:39936
    ds_read_b64_tr_b16 v[54:55], v10 offset:40704
    v_mfma_f32_32x32x16_bf16 v[96:111], v[44:47], v[192:195], v[96:111]
    ds_read_b64_tr_b16 v[56:57], v11 offset:39936
    ds_read_b64_tr_b16 v[58:59], v11 offset:40704
    v_mfma_f32_32x32x16_bf16 v[112:127], v[48:51], v[192:195], v[112:127]
    s_add_u32 m0, s13, 61440
    s_mov_b64 exec, s[74:75]
    buffer_load_dwordx4 v4, s[44:47], s34 offen lds
    s_mov_b64 exec, -1
    ds_read_b64_tr_b16 v[60:61], v12 offset:39936
    ds_read_b64_tr_b16 v[62:63], v12 offset:40704
    ds_read_b64_tr_b16 v[72:73], v13 offset:36864
    ds_read_b64_tr_b16 v[74:75], v13 offset:37632
    ds_read_b64_tr_b16 v[76:77], v14 offset:24576
    ds_read_b64_tr_b16 v[78:79], v14 offset:25344
    s_nop 0
    s_waitcnt lgkmcnt(4)
    v_mfma_f32_32x32x16_bf16 v[80:95], v[52:55], v[196:199], v[80:95]
    ds_read_b64_tr_b16 v[40:41], v10 offset:43008
    ds_read_b64_tr_b16 v[42:43], v10 offset:43776
    v_mfma_f32_32x32x16_bf16 v[96:111], v[56:59], v[196:199], v[96:111]
    s_lshl_b32 s32, s95, 7
    s_add_u32 m0, s17, 32768
    s_add_u32 s32, s32, s16
    buffer_load_dwordx4 v2, s[52:55], s32 offen lds
    s_add_u32 m0, s17, 33792
    s_add_u32 s32, s32, 7168
    buffer_load_dwordx4 v3, s[52:55], s32 offen lds
    s_add_u32 m0, s17, 34816
    s_add_u32 s32, s32, 7168
    buffer_load_dwordx4 v2, s[52:55], s32 offen lds
    s_add_u32 m0, s17, 35840
    s_add_u32 s32, s32, 7168
    buffer_load_dwordx4 v3, s[52:55], s32 offen lds
    ds_read_b64_tr_b16 v[44:45], v11 offset:43008
    ds_read_b64_tr_b16 v[46:47], v11 offset:43776
    s_nop 0
    s_waitcnt lgkmcnt(6)
    v_mfma_f32_16x16x32_bf16 v[64:67], v[24:27], v[72:75], v[64:67]
    v_mfma_f32_32x32x16_bf16 v[112:127], v[60:63], v[196:199], v[112:127]
    ds_read_b64_tr_b16 v[48:49], v12 offset:43008
    ds_read_b64_tr_b16 v[50:51], v12 offset:43776
    s_waitcnt lgkmcnt(6)
    v_mfma_f32_16x16x32_bf16 v[68:71], v[24:27], v[76:79], v[68:71]
    s_waitcnt lgkmcnt(0)
    v_mfma_f32_32x32x16_bf16 v[80:95], v[40:43], v[200:203], v[80:95]
    ds_read_b64_tr_b16 v[52:53], v10 offset:46080
    ds_read_b64_tr_b16 v[54:55], v10 offset:46848
    v_mfma_f32_32x32x16_bf16 v[96:111], v[44:47], v[200:203], v[96:111]
    ds_read_b64_tr_b16 v[56:57], v11 offset:46080
    ds_read_b64_tr_b16 v[58:59], v11 offset:46848
    v_mfma_f32_32x32x16_bf16 v[112:127], v[48:51], v[200:203], v[112:127]
    ds_read_b64_tr_b16 v[60:61], v12 offset:46080
    ds_read_b64_tr_b16 v[62:63], v12 offset:46848
    s_waitcnt vmcnt(10)
    s_barrier
    s_waitcnt lgkmcnt(0)
    v_mfma_f32_32x32x16_bf16 v[80:95], v[52:55], v[204:207], v[80:95]
    s_waitcnt vmcnt(6)
    ds_read_b128 v[208:211], v6 offset:0
    ds_read_b128 v[212:215], v7 offset:0
    v_mfma_f32_32x32x16_bf16 v[96:111], v[56:59], v[204:207], v[96:111]
    ds_read_b128 v[216:219], v8 offset:0
    ds_read_b128 v[220:223], v9 offset:0
    ds_read_b64_tr_b16 v[40:41], v10 offset:49152
    ds_read_b64_tr_b16 v[42:43], v10 offset:49920
    v_mfma_f32_32x32x16_bf16 v[112:127], v[60:63], v[204:207], v[112:127]
    ds_read_b64_tr_b16 v[44:45], v11 offset:49152
    ds_read_b64_tr_b16 v[46:47], v11 offset:49920
    ds_read_b64_tr_b16 v[48:49], v12 offset:49152
    ds_read_b64_tr_b16 v[50:51], v12 offset:49920
    s_waitcnt lgkmcnt(0)
    v_mfma_f32_32x32x16_bf16 v[80:95], v[40:43], v[208:211], v[80:95]
    s_mul_i32 s34, s96, 172032
    s_add_u32 m0, s12, 73728
    s_add_u32 s34, s34, s10
    buffer_load_dwordx4 v5, s[44:47], s34 offen lds
    ds_read_b64_tr_b16 v[52:53], v10 offset:52224
    ds_read_b64_tr_b16 v[54:55], v10 offset:52992
    v_mfma_f32_32x32x16_bf16 v[96:111], v[44:47], v[208:211], v[96:111]
    ds_read_b64_tr_b16 v[56:57], v11 offset:52224
    ds_read_b64_tr_b16 v[58:59], v11 offset:52992
    v_mfma_f32_32x32x16_bf16 v[112:127], v[48:51], v[208:211], v[112:127]
    s_add_u32 m0, s13, 73728
    s_mov_b64 exec, s[74:75]
    buffer_load_dwordx4 v4, s[44:47], s34 offen lds
    s_mov_b64 exec, -1
    ds_read_b64_tr_b16 v[60:61], v12 offset:52224
    ds_read_b64_tr_b16 v[62:63], v12 offset:52992
    ds_read_b64_tr_b16 v[72:73], v13 offset:49152
    ds_read_b64_tr_b16 v[74:75], v13 offset:49920
    s_waitcnt lgkmcnt(2)
    v_mfma_f32_32x32x16_bf16 v[80:95], v[52:55], v[212:215], v[80:95]
    ds_read_b64_tr_b16 v[40:41], v10 offset:55296
    ds_read_b64_tr_b16 v[42:43], v10 offset:56064
    v_mfma_f32_32x32x16_bf16 v[96:111], v[56:59], v[212:215], v[96:111]
    s_lshl_b32 s32, s96, 7
    s_add_u32 m0, s17, 0
    s_add_u32 s32, s32, s16
    buffer_load_dwordx4 v2, s[52:55], s32 offen lds
    s_add_u32 m0, s17, 1024
    s_add_u32 s32, s32, 7168
    buffer_load_dwordx4 v3, s[52:55], s32 offen lds
    s_add_u32 m0, s17, 2048
    s_add_u32 s32, s32, 7168
    buffer_load_dwordx4 v2, s[52:55], s32 offen lds
    s_add_u32 m0, s17, 3072
    s_add_u32 s32, s32, 7168
    buffer_load_dwordx4 v3, s[52:55], s32 offen lds
    ds_read_b64_tr_b16 v[44:45], v11 offset:55296
    ds_read_b64_tr_b16 v[46:47], v11 offset:56064
    s_waitcnt lgkmcnt(4)
    v_mfma_f32_16x16x32_bf16 v[64:67], v[24:27], v[72:75], v[64:67]
    v_mfma_f32_32x32x16_bf16 v[112:127], v[60:63], v[212:215], v[112:127]
    ds_read_b64_tr_b16 v[48:49], v12 offset:55296
    ds_read_b64_tr_b16 v[50:51], v12 offset:56064
    s_waitcnt lgkmcnt(0)
    v_mfma_f32_32x32x16_bf16 v[80:95], v[40:43], v[216:219], v[80:95]
    ds_read_b64_tr_b16 v[52:53], v10 offset:58368
    ds_read_b64_tr_b16 v[54:55], v10 offset:59136
    v_mfma_f32_32x32x16_bf16 v[96:111], v[44:47], v[216:219], v[96:111]
    v_mov_b32 v5, 156672
    s_sub_u32 s29, s7, 24
    s_lshl_b32 s29, s29, 6
    ds_read_b64_tr_b16 v[56:57], v11 offset:58368
    ds_read_b64_tr_b16 v[58:59], v11 offset:59136
    v_mfma_f32_32x32x16_bf16 v[112:127], v[48:51], v[216:219], v[112:127]
    s_add_u32 s29, s29, 3072
    s_mul_i32 s34, s14, 57344
    s_add_u32 s29, s29, s34
    s_lshl_b32 s30, s14, 10
    ds_read_b64_tr_b16 v[60:61], v12 offset:58368
    ds_read_b64_tr_b16 v[62:63], v12 offset:59136
    s_waitcnt vmcnt(10)
    s_barrier
    s_waitcnt lgkmcnt(0)
    v_mfma_f32_32x32x16_bf16 v[80:95], v[52:55], v[220:223], v[80:95]
    v_lshrrev_b32 v4, 2, v0
    v_mul_u32_u24 v4, 3584, v4
    v_and_b32_e64 v23, 3, v0
    v_lshl_add_u32 v4, v23, 4, v4
    v_add_u32 v10, 49152, v10
    v_add_u32 v11, 49152, v11
    v_add_u32 v12, 49152, v12
    v_add_u32 v13, 49152, v13
    v_add_u32 v14, 49152, v14
    s_waitcnt vmcnt(6)
    ds_read_b128 v[224:227], v6 offset:32768
    ds_read_b128 v[228:231], v7 offset:32768
    v_mfma_f32_32x32x16_bf16 v[96:111], v[56:59], v[220:223], v[96:111]
    s_cmp_eq_u32 s15, 0
    s_cselect_b32 s34, s90, s91
    s_cselect_b32 s35, 0, 4096
    s_mul_i32 s34, s34, 229376
    s_add_u32 s35, s35, s30
    s_add_u32 m0, s35, 0
    s_add_u32 s34, s34, s29
    buffer_load_dwordx4 v4, s[36:39], s34 offen lds
    ds_read_b128 v[232:235], v8 offset:32768
    ds_read_b128 v[236:239], v9 offset:32768
    ds_read_b64_tr_b16 v[40:41], v10 offset:12288
    ds_read_b64_tr_b16 v[42:43], v10 offset:13056
    v_mfma_f32_32x32x16_bf16 v[112:127], v[60:63], v[220:223], v[112:127]
    v_and_b32_e64 v22, 31, v0
    v_lshlrev_b32 v22, 4, v22
    s_lshl_b32 s99, s8, 9
    s_add_u32 s99, s99, 18874368
    buffer_load_dwordx4 v[18:21], v22, s[48:51], s99 offen sc1
    ds_read_b64_tr_b16 v[44:45], v11 offset:12288
    ds_read_b64_tr_b16 v[46:47], v11 offset:13056
    ds_read_b64_tr_b16 v[48:49], v12 offset:12288
    ds_read_b64_tr_b16 v[50:51], v12 offset:13056
    s_nop 0
    s_waitcnt lgkmcnt(0)
    v_mfma_f32_32x32x16_bf16 v[80:95], v[40:43], v[224:227], v[80:95]
    s_cmp_eq_u32 s15, 0
    s_cselect_b32 s34, s92, s93
    s_cselect_b32 s35, 0, 4096
    s_mul_i32 s34, s34, 229376
    s_add_u32 s35, s35, s30
    s_add_u32 m0, s35, 8192
    s_add_u32 s34, s34, s29
    buffer_load_dwordx4 v4, s[36:39], s34 offen lds
    ds_read_b64_tr_b16 v[52:53], v10 offset:15360
    ds_read_b64_tr_b16 v[54:55], v10 offset:16128
    v_mfma_f32_32x32x16_bf16 v[96:111], v[44:47], v[224:227], v[96:111]
    s_cmp_eq_u32 s15, 0
    s_cselect_b32 s34, s90, s91
    s_cselect_b32 s35, 0, 4096
    s_mul_i32 s34, s34, 229376
    s_add_u32 s35, s35, s30
    s_add_u32 m0, s35, 28672
    s_add_u32 s34, s34, s29
    buffer_load_dwordx4 v4, s[40:43], s34 offen lds
    ds_read_b64_tr_b16 v[56:57], v11 offset:15360
    ds_read_b64_tr_b16 v[58:59], v11 offset:16128
    v_mfma_f32_32x32x16_bf16 v[112:127], v[48:51], v[224:227], v[112:127]
    ds_read_b64_tr_b16 v[60:61], v12 offset:15360
    ds_read_b64_tr_b16 v[62:63], v12 offset:16128
    ds_read_b64_tr_b16 v[72:73], v13 offset:12288
    ds_read_b64_tr_b16 v[74:75], v13 offset:13056
    ds_read_b64_tr_b16 v[76:77], v14 offset:0
    ds_read_b64_tr_b16 v[78:79], v14 offset:768
    s_waitcnt lgkmcnt(4)
    v_mfma_f32_32x32x16_bf16 v[80:95], v[52:55], v[228:231], v[80:95]
    s_cmp_eq_u32 s15, 0
    s_cselect_b32 s34, s96, s96
    s_cselect_b32 s35, 0, 0
    s_mul_i32 s34, s34, 229376
    s_add_u32 s35, s35, s30
    s_add_u32 m0, s35, 36864
    s_add_u32 s34, s34, s29
    buffer_load_dwordx4 v4, s[40:43], s34 offen lds
    ds_read_b64_tr_b16 v[40:41], v10 offset:18432
    ds_read_b64_tr_b16 v[42:43], v10 offset:19200
    v_mfma_f32_32x32x16_bf16 v[96:111], v[56:59], v[228:231], v[96:111]
    s_cmp_eq_u32 s15, 0
    s_cselect_b32 s34, s94, s95
    s_cselect_b32 s35, 0, 4096
    s_mul_i32 s34, s34, 229376
    s_add_u32 s35, s35, s30
    s_add_u32 m0, s35, 40960
    s_add_u32 s34, s34, s29
    buffer_load_dwordx4 v4, s[36:39], s34 offen lds
    ds_read_b64_tr_b16 v[44:45], v11 offset:18432
    ds_read_b64_tr_b16 v[46:47], v11 offset:19200
    s_waitcnt lgkmcnt(6)
    v_mfma_f32_16x16x32_bf16 v[64:67], v[24:27], v[72:75], v[64:67]
    v_mfma_f32_32x32x16_bf16 v[112:127], v[60:63], v[228:231], v[112:127]
    ds_read_b64_tr_b16 v[48:49], v12 offset:18432
    ds_read_b64_tr_b16 v[50:51], v12 offset:19200
    s_waitcnt lgkmcnt(6)
    v_mfma_f32_16x16x32_bf16 v[68:71], v[24:27], v[76:79], v[68:71]
    s_waitcnt lgkmcnt(0)
    v_mfma_f32_32x32x16_bf16 v[80:95], v[40:43], v[232:235], v[80:95]
    s_cmp_eq_u32 s15, 0
    s_cselect_b32 s34, s96, s96
    s_cselect_b32 s35, 0, 0
    s_mul_i32 s34, s34, 229376
    s_add_u32 s35, s35, s30
    s_add_u32 m0, s35, 16384
    s_add_u32 s34, s34, s29
    buffer_load_dwordx4 v4, s[36:39], s34 offen lds
    ds_read_b64_tr_b16 v[52:53], v10 offset:21504
    ds_read_b64_tr_b16 v[54:55], v10 offset:22272
    v_mfma_f32_32x32x16_bf16 v[96:111], v[44:47], v[232:235], v[96:111]
    ds_read_b64_tr_b16 v[56:57], v11 offset:21504
    ds_read_b64_tr_b16 v[58:59], v11 offset:22272
    v_mfma_f32_32x32x16_bf16 v[112:127], v[48:51], v[232:235], v[112:127]
    ds_read_b64_tr_b16 v[60:61], v12 offset:21504
    ds_read_b64_tr_b16 v[62:63], v12 offset:22272
    s_waitcnt vmcnt(11)
    s_barrier
    s_waitcnt lgkmcnt(0)
    v_mfma_f32_32x32x16_bf16 v[80:95], v[52:55], v[236:239], v[80:95]
    s_waitcnt vmcnt(7)
    ds_read_b128 v[240:243], v6 offset:0
    ds_read_b128 v[244:247], v7 offset:0
    v_mfma_f32_32x32x16_bf16 v[96:111], v[56:59], v[236:239], v[96:111]
    ds_read_b128 v[248:251], v8 offset:0
    ds_read_b128 v[252:255], v9 offset:0
    ds_read_b64_tr_b16 v[40:41], v10 offset:24576
    ds_read_b64_tr_b16 v[42:43], v10 offset:25344
    v_mfma_f32_32x32x16_bf16 v[112:127], v[60:63], v[236:239], v[112:127]
    ds_read_b64_tr_b16 v[44:45], v11 offset:24576
    ds_read_b64_tr_b16 v[46:47], v11 offset:25344
    ds_read_b64_tr_b16 v[48:49], v12 offset:24576
    ds_read_b64_tr_b16 v[50:51], v12 offset:25344
    s_waitcnt lgkmcnt(0)
    v_mfma_f32_32x32x16_bf16 v[80:95], v[40:43], v[240:243], v[80:95]
    s_waitcnt vmcnt(5)
    ds_read_b64_tr_b16 v[52:53], v10 offset:27648
    ds_read_b64_tr_b16 v[54:55], v10 offset:28416
    v_mfma_f32_32x32x16_bf16 v[96:111], v[44:47], v[240:243], v[96:111]
    v_cmp_ne_u32 vcc, s97, v20
    s_cbranch_vccz L_ok21
    s_mov_b32 s76, 200000
L_lp21:
    s_sleep 6
    buffer_load_dwordx4 v[18:21], v22, s[48:51], s99 offen sc1
    s_waitcnt vmcnt(0)
    v_cmp_ne_u32 vcc, s97, v20
    s_cbranch_vccz L_ok21
    s_sub_u32 s76, s76, 1
    s_cbranch_scc0 L_lp21
L_ok21:
    v_rsq_f32_e64 v22, v19
    ds_read_b64_tr_b16 v[56:57], v11 offset:27648
    ds_read_b64_tr_b16 v[58:59], v11 offset:28416
    v_mfma_f32_32x32x16_bf16 v[112:127], v[48:51], v[240:243], v[112:127]
    v_cvt_pk_bf16_f32 v28, -v18, -v18
    v_and_b32 v23, 0xffff0000, v28
    ds_read_b64_tr_b16 v[60:61], v12 offset:27648
    ds_read_b64_tr_b16 v[62:63], v12 offset:28416
    ds_read_b64_tr_b16 v[72:73], v13 offset:24576
    ds_read_b64_tr_b16 v[74:75], v13 offset:25344
    ds_read_b64_tr_b16 v[76:77], v14 offset:24576
    ds_read_b64_tr_b16 v[78:79], v14 offset:25344
    s_nop 0
    s_waitcnt lgkmcnt(4)
    v_mfma_f32_32x32x16_bf16 v[80:95], v[52:55], v[244:247], v[80:95]
    v_sub_f32 v23, -v18, v23
    v_cvt_pk_bf16_f32 v29, v23, v23
    ds_read_b64_tr_b16 v[40:41], v10 offset:30720
    ds_read_b64_tr_b16 v[42:43], v10 offset:31488
    v_mfma_f32_32x32x16_bf16 v[96:111], v[56:59], v[244:247], v[96:111]
    s_lshl_b32 s78, s2, 3
    s_add_u32 s78, s78, s5
    v_min_u32 v7, 6, v0
    v_lshlrev_b32 v7, 7, v7
    s_mul_i32 s79, s78, 784
    buffer_load_dword v6, v7, s[56:59], s79 offen
    s_mul_i32 s79, s78, 196
    v_min_u32 v7, 128, v7
    buffer_load_dword v6, v7, s[60:63], s79 offen
    v_cndmask_b32 v28, v28, 0, s[72:73]
    v_cndmask_b32 v29, v29, 0, s[72:73]
    ds_read_b64_tr_b16 v[44:45], v11 offset:30720
    ds_read_b64_tr_b16 v[46:47], v11 offset:31488
    s_waitcnt lgkmcnt(6)
    v_mfma_f32_16x16x32_bf16 v[64:67], v[24:27], v[72:75], v[64:67]
    v_mfma_f32_32x32x16_bf16 v[112:127], v[60:63], v[244:247], v[112:127]
    v_mov_b32 v18, v22
    v_mul_f32 v20, 0xc0135761, v22
    ds_read_b64_tr_b16 v[48:49], v12 offset:30720
    ds_read_b64_tr_b16 v[50:51], v12 offset:31488
    s_waitcnt lgkmcnt(6)
    s_cmp_lg_u32 s15, 0
    s_cbranch_scc1 L_sk22
    v_mfma_f32_16x16x32_bf16 v[68:71], v[24:27], v[76:79], v[68:71]
L_sk22:
    s_waitcnt lgkmcnt(0)
    v_mfma_f32_32x32x16_bf16 v[80:95], v[40:43], v[248:251], v[80:95]
    v_mul_f32 v21, 0xbdd2d3e8, v22
    v_mul_f32_e64 v23, v22, v22
    ds_read_b64_tr_b16 v[52:53], v10 offset:33792
    ds_read_b64_tr_b16 v[54:55], v10 offset:34560
    v_mfma_f32_32x32x16_bf16 v[96:111], v[44:47], v[248:251], v[96:111]
    v_mul_f32 v21, v21, v23
    v_mov_b32 v9, 1
    ds_read_b64_tr_b16 v[56:57], v11 offset:33792
    ds_read_b64_tr_b16 v[58:59], v11 offset:34560
    v_mfma_f32_32x32x16_bf16 v[112:127], v[48:51], v[248:251], v[112:127]
    ds_read_b64_tr_b16 v[60:61], v12 offset:33792
    ds_read_b64_tr_b16 v[62:63], v12 offset:34560
    ds_write_b32 v15, v64
    ds_write_b32 v15, v68 offset:1024
    s_waitcnt lgkmcnt(2)
    v_mfma_f32_32x32x16_bf16 v[112:127], v[60:63], v[252:255], v[112:127]
    v_mov_b32 v10, v39
    v_add_u32 v11, 57344, v39
    v_mov_b32 v39, 0
    s_lshl_b32 s34, s14, 10
    s_lshl_b32 s35, s15, 12
    s_add_u32 s34, s34, s35
    v_add_u32_e64 v13, s34, v10
    v_add_u32 v7, s34, v11
    s_waitcnt vmcnt(2) lgkmcnt(0)
    s_barrier
    s_setprio 2
    s_cmp_lg_u32 s15, 0
    s_cbranch_scc1 L_p1g_B
    ds_read_b128 v[72:75], v16 offset:1024
    ds_read_b128 v[76:79], v16 offset:1536
    ds_read_b64_tr_b16 v[40:41], v10 offset:0
    ds_read_b64_tr_b16 v[42:43], v10 offset:256
    ds_read_b64_tr_b16 v[44:45], v10 offset:1024
    ds_read_b64_tr_b16 v[46:47], v10 offset:1280
    ds_read_b64_tr_b16 v[48:49], v10 offset:2048
    ds_read_b64_tr_b16 v[50:51], v10 offset:2304
    v_mfma_f32_32x32x16_bf16 v[80:95], v[52:55], v[252:255], v[80:95]
    v_mfma_f32_32x32x16_bf16 v[96:111], v[56:59], v[252:255], v[96:111]
    ds_read_b64_tr_b16 v[52:53], v10 offset:3072
    ds_read_b64_tr_b16 v[54:55], v10 offset:3328
    s_waitcnt lgkmcnt(6)
    v_mfma_f32_32x32x16_bf16 v[128:143], v[40:43], v[144:147], 0
    s_cmp_eq_u32 s15, 0
    s_cselect_b32 s34, s92, s93
    s_cselect_b32 s35, 0, 4096
    s_mul_i32 s34, s34, 229376
    s_add_u32 s35, s35, s30
    s_add_u32 m0, s35, 57344
    s_add_u32 s34, s34, s29
    buffer_load_dwordx4 v4, s[40:43], s34 offen lds
    v_add_f32 v72, v72, v76
    v_add_f32 v73, v73, v77
    v_add_f32 v74, v74, v78
    v_add_f32 v75, v75, v79
    v_add_f32 v72, v72, v73
    v_add_f32_e64 v74, v74, v75
    ds_read_b64_tr_b16 v[56:57], v10 offset:4096
    ds_read_b64_tr_b16 v[58:59], v10 offset:4352
    ds_read_b64_tr_b16 v[60:61], v13 offset:0
    ds_read_b64_tr_b16 v[62:63], v13 offset:256
    s_waitcnt lgkmcnt(8)
    v_mfma_f32_32x32x16_bf16 v[128:143], v[44:47], v[148:151], v[128:143]
    s_cmp_eq_u32 s15, 0
    s_cselect_b32 s34, s94, s95
    s_cselect_b32 s35, 0, 4096
    s_mul_i32 s34, s34, 229376
    s_add_u32 s35, s35, s30
    s_add_u32 m0, s35, 65536
    s_add_u32 s34, s34, s29
    buffer_load_dwordx4 v4, s[40:43], s34 offen lds
    v_add_f32 v72, v72, v74
    v_cvt_pk_bf16_f32 v73, v72, v72
    v_and_b32 v73, 0xffff0000, v73
    v_sub_f32_e64 v73, v72, v73
    v_cvt_pk_bf16_f32 v32, v72, v73
    v_cvt_pk_bf16_f32 v33, v72, v73
    ds_read_b128 v[72:75], v16 offset:0
    ds_read_b64_tr_b16 v[40:41], v10 offset:5120
    ds_read_b64_tr_b16 v[42:43], v10 offset:5376
    s_waitcnt lgkmcnt(9)
    v_mfma_f32_32x32x16_bf16 v[128:143], v[48:51], v[152:155], v[128:143]
    ds_read_b128 v[76:79], v16 offset:512
    v_mfma_f32_32x32x16_bf16 v[112:127], v[32:35], v[28:31], v[112:127]
    s_waitcnt lgkmcnt(3)
    v_add_f32 v72, v72, v73
    v_add_f32 v74, v74, v75
    v_add_f32_e64 v72, v72, v74
    v_cvt_pk_bf16_f32 v73, v72, v72
    v_mfma_f32_16x16x32_bf16 v[64:67], v[24:27], v[60:63], 0
    ds_read_b64_tr_b16 v[44:45], v10 offset:6144
    ds_read_b64_tr_b16 v[46:47], v10 offset:6400
    ds_read_b64_tr_b16 v[60:61], v13 offset:8192
    ds_read_b64_tr_b16 v[62:63], v13 offset:8448
    v_mfma_f32_32x32x16_bf16 v[128:143], v[52:55], v[156:159], v[128:143]
    v_and_b32 v73, 0xffff0000, v73
    v_sub_f32_e64 v73, v72, v73
    v_cvt_pk_bf16_f32 v36, v72, v73
    v_cvt_pk_bf16_f32 v37, v72, v73
    s_nop 1
    v_mfma_f32_32x32x16_bf16 v[80:95], v[36:39], v[28:31], v[80:95]
    s_waitcnt lgkmcnt(4)
    v_add_f32 v76, v76, v77
    v_add_f32 v78, v78, v79
    ds_read_b64_tr_b16 v[48:49], v10 offset:7168
    ds_read_b64_tr_b16 v[50:51], v10 offset:7424
    v_mfma_f32_32x32x16_bf16 v[128:143], v[56:59], v[160:163], v[128:143]
    v_add_f32_e64 v76, v76, v78
    v_cvt_pk_bf16_f32 v77, v76, v76
    v_and_b32 v77, 0xffff0000, v77
    v_sub_f32_e64 v77, v76, v77
    v_cvt_pk_bf16_f32 v32, v76, v77
    v_cvt_pk_bf16_f32 v33, v76, v77
    s_nop 1
    v_mfma_f32_32x32x16_bf16 v[96:111], v[32:35], v[28:31], v[96:111]
    s_waitcnt lgkmcnt(2)
    v_mfma_f32_16x16x32_bf16 v[64:67], v[24:27], v[60:63], v[64:67]
    ds_read_b64_tr_b16 v[52:53], v10 offset:8192
    ds_read_b64_tr_b16 v[54:55], v10 offset:8448
    ds_read_b64_tr_b16 v[60:61], v13 offset:40960
    ds_read_b64_tr_b16 v[62:63], v13 offset:41216
    v_mfma_f32_32x32x16_bf16 v[128:143], v[40:43], v[164:167], v[128:143]
    v_mul_f32 v112, v112, v18
    v_mul_f32 v113, v113, v18
    v_mul_f32 v114, v114, v18
    v_mul_f32 v115, v115, v18
    v_mul_f32 v116, v116, v18
    v_mul_f32 v117, v117, v18
    v_mul_f32_e64 v118, v118, v18
    ds_read_b64_tr_b16 v[56:57], v10 offset:9216
    ds_read_b64_tr_b16 v[58:59], v10 offset:9472
    v_mfma_f32_32x32x16_bf16 v[128:143], v[44:47], v[168:171], v[128:143]
    v_mul_f32 v119, v119, v18
    v_mul_f32 v120, v120, v18
    v_mul_f32 v121, v121, v18
    v_mul_f32 v122, v122, v18
    v_mul_f32 v123, v123, v18
    v_mul_f32 v124, v124, v18
    v_mul_f32_e64 v125, v125, v18
    v_mul_f32 v126, v126, v18
    s_waitcnt lgkmcnt(2)
    v_mfma_f32_16x16x32_bf16 v[64:67], v[24:27], v[60:63], v[64:67]
    ds_read_b64_tr_b16 v[40:41], v10 offset:10240
    ds_read_b64_tr_b16 v[42:43], v10 offset:10496
    ds_read_b64_tr_b16 v[60:61], v13 offset:16384
    ds_read_b64_tr_b16 v[62:63], v13 offset:16640
    v_mfma_f32_32x32x16_bf16 v[128:143], v[48:51], v[172:175], v[128:143]
    v_mul_f32_e64 v127, v127, v18
    v_cvt_pk_bf16_f32 v112, v112, v113
    v_cvt_pk_bf16_f32 v113, v114, v115
    v_cvt_pk_bf16_f32 v114, v116, v117
    v_cvt_pk_bf16_f32 v115, v118, v119
    v_cvt_pk_bf16_f32 v116, v120, v121
    v_cvt_pk_bf16_f32 v117, v122, v123
    ds_read_b64_tr_b16 v[44:45], v10 offset:11264
    ds_read_b64_tr_b16 v[46:47], v10 offset:11520
    v_mfma_f32_32x32x16_bf16 v[128:143], v[52:55], v[176:179], v[128:143]
    v_cvt_pk_bf16_f32 v118, v124, v125
    v_cvt_pk_bf16_f32 v119, v126, v127
    v_mov_b32 v120, s28
    v_cndmask_b32 v119, v119, 0, s[72:73]
    v_cndmask_b32 v118, v118, v120, s[72:73]
    buffer_store_dwordx4 v[112:115], v1, s[48:51], s22 offen sc1
    buffer_store_dwordx4 v[116:119], v1, s[48:51], s22 offen offset:1024 sc1
    s_waitcnt lgkmcnt(2)
    s_cmp_lg_u32 s15, 0
    s_cbranch_scc1 L_sk24
    v_mfma_f32_16x16x32_bf16 v[64:67], v[24:27], v[60:63], v[64:67]
L_sk24:
    ds_read_b64_tr_b16 v[48:49], v10 offset:12288
    ds_read_b64_tr_b16 v[50:51], v10 offset:12544
    ds_read_b64_tr_b16 v[60:61], v13 offset:28672
    ds_read_b64_tr_b16 v[62:63], v13 offset:28928
    v_mfma_f32_32x32x16_bf16 v[128:143], v[56:59], v[180:183], v[128:143]
    v_mul_f32 v80, v80, v18
    v_mul_f32 v81, v81, v18
    v_mul_f32 v82, v82, v18
    v_mul_f32 v83, v83, v18
    v_mul_f32 v84, v84, v18
    v_mul_f32 v85, v85, v18
    v_mul_f32_e64 v86, v86, v18
    ds_read_b64_tr_b16 v[52:53], v10 offset:13312
    ds_read_b64_tr_b16 v[54:55], v10 offset:13568
    v_mfma_f32_32x32x16_bf16 v[128:143], v[40:43], v[184:187], v[128:143]
    v_mul_f32 v87, v87, v18
    v_mul_f32 v88, v88, v18
    v_mul_f32 v89, v89, v18
    v_mul_f32 v90, v90, v18
    v_mul_f32 v91, v91, v18
    v_mul_f32 v92, v92, v18
    v_mul_f32 v93, v93, v18
    v_mul_f32 v94, v94, v18
    s_waitcnt lgkmcnt(2)
    v_mfma_f32_16x16x32_bf16 v[68:71], v[24:27], v[60:63], 0
    ds_read_b64_tr_b16 v[56:57], v10 offset:14336
    ds_read_b64_tr_b16 v[58:59], v10 offset:14592
    s_waitcnt vmcnt(3)
    ds_read_b64_tr_b16 v[60:61], v7 offset:0
    ds_read_b64_tr_b16 v[62:63], v7 offset:256
    v_mfma_f32_32x32x16_bf16 v[128:143], v[44:47], v[188:191], v[128:143]
    v_mul_f32_e64 v95, v95, v18
    v_cvt_pk_bf16_f32 v80, v80, v81
    v_cvt_pk_bf16_f32 v81, v82, v83
    v_cvt_pk_bf16_f32 v82, v84, v85
    v_cvt_pk_bf16_f32 v83, v86, v87
    v_cvt_pk_bf16_f32 v84, v88, v89
    v_cvt_pk_bf16_f32 v85, v90, v91
    ds_write_b32 v15, v64 offset:2048
    ds_read_b64_tr_b16 v[40:41], v10 offset:15360
    ds_read_b64_tr_b16 v[42:43], v10 offset:15616
    v_mfma_f32_32x32x16_bf16 v[128:143], v[48:51], v[192:195], v[128:143]
    v_cvt_pk_bf16_f32 v86, v92, v93
    v_cvt_pk_bf16_f32 v87, v94, v95
    v_mov_b32_e64 v88, s26
    v_cndmask_b32 v87, v87, 0, s[72:73]
    v_cndmask_b32 v86, v86, v88, s[72:73]
    buffer_store_dwordx4 v[80:83], v1, s[48:51], s20 offen sc1
    buffer_store_dwordx4 v[84:87], v1, s[48:51], s20 offen offset:1024 sc1
    s_waitcnt lgkmcnt(3)
    v_mfma_f32_16x16x32_bf16 v[68:71], v[24:27], v[60:63], v[68:71]
    ds_read_b64_tr_b16 v[44:45], v10 offset:40960
    ds_read_b64_tr_b16 v[46:47], v10 offset:41216
    s_waitcnt vmcnt(4)
    ds_read_b64_tr_b16 v[60:61], v7 offset:8192
    ds_read_b64_tr_b16 v[62:63], v7 offset:8448
    v_mfma_f32_32x32x16_bf16 v[128:143], v[52:55], v[196:199], v[128:143]
    v_mul_f32 v96, v96, v18
    v_mul_f32 v97, v97, v18
    v_mul_f32 v98, v98, v18
    v_mul_f32 v99, v99, v18
    v_mul_f32 v100, v100, v18
    v_mul_f32 v101, v101, v18
    v_mul_f32 v102, v102, v18
    v_mul_f32 v103, v103, v18
    ds_read_b64_tr_b16 v[48:49], v10 offset:41984
    ds_read_b64_tr_b16 v[50:51], v10 offset:42240
    v_mfma_f32_32x32x16_bf16 v[128:143], v[56:59], v[200:203], v[128:143]
    v_mul_f32 v104, v104, v18
    v_mul_f32 v105, v105, v18
    v_mul_f32 v106, v106, v18
    v_mul_f32 v107, v107, v18
    v_mul_f32 v108, v108, v18
    v_mul_f32 v109, v109, v18
    v_mul_f32 v110, v110, v18
    s_waitcnt lgkmcnt(2)
    v_mfma_f32_16x16x32_bf16 v[68:71], v[24:27], v[60:63], v[68:71]
    ds_read_b64_tr_b16 v[52:53], v10 offset:43008
    ds_read_b64_tr_b16 v[54:55], v10 offset:43264
    ds_read_b64_tr_b16 v[60:61], v13 offset:36864
    ds_read_b64_tr_b16 v[62:63], v13 offset:37120
    v_mfma_f32_32x32x16_bf16 v[128:143], v[40:43], v[204:207], v[128:143]
    v_mul_f32_e64 v111, v111, v18
    v_cvt_pk_bf16_f32 v96, v96, v97
    v_cvt_pk_bf16_f32 v97, v98, v99
    v_cvt_pk_bf16_f32 v98, v100, v101
    v_cvt_pk_bf16_f32 v99, v102, v103
    v_cvt_pk_bf16_f32 v100, v104, v105
    v_cvt_pk_bf16_f32 v101, v106, v107
    ds_read_b64_tr_b16 v[56:57], v10 offset:44032
    ds_read_b64_tr_b16 v[58:59], v10 offset:44288
    v_mfma_f32_32x32x16_bf16 v[128:143], v[44:47], v[208:211], v[128:143]
    v_cvt_pk_bf16_f32 v102, v108, v109
    v_cvt_pk_bf16_f32 v103, v110, v111
    v_mov_b32_e64 v104, s27
    v_cndmask_b32 v103, v103, 0, s[72:73]
    v_cndmask_b32 v102, v102, v104, s[72:73]
    buffer_store_dwordx4 v[96:99], v1, s[48:51], s21 offen sc1
    buffer_store_dwordx4 v[100:103], v1, s[48:51], s21 offen offset:1024 sc1
    s_setprio 0
    s_waitcnt lgkmcnt(2)
    s_cmp_lg_u32 s15, 0
    s_cbranch_scc1 L_sk25
    v_mfma_f32_16x16x32_bf16 v[68:71], v[24:27], v[60:63], v[68:71]
L_sk25:
    ds_read_b64_tr_b16 v[40:41], v10 offset:45056
    ds_read_b64_tr_b16 v[42:43], v10 offset:45312
    v_mfma_f32_32x32x16_bf16 v[128:143], v[48:51], v[212:215], v[128:143]
    ds_read_b64_tr_b16 v[44:45], v10 offset:46080
    ds_read_b64_tr_b16 v[46:47], v10 offset:46336
    v_mfma_f32_32x32x16_bf16 v[128:143], v[52:55], v[216:219], v[128:143]
    ds_read_b64_tr_b16 v[48:49], v10 offset:47104
    ds_read_b64_tr_b16 v[50:51], v10 offset:47360
    s_waitcnt lgkmcnt(6)
    v_mfma_f32_32x32x16_bf16 v[128:143], v[56:59], v[220:223], v[128:143]
    ds_write_b32 v15, v68 offset:3072
    ds_read_b64_tr_b16 v[52:53], v10 offset:48128
    ds_read_b64_tr_b16 v[54:55], v10 offset:48384
    s_waitcnt lgkmcnt(7)
    v_mfma_f32_32x32x16_bf16 v[128:143], v[40:43], v[224:227], v[128:143]
    ds_read_b64_tr_b16 v[56:57], v10 offset:16384
    ds_read_b64_tr_b16 v[58:59], v10 offset:16640
    s_waitcnt lgkmcnt(7)
    v_mfma_f32_32x32x16_bf16 v[128:143], v[44:47], v[228:231], v[128:143]
    s_waitcnt lgkmcnt(4)
    s_mov_b64 exec, 1
    ds_add_u32 v5, v9 offset:48
    s_mov_b64 exec, -1
    ds_read_b64_tr_b16 v[40:41], v10 offset:17408
    ds_read_b64_tr_b16 v[42:43], v10 offset:17664
    v_mfma_f32_32x32x16_bf16 v[128:143], v[48:51], v[232:235], v[128:143]
    ds_read_b64_tr_b16 v[44:45], v10 offset:18432
    ds_read_b64_tr_b16 v[46:47], v10 offset:18688
    s_waitcnt lgkmcnt(7)
    v_mfma_f32_32x32x16_bf16 v[128:143], v[52:55], v[236:239], v[128:143]
    v_mov_b32 v23, s97
    s_waitcnt vmcnt(0)
    buffer_store_dword v23, off, s[48:51], s19 offset:0 sc1
    buffer_store_dword v23, off, s[48:51], s19 offset:256 sc1
    buffer_store_dword v23, off, s[48:51], s19 offset:512 sc1
    ds_read_b64_tr_b16 v[48:49], v10 offset:19456
    ds_read_b64_tr_b16 v[50:51], v10 offset:19712
    s_waitcnt lgkmcnt(7)
    v_mfma_f32_32x32x16_bf16 v[128:143], v[56:59], v[240:243], v[128:143]
    s_mov_b32 s76, 200000
L_ll23:
    ds_read_b32 v23, v5 offset:48
    s_waitcnt lgkmcnt(0)
    v_readfirstlane_b32 s77, v23
    s_nop 0
    s_cmp_eq_u32 s77, 8
    s_cbranch_scc1 L_lk23
    s_sleep 1
    s_sub_u32 s76, s76, 1
    s_cbranch_scc0 L_ll23
L_lk23:
    ds_read_b128 v[72:75], v16 offset:2048
    ds_read_b128 v[76:79], v16 offset:2560
    ds_read_b128 v[96:99], v16 offset:3072
    ds_read_b128 v[100:103], v16 offset:3584
    ds_read_b64_tr_b16 v[52:53], v10 offset:28672
    ds_read_b64_tr_b16 v[54:55], v10 offset:28928
    v_mfma_f32_32x32x16_bf16 v[128:143], v[40:43], v[244:247], v[128:143]
    s_waitcnt lgkmcnt(4)
    v_add_f32 v72, v72, v76
    v_add_f32 v73, v73, v77
    v_add_f32 v74, v74, v78
    v_add_f32 v75, v75, v79
    v_add_f32 v72, v72, v73
    ds_read_b64_tr_b16 v[56:57], v10 offset:29696
    ds_read_b64_tr_b16 v[58:59], v10 offset:29952
    v_mfma_f32_32x32x16_bf16 v[128:143], v[44:47], v[248:251], v[128:143]
    v_add_f32 v74, v74, v75
    v_add_f32 v72, v72, v74
    v_cvt_pk_bf16_f32 v73, v72, v72
    v_and_b32 v73, 0xffff0000, v73
    v_sub_f32_e64 v73, v72, v73
    v_cvt_pk_bf16_f32 v36, v72, v73
    v_cvt_pk_bf16_f32 v37, v72, v73
    ds_read_b64_tr_b16 v[40:41], v10 offset:30720
    ds_read_b64_tr_b16 v[42:43], v10 offset:30976
    v_mfma_f32_32x32x16_bf16 v[128:143], v[48:51], v[252:255], v[128:143]
    v_mfma_f32_32x32x16_bf16 v[128:143], v[36:39], v[28:31], v[128:143]
    s_waitcnt lgkmcnt(6)
    v_add_f32 v96, v96, v100
    v_add_f32 v97, v97, v101
    v_add_f32 v98, v98, v102
    v_add_f32 v99, v99, v103
    v_add_f32 v96, v96, v97
    ds_read_b64_tr_b16 v[44:45], v10 offset:31744
    ds_read_b64_tr_b16 v[46:47], v10 offset:32000
    s_waitcnt lgkmcnt(6)
    v_mfma_f32_32x32x16_bf16 v[80:95], v[52:55], v[144:147], 0
    v_add_f32 v98, v98, v99
    v_add_f32_e64 v96, v96, v98
    v_cvt_pk_bf16_f32 v97, v96, v96
    v_and_b32 v97, 0xffff0000, v97
    v_sub_f32_e64 v97, v96, v97
    v_cvt_pk_bf16_f32 v32, v96, v97
    v_cvt_pk_bf16_f32 v33, v96, v97
    ds_read_b64_tr_b16 v[48:49], v10 offset:32768
    ds_read_b64_tr_b16 v[50:51], v10 offset:33024
    s_waitcnt lgkmcnt(6)
    v_mfma_f32_32x32x16_bf16 v[80:95], v[56:59], v[148:151], v[80:95]
    v_mfma_f32_32x32x16_bf16 v[80:95], v[32:35], v[28:31], v[80:95]
    s_mov_b64 exec, 1
    ds_add_u32 v5, v9 offset:64
    s_mov_b64 exec, -1
    ds_read_b64_tr_b16 v[52:53], v10 offset:33792
    ds_read_b64_tr_b16 v[54:55], v10 offset:34048
    s_waitcnt lgkmcnt(7)
    v_mfma_f32_32x32x16_bf16 v[80:95], v[40:43], v[152:155], v[80:95]
    v_mul_f32 v72, v128, v128
    v_mul_f32 v73, v129, v129
    v_mul_f32 v74, v130, v130
    v_mul_f32 v75, v131, v131
    s_lshl_b32 s76, s4, 3
    s_add_u32 s76, s76, s5
    v_min_u32 v23, 12, v0
    v_lshlrev_b32 v23, 7, v23
    s_mul_i32 s77, s76, 1568
    buffer_load_dword v127, v23, s[60:63], s77 offen
    ds_read_b64_tr_b16 v[56:57], v10 offset:34816
    ds_read_b64_tr_b16 v[58:59], v10 offset:35072
    s_nop 0
    s_waitcnt lgkmcnt(7)
    v_mfma_f32_32x32x16_bf16 v[80:95], v[44:47], v[156:159], v[80:95]
    v_fma_f32 v72, v72, v21, v20
    v_fma_f32 v73, v73, v21, v20
    v_fma_f32 v74, v74, v21, v20
    v_fma_f32 v75, v75, v21, v20
    v_mul_f32_e64 v72, v72, v128
    ds_read_b64_tr_b16 v[40:41], v10 offset:35840
    ds_read_b64_tr_b16 v[42:43], v10 offset:36096
    s_waitcnt lgkmcnt(7)
    v_mfma_f32_32x32x16_bf16 v[80:95], v[48:51], v[160:163], v[80:95]
    v_mul_f32 v73, v73, v129
    v_mul_f32 v74, v74, v130
    v_mul_f32 v75, v75, v131
    v_exp_f32 v72, v72
    v_exp_f32 v73, v73
    ds_read_b64_tr_b16 v[44:45], v11 offset:0
    ds_read_b64_tr_b16 v[46:47], v11 offset:256
    s_waitcnt lgkmcnt(6)
    v_mfma_f32_32x32x16_bf16 v[80:95], v[52:55], v[164:167], v[80:95]
    v_exp_f32 v74, v74
    v_exp_f32_e64 v75, v75
    v_fma_f32 v72, v72, v19, v19
    v_fma_f32 v73, v73, v19, v19
    ds_read_b64_tr_b16 v[48:49], v11 offset:1024
    ds_read_b64_tr_b16 v[50:51], v11 offset:1280
    s_waitcnt lgkmcnt(6)
    v_mfma_f32_32x32x16_bf16 v[80:95], v[56:59], v[168:171], v[80:95]
    v_fma_f32 v74, v74, v19, v19
    v_fma_f32 v75, v75, v19, v19
    v_rcp_f32 v72, v72
    v_rcp_f32 v73, v73
    v_rcp_f32 v74, v74
    ds_read_b64_tr_b16 v[52:53], v11 offset:2048
    ds_read_b64_tr_b16 v[54:55], v11 offset:2304
    s_waitcnt lgkmcnt(6)
    v_mfma_f32_32x32x16_bf16 v[80:95], v[40:43], v[172:175], v[80:95]
    v_rcp_f32 v75, v75
    v_mul_f32 v128, v128, v72
    v_mul_f32 v129, v129, v73
    v_mul_f32 v130, v130, v74
    v_mul_f32 v131, v131, v75
    ds_read_b64_tr_b16 v[56:57], v11 offset:3072
    ds_read_b64_tr_b16 v[58:59], v11 offset:3328
    s_waitcnt lgkmcnt(6)
    v_mfma_f32_32x32x16_bf16 v[80:95], v[44:47], v[176:179], v[80:95]
    v_mul_f32 v76, v132, v132
    v_mul_f32 v77, v133, v133
    v_mul_f32 v78, v134, v134
    v_mul_f32 v79, v135, v135
    ds_read_b64_tr_b16 v[40:41], v11 offset:4096
    ds_read_b64_tr_b16 v[42:43], v11 offset:4352
    s_waitcnt lgkmcnt(6)
    v_mfma_f32_32x32x16_bf16 v[80:95], v[48:51], v[180:183], v[80:95]
    v_fma_f32 v76, v76, v21, v20
    v_fma_f32 v77, v77, v21, v20
    v_fma_f32 v78, v78, v21, v20
    v_fma_f32 v79, v79, v21, v20
    v_mul_f32_e64 v76, v76, v132
    ds_read_b64_tr_b16 v[44:45], v11 offset:5120
    ds_read_b64_tr_b16 v[46:47], v11 offset:5376
    s_waitcnt lgkmcnt(6)
    v_mfma_f32_32x32x16_bf16 v[80:95], v[52:55], v[184:187], v[80:95]
    v_mul_f32 v77, v77, v133
    v_mul_f32 v78, v78, v134
    v_mul_f32 v79, v79, v135
    v_exp_f32 v76, v76
    v_exp_f32 v77, v77
    ds_read_b64_tr_b16 v[48:49], v11 offset:6144
    ds_read_b64_tr_b16 v[50:51], v11 offset:6400
    s_waitcnt lgkmcnt(6)
    v_mfma_f32_32x32x16_bf16 v[80:95], v[56:59], v[188:191], v[80:95]
    v_exp_f32 v78, v78
    v_exp_f32_e64 v79, v79
    v_fma_f32 v76, v76, v19, v19
    v_fma_f32 v77, v77, v19, v19
    ds_read_b64_tr_b16 v[52:53], v11 offset:7168
    ds_read_b64_tr_b16 v[54:55], v11 offset:7424
    s_waitcnt lgkmcnt(6)
    v_mfma_f32_32x32x16_bf16 v[80:95], v[40:43], v[192:195], v[80:95]
    v_fma_f32 v78, v78, v19, v19
    v_fma_f32 v79, v79, v19, v19
    v_rcp_f32 v76, v76
    v_rcp_f32 v77, v77
    v_rcp_f32 v78, v78
    ds_read_b64_tr_b16 v[56:57], v11 offset:8192
    ds_read_b64_tr_b16 v[58:59], v11 offset:8448
    s_waitcnt lgkmcnt(6)
    v_mfma_f32_32x32x16_bf16 v[80:95], v[44:47], v[196:199], v[80:95]
    v_rcp_f32 v79, v79
    v_mul_f32 v132, v132, v76
    v_mul_f32 v133, v133, v77
    v_mul_f32 v134, v134, v78
    v_mul_f32 v135, v135, v79
    ds_read_b64_tr_b16 v[40:41], v11 offset:9216
    ds_read_b64_tr_b16 v[42:43], v11 offset:9472
    s_waitcnt lgkmcnt(6)
    v_mfma_f32_32x32x16_bf16 v[80:95], v[48:51], v[200:203], v[80:95]
    v_mul_f32 v72, v136, v136
    v_mul_f32 v73, v137, v137
    v_mul_f32 v74, v138, v138
    v_mul_f32 v75, v139, v139
    ds_read_b64_tr_b16 v[44:45], v11 offset:10240
    ds_read_b64_tr_b16 v[46:47], v11 offset:10496
    s_waitcnt lgkmcnt(6)
    v_mfma_f32_32x32x16_bf16 v[80:95], v[52:55], v[204:207], v[80:95]
    v_fma_f32 v72, v72, v21, v20
    v_fma_f32 v73, v73, v21, v20
    v_fma_f32 v74, v74, v21, v20
    v_fma_f32 v75, v75, v21, v20
    v_mul_f32_e64 v72, v72, v136
    ds_read_b64_tr_b16 v[48:49], v11 offset:11264
    ds_read_b64_tr_b16 v[50:51], v11 offset:11520
    s_waitcnt lgkmcnt(6)
    v_mfma_f32_32x32x16_bf16 v[80:95], v[56:59], v[208:211], v[80:95]
    v_mul_f32 v73, v73, v137
    v_mul_f32 v74, v74, v138
    v_mul_f32 v75, v75, v139
    v_exp_f32_e64 v72, v72
    v_exp_f32 v73, v73
    s_lshr_b32 s16, s4, 4
    s_lshl_b32 s34, s3, 1
    s_add_u32 s16, s16, s34
    s_and_b32 s17, s4, 15
    s_lshl_b32 s21, s17, 2
    ds_read_b64_tr_b16 v[52:53], v11 offset:12288
    ds_read_b64_tr_b16 v[54:55], v11 offset:12544
    s_waitcnt lgkmcnt(6)
    v_mfma_f32_32x32x16_bf16 v[80:95], v[40:43], v[212:215], v[80:95]
    v_exp_f32 v74, v74
    v_exp_f32_e64 v75, v75
    v_fma_f32 v72, v72, v19, v19
    v_fma_f32 v73, v73, v19, v19
    s_mul_i32 s20, s14, 3
    s_add_u32 s20, s20, s21
    s_add_u32 s22, s21, s14
    v_and_b32 v104, 7, v0
    v_cmp_lt_u32 vcc, 2, v104
    ds_read_b64_tr_b16 v[56:57], v11 offset:13312
    ds_read_b64_tr_b16 v[58:59], v11 offset:13568
    s_waitcnt lgkmcnt(6)
    v_mfma_f32_32x32x16_bf16 v[80:95], v[44:47], v[216:219], v[80:95]
    v_fma_f32 v74, v74, v19, v19
    v_fma_f32 v75, v75, v19, v19
    v_rcp_f32 v72, v72
    v_rcp_f32 v73, v73
    v_rcp_f32 v74, v74
    v_subrev_u32 v105, 3, v104
    v_mov_b32 v106, 1024
    v_cndmask_b32_e64 v105, v104, v105, vcc
    v_mov_b32 v107, 2048
    v_cndmask_b32_e64 v106, v106, v107, vcc
    ds_read_b64_tr_b16 v[40:41], v11 offset:14336
    ds_read_b64_tr_b16 v[42:43], v11 offset:14592
    s_waitcnt lgkmcnt(6)
    v_mfma_f32_32x32x16_bf16 v[80:95], v[48:51], v[220:223], v[80:95]
    v_rcp_f32 v75, v75
    v_mul_f32 v136, v136, v72
    v_mul_f32 v137, v137, v73
    v_mul_f32 v138, v138, v74
    v_mul_f32 v139, v139, v75
    v_add_u32_e64 v105, s20, v105
    v_subrev_u32 v105, 8, v105
    v_max_i32 v105, 0, v105
    v_add_u32 v105, v105, v106
    v_cmp_lt_u32 vcc, 5, v104
    ds_read_b64_tr_b16 v[44:45], v11 offset:15360
    ds_read_b64_tr_b16 v[46:47], v11 offset:15616
    s_waitcnt lgkmcnt(6)
    v_mfma_f32_32x32x16_bf16 v[80:95], v[52:55], v[224:227], v[80:95]
    v_mul_f32 v76, v140, v140
    v_mul_f32 v77, v141, v141
    v_mul_f32 v78, v142, v142
    v_mul_f32 v79, v143, v143
    v_mov_b32 v106, s22
    s_lshl_b32 s23, s16, 8
    v_cndmask_b32 v105, v105, v106, vcc
    v_lshlrev_b32 v3, 2, v105
    s_add_u32 s23, s23, 18939904
    ds_read_b64_tr_b16 v[48:49], v10 offset:36864
    ds_read_b64_tr_b16 v[50:51], v10 offset:37120
    s_waitcnt lgkmcnt(6)
    v_mfma_f32_32x32x16_bf16 v[80:95], v[56:59], v[228:231], v[80:95]
    v_fma_f32 v76, v76, v21, v20
    v_fma_f32 v77, v77, v21, v20
    v_fma_f32 v78, v78, v21, v20
    v_fma_f32 v79, v79, v21, v20
    v_mul_f32_e64 v76, v76, v140
    s_mul_i32 s21, s14, 12288
    s_add_u32 s21, s21, 86016
    s_lshl_b32 s24, s16, 17
    s_mov_b32 s25, 0
    buffer_load_dword v6, v3, s[48:51], s23 offen sc1
    ds_read_b64_tr_b16 v[52:53], v10 offset:37888
    ds_read_b64_tr_b16 v[54:55], v10 offset:38144
    s_waitcnt lgkmcnt(6)
    v_mfma_f32_32x32x16_bf16 v[80:95], v[40:43], v[232:235], v[80:95]
    v_mul_f32 v77, v77, v141
    v_mul_f32 v78, v78, v142
    v_mul_f32 v79, v79, v143
    v_exp_f32 v76, v76
    v_exp_f32 v77, v77
    ds_read_b64_tr_b16 v[56:57], v10 offset:38912
    ds_read_b64_tr_b16 v[58:59], v10 offset:39168
    s_waitcnt lgkmcnt(6)
    v_mfma_f32_32x32x16_bf16 v[80:95], v[44:47], v[236:239], v[80:95]
    v_exp_f32 v78, v78
    v_exp_f32_e64 v79, v79
    v_fma_f32 v76, v76, v19, v19
    v_fma_f32 v77, v77, v19, v19
    ds_read_b64_tr_b16 v[40:41], v10 offset:39936
    ds_read_b64_tr_b16 v[42:43], v10 offset:40192
    s_waitcnt lgkmcnt(6)
    v_mfma_f32_32x32x16_bf16 v[80:95], v[48:51], v[240:243], v[80:95]
    v_fma_f32 v78, v78, v19, v19
    v_fma_f32 v79, v79, v19, v19
    v_rcp_f32 v76, v76
    v_rcp_f32_e64 v77, v77
    v_rcp_f32 v78, v78
    s_waitcnt lgkmcnt(4)
    v_mfma_f32_32x32x16_bf16 v[80:95], v[52:55], v[244:247], v[80:95]
    s_waitcnt lgkmcnt(0)
    s_mov_b64 exec, 1
    ds_add_u32 v5, v9 offset:80
    s_mov_b64 exec, -1
    v_rcp_f32 v79, v79
    v_mul_f32 v140, v140, v76
    v_mul_f32 v141, v141, v77
    v_mul_f32 v142, v142, v78
    v_mul_f32 v143, v143, v79
    v_mfma_f32_32x32x16_bf16 v[80:95], v[56:59], v[248:251], v[80:95]
    v_mfma_f32_32x32x16_bf16 v[80:95], v[40:43], v[252:255], v[80:95]
    s_lshl_b32 s99, s8, 7
    s_lshl_b32 s34, s7, 2
    s_add_u32 s99, s99, s34
    s_add_u32 s99, s99, 18956288
    s_nop 7
    v_mul_f32 v128, v128, v80
    v_mul_f32 v129, v129, v81
    v_mul_f32 v130, v130, v82
    v_mul_f32 v131, v131, v83
    v_mul_f32 v132, v132, v84
    v_mul_f32 v133, v133, v85
    v_mul_f32 v134, v134, v86
    v_mul_f32 v135, v135, v87
    v_cvt_pk_bf16_f32 v128, v128, v129
    v_cvt_pk_bf16_f32 v129, v130, v131
    v_cvt_pk_bf16_f32 v130, v132, v133
    v_cvt_pk_bf16_f32 v131, v134, v135
    buffer_store_dwordx4 v[128:131], v1, s[48:51], s18 offen offset:0 sc1
    v_mul_f32 v136, v136, v88
    v_mul_f32 v137, v137, v89
    v_mul_f32 v138, v138, v90
    v_mul_f32 v139, v139, v91
    v_mul_f32 v140, v140, v92
    v_mul_f32 v141, v141, v93
    v_mul_f32 v142, v142, v94
    v_mul_f32 v143, v143, v95
    v_cvt_pk_bf16_f32 v136, v136, v137
    v_cvt_pk_bf16_f32 v137, v138, v139
    v_cvt_pk_bf16_f32 v138, v140, v141
    v_cvt_pk_bf16_f32 v139, v142, v143
    buffer_store_dwordx4 v[136:139], v1, s[48:51], s18 offen offset:1024 sc1
    s_waitcnt vmcnt(2)
    s_branch L_attn
L_p1g_B:
    ds_read_b128 v[72:75], v16 offset:1024
    ds_read_b128 v[76:79], v16 offset:1536
    ds_read_b64_tr_b16 v[40:41], v10 offset:0
    ds_read_b64_tr_b16 v[42:43], v10 offset:256
    ds_read_b64_tr_b16 v[44:45], v10 offset:1024
    ds_read_b64_tr_b16 v[46:47], v10 offset:1280
    ds_read_b64_tr_b16 v[48:49], v10 offset:2048
    ds_read_b64_tr_b16 v[50:51], v10 offset:2304
    v_mfma_f32_32x32x16_bf16 v[80:95], v[52:55], v[252:255], v[80:95]
    v_mfma_f32_32x32x16_bf16 v[96:111], v[56:59], v[252:255], v[96:111]
    ds_read_b64_tr_b16 v[52:53], v10 offset:3072
    ds_read_b64_tr_b16 v[54:55], v10 offset:3328
    s_waitcnt lgkmcnt(6)
    v_mfma_f32_32x32x16_bf16 v[128:143], v[40:43], v[144:147], 0
    s_cmp_eq_u32 s15, 0
    s_cselect_b32 s34, s92, s93
    s_cselect_b32 s35, 0, 4096
    s_mul_i32 s34, s34, 229376
    s_add_u32 s35, s35, s30
    s_add_u32 m0, s35, 57344
    s_add_u32 s34, s34, s29
    buffer_load_dwordx4 v4, s[40:43], s34 offen lds
    v_add_f32 v72, v72, v76
    v_add_f32 v73, v73, v77
    v_add_f32 v74, v74, v78
    v_add_f32 v75, v75, v79
    v_add_f32 v72, v72, v73
    v_add_f32_e64 v74, v74, v75
    ds_read_b64_tr_b16 v[56:57], v10 offset:4096
    ds_read_b64_tr_b16 v[58:59], v10 offset:4352
    ds_read_b64_tr_b16 v[60:61], v13 offset:0
    ds_read_b64_tr_b16 v[62:63], v13 offset:256
    s_waitcnt lgkmcnt(8)
    v_mfma_f32_32x32x16_bf16 v[128:143], v[44:47], v[148:151], v[128:143]
    s_cmp_eq_u32 s15, 0
    s_cselect_b32 s34, s94, s95
    s_cselect_b32 s35, 0, 4096
    s_mul_i32 s34, s34, 229376
    s_add_u32 s35, s35, s30
    s_add_u32 m0, s35, 65536
    s_add_u32 s34, s34, s29
    buffer_load_dwordx4 v4, s[40:43], s34 offen lds
    v_add_f32 v72, v72, v74
    v_cvt_pk_bf16_f32 v73, v72, v72
    v_and_b32 v73, 0xffff0000, v73
    v_sub_f32_e64 v73, v72, v73
    v_cvt_pk_bf16_f32 v32, v72, v73
    v_cvt_pk_bf16_f32 v33, v72, v73
    ds_read_b128 v[72:75], v16 offset:0
    ds_read_b64_tr_b16 v[40:41], v10 offset:5120
    ds_read_b64_tr_b16 v[42:43], v10 offset:5376
    s_waitcnt lgkmcnt(9)
    v_mfma_f32_32x32x16_bf16 v[128:143], v[48:51], v[152:155], v[128:143]
    ds_read_b128 v[76:79], v16 offset:512
    v_mfma_f32_32x32x16_bf16 v[112:127], v[32:35], v[28:31], v[112:127]
    s_waitcnt lgkmcnt(3)
    v_add_f32 v72, v72, v73
    v_add_f32 v74, v74, v75
    v_add_f32_e64 v72, v72, v74
    v_cvt_pk_bf16_f32 v73, v72, v72
    v_mfma_f32_16x16x32_bf16 v[64:67], v[24:27], v[60:63], 0
    ds_read_b64_tr_b16 v[44:45], v10 offset:6144
    ds_read_b64_tr_b16 v[46:47], v10 offset:6400
    ds_read_b64_tr_b16 v[60:61], v13 offset:8192
    ds_read_b64_tr_b16 v[62:63], v13 offset:8448
    v_mfma_f32_32x32x16_bf16 v[128:143], v[52:55], v[156:159], v[128:143]
    v_and_b32 v73, 0xffff0000, v73
    v_sub_f32_e64 v73, v72, v73
    v_cvt_pk_bf16_f32 v36, v72, v73
    v_cvt_pk_bf16_f32 v37, v72, v73
    s_nop 1
    v_mfma_f32_32x32x16_bf16 v[80:95], v[36:39], v[28:31], v[80:95]
    s_waitcnt lgkmcnt(4)
    v_add_f32 v76, v76, v77
    v_add_f32 v78, v78, v79
    ds_read_b64_tr_b16 v[48:49], v10 offset:7168
    ds_read_b64_tr_b16 v[50:51], v10 offset:7424
    v_mfma_f32_32x32x16_bf16 v[128:143], v[56:59], v[160:163], v[128:143]
    v_add_f32_e64 v76, v76, v78
    v_cvt_pk_bf16_f32 v77, v76, v76
    v_and_b32 v77, 0xffff0000, v77
    v_sub_f32_e64 v77, v76, v77
    v_cvt_pk_bf16_f32 v32, v76, v77
    v_cvt_pk_bf16_f32 v33, v76, v77
    s_nop 1
    v_mfma_f32_32x32x16_bf16 v[96:111], v[32:35], v[28:31], v[96:111]
    s_waitcnt lgkmcnt(2)
    v_mfma_f32_16x16x32_bf16 v[64:67], v[24:27], v[60:63], v[64:67]
    ds_read_b64_tr_b16 v[52:53], v10 offset:8192
    ds_read_b64_tr_b16 v[54:55], v10 offset:8448
    ds_read_b64_tr_b16 v[60:61], v13 offset:40960
    ds_read_b64_tr_b16 v[62:63], v13 offset:41216
    v_mfma_f32_32x32x16_bf16 v[128:143], v[40:43], v[164:167], v[128:143]
    v_mul_f32 v112, v112, v18
    v_mul_f32 v113, v113, v18
    v_mul_f32 v114, v114, v18
    v_mul_f32 v115, v115, v18
    v_mul_f32 v116, v116, v18
    v_mul_f32 v117, v117, v18
    v_mul_f32_e64 v118, v118, v18
    ds_read_b64_tr_b16 v[56:57], v10 offset:9216
    ds_read_b64_tr_b16 v[58:59], v10 offset:9472
    v_mfma_f32_32x32x16_bf16 v[128:143], v[44:47], v[168:171], v[128:143]
    v_mul_f32 v119, v119, v18
    v_mul_f32 v120, v120, v18
    v_mul_f32 v121, v121, v18
    v_mul_f32 v122, v122, v18
    v_mul_f32 v123, v123, v18
    v_mul_f32 v124, v124, v18
    v_mul_f32_e64 v125, v125, v18
    v_mul_f32 v126, v126, v18
    s_waitcnt lgkmcnt(2)
    v_mfma_f32_16x16x32_bf16 v[64:67], v[24:27], v[60:63], v[64:67]
    ds_read_b64_tr_b16 v[40:41], v10 offset:10240
    ds_read_b64_tr_b16 v[42:43], v10 offset:10496
    ds_read_b64_tr_b16 v[60:61], v13 offset:16384
    ds_read_b64_tr_b16 v[62:63], v13 offset:16640
    v_mfma_f32_32x32x16_bf16 v[128:143], v[48:51], v[172:175], v[128:143]
    v_mul_f32_e64 v127, v127, v18
    v_cvt_pk_bf16_f32 v112, v112, v113
    v_cvt_pk_bf16_f32 v113, v114, v115
    v_cvt_pk_bf16_f32 v114, v116, v117
    v_cvt_pk_bf16_f32 v115, v118, v119
    v_cvt_pk_bf16_f32 v116, v120, v121
    v_cvt_pk_bf16_f32 v117, v122, v123
    ds_read_b64_tr_b16 v[44:45], v10 offset:11264
    ds_read_b64_tr_b16 v[46:47], v10 offset:11520
    v_mfma_f32_32x32x16_bf16 v[128:143], v[52:55], v[176:179], v[128:143]
    v_cvt_pk_bf16_f32 v118, v124, v125
    v_cvt_pk_bf16_f32 v119, v126, v127
    v_mov_b32 v120, s28
    v_cndmask_b32 v119, v119, 0, s[72:73]
    v_cndmask_b32 v118, v118, v120, s[72:73]
    buffer_store_dwordx4 v[112:115], v1, s[48:51], s22 offen sc1
    buffer_store_dwordx4 v[116:119], v1, s[48:51], s22 offen offset:1024 sc1
    s_waitcnt lgkmcnt(2)
    s_cmp_lg_u32 s15, 0
    s_cbranch_scc1 L_sk28
    v_mfma_f32_16x16x32_bf16 v[64:67], v[24:27], v[60:63], v[64:67]
L_sk28:
    ds_read_b64_tr_b16 v[48:49], v10 offset:12288
    ds_read_b64_tr_b16 v[50:51], v10 offset:12544
    ds_read_b64_tr_b16 v[60:61], v13 offset:28672
    ds_read_b64_tr_b16 v[62:63], v13 offset:28928
    v_mfma_f32_32x32x16_bf16 v[128:143], v[56:59], v[180:183], v[128:143]
    v_mul_f32 v80, v80, v18
    v_mul_f32 v81, v81, v18
    v_mul_f32 v82, v82, v18
    v_mul_f32 v83, v83, v18
    v_mul_f32 v84, v84, v18
    v_mul_f32 v85, v85, v18
    v_mul_f32_e64 v86, v86, v18
    ds_read_b64_tr_b16 v[52:53], v10 offset:13312
    ds_read_b64_tr_b16 v[54:55], v10 offset:13568
    v_mfma_f32_32x32x16_bf16 v[128:143], v[40:43], v[184:187], v[128:143]
    v_mul_f32 v87, v87, v18
    v_mul_f32 v88, v88, v18
    v_mul_f32 v89, v89, v18
    v_mul_f32 v90, v90, v18
    v_mul_f32 v91, v91, v18
    v_mul_f32 v92, v92, v18
    v_mul_f32 v93, v93, v18
    v_mul_f32 v94, v94, v18
    s_waitcnt lgkmcnt(2)
    v_mfma_f32_16x16x32_bf16 v[68:71], v[24:27], v[60:63], 0
    ds_read_b64_tr_b16 v[56:57], v10 offset:14336
    ds_read_b64_tr_b16 v[58:59], v10 offset:14592
    s_waitcnt vmcnt(3)
    ds_read_b64_tr_b16 v[60:61], v7 offset:0
    ds_read_b64_tr_b16 v[62:63], v7 offset:256
    v_mfma_f32_32x32x16_bf16 v[128:143], v[44:47], v[188:191], v[128:143]
    v_mul_f32_e64 v95, v95, v18
    v_cvt_pk_bf16_f32 v80, v80, v81
    v_cvt_pk_bf16_f32 v81, v82, v83
    v_cvt_pk_bf16_f32 v82, v84, v85
    v_cvt_pk_bf16_f32 v83, v86, v87
    v_cvt_pk_bf16_f32 v84, v88, v89
    v_cvt_pk_bf16_f32 v85, v90, v91
    ds_write_b32 v15, v64 offset:2048
    ds_read_b64_tr_b16 v[40:41], v10 offset:15360
    ds_read_b64_tr_b16 v[42:43], v10 offset:15616
    v_mfma_f32_32x32x16_bf16 v[128:143], v[48:51], v[192:195], v[128:143]
    v_cvt_pk_bf16_f32 v86, v92, v93
    v_cvt_pk_bf16_f32 v87, v94, v95
    v_mov_b32_e64 v88, s26
    v_cndmask_b32 v87, v87, 0, s[72:73]
    v_cndmask_b32 v86, v86, v88, s[72:73]
    buffer_store_dwordx4 v[80:83], v1, s[48:51], s20 offen sc1
    buffer_store_dwordx4 v[84:87], v1, s[48:51], s20 offen offset:1024 sc1
    s_waitcnt lgkmcnt(3)
    v_mfma_f32_16x16x32_bf16 v[68:71], v[24:27], v[60:63], v[68:71]
    ds_read_b64_tr_b16 v[44:45], v10 offset:40960
    ds_read_b64_tr_b16 v[46:47], v10 offset:41216
    s_waitcnt vmcnt(4)
    ds_read_b64_tr_b16 v[60:61], v7 offset:8192
    ds_read_b64_tr_b16 v[62:63], v7 offset:8448
    v_mfma_f32_32x32x16_bf16 v[128:143], v[52:55], v[196:199], v[128:143]
    v_mul_f32 v96, v96, v18
    v_mul_f32 v97, v97, v18
    v_mul_f32 v98, v98, v18
    v_mul_f32 v99, v99, v18
    v_mul_f32 v100, v100, v18
    v_mul_f32 v101, v101, v18
    v_mul_f32 v102, v102, v18
    v_mul_f32 v103, v103, v18
    ds_read_b64_tr_b16 v[48:49], v10 offset:41984
    ds_read_b64_tr_b16 v[50:51], v10 offset:42240
    v_mfma_f32_32x32x16_bf16 v[128:143], v[56:59], v[200:203], v[128:143]
    v_mul_f32 v104, v104, v18
    v_mul_f32 v105, v105, v18
    v_mul_f32 v106, v106, v18
    v_mul_f32 v107, v107, v18
    v_mul_f32 v108, v108, v18
    v_mul_f32 v109, v109, v18
    v_mul_f32 v110, v110, v18
    s_waitcnt lgkmcnt(2)
    v_mfma_f32_16x16x32_bf16 v[68:71], v[24:27], v[60:63], v[68:71]
    ds_read_b64_tr_b16 v[52:53], v10 offset:43008
    ds_read_b64_tr_b16 v[54:55], v10 offset:43264
    ds_read_b64_tr_b16 v[60:61], v13 offset:36864
    ds_read_b64_tr_b16 v[62:63], v13 offset:37120
    v_mfma_f32_32x32x16_bf16 v[128:143], v[40:43], v[204:207], v[128:143]
    v_mul_f32_e64 v111, v111, v18
    v_cvt_pk_bf16_f32 v96, v96, v97
    v_cvt_pk_bf16_f32 v97, v98, v99
    v_cvt_pk_bf16_f32 v98, v100, v101
    v_cvt_pk_bf16_f32 v99, v102, v103
    v_cvt_pk_bf16_f32 v100, v104, v105
    v_cvt_pk_bf16_f32 v101, v106, v107
    ds_read_b64_tr_b16 v[56:57], v10 offset:44032
    ds_read_b64_tr_b16 v[58:59], v10 offset:44288
    v_mfma_f32_32x32x16_bf16 v[128:143], v[44:47], v[208:211], v[128:143]
    v_cvt_pk_bf16_f32 v102, v108, v109
    v_cvt_pk_bf16_f32 v103, v110, v111
    v_mov_b32_e64 v104, s27
    v_cndmask_b32 v103, v103, 0, s[72:73]
    v_cndmask_b32 v102, v102, v104, s[72:73]
    buffer_store_dwordx4 v[96:99], v1, s[48:51], s21 offen sc1
    buffer_store_dwordx4 v[100:103], v1, s[48:51], s21 offen offset:1024 sc1
    s_setprio 2
    s_waitcnt lgkmcnt(2)
    s_cmp_lg_u32 s15, 0
    s_cbranch_scc1 L_sk29
    v_mfma_f32_16x16x32_bf16 v[68:71], v[24:27], v[60:63], v[68:71]
L_sk29:
    ds_read_b64_tr_b16 v[40:41], v10 offset:45056
    ds_read_b64_tr_b16 v[42:43], v10 offset:45312
    v_mfma_f32_32x32x16_bf16 v[128:143], v[48:51], v[212:215], v[128:143]
    ds_read_b64_tr_b16 v[44:45], v10 offset:46080
    ds_read_b64_tr_b16 v[46:47], v10 offset:46336
    v_mfma_f32_32x32x16_bf16 v[128:143], v[52:55], v[216:219], v[128:143]
    s_min_u32 s34, s4, 27
    s_lshr_b32 s35, s34, 2
    s_and_b32 s34, s34, 3
    s_lshl_b32 s34, s34, 1
    s_add_u32 s34, s34, s35
    s_add_u32 s34, s34, s3
    s_mul_i32 s13, s34, 37
    ds_read_b64_tr_b16 v[48:49], v10 offset:47104
    ds_read_b64_tr_b16 v[50:51], v10 offset:47360
    s_waitcnt lgkmcnt(6)
    v_mfma_f32_32x32x16_bf16 v[128:143], v[56:59], v[220:223], v[128:143]
    s_lshr_b32 s13, s13, 8
    s_mul_i32 s13, s13, 7
    s_sub_u32 s10, s34, s13
    s_lshl_b32 s10, s10, 2
    s_lshl_b32 s35, s35, 7
    s_mul_i32 s12, s14, 401408
    s_add_u32 s12, s12, s35
    ds_write_b32 v15, v68 offset:3072
    ds_read_b64_tr_b16 v[52:53], v10 offset:48128
    ds_read_b64_tr_b16 v[54:55], v10 offset:48384
    s_waitcnt lgkmcnt(7)
    v_mfma_f32_32x32x16_bf16 v[128:143], v[40:43], v[224:227], v[128:143]
    s_add_u32 s13, s12, 401408
    s_mul_i32 s9, s10, 14336
    s_add_u32 s9, s9, s12
    s_lshl_b32 s11, s14, 11
    s_cmp_lt_u32 s4, 28
    s_cselect_b32 s58, s58, 0
    v_and_b32 v2, 7, v0
    ds_read_b64_tr_b16 v[56:57], v10 offset:16384
    ds_read_b64_tr_b16 v[58:59], v10 offset:16640
    s_waitcnt lgkmcnt(7)
    v_mfma_f32_32x32x16_bf16 v[128:143], v[44:47], v[228:231], v[128:143]
    s_waitcnt lgkmcnt(4)
    s_mov_b64 exec, 1
    ds_add_u32 v5, v9 offset:48
    s_mov_b64 exec, -1
    v_bfe_u32 v3, v0, 4, 1
    v_lshlrev_b32 v3, 2, v3
    v_xor_b32 v2, v2, v3
    v_lshlrev_b32 v2, 4, v2
    v_lshrrev_b32 v3, 3, v0
    v_mul_u32_u24 v3, 896, v3
    v_add_u32_e64 v2, v2, v3
    v_add_u32 v3, 6144, v2
    ds_read_b64_tr_b16 v[40:41], v10 offset:17408
    ds_read_b64_tr_b16 v[42:43], v10 offset:17664
    v_mfma_f32_32x32x16_bf16 v[128:143], v[48:51], v[232:235], v[128:143]
    ds_read_b64_tr_b16 v[44:45], v10 offset:18432
    ds_read_b64_tr_b16 v[46:47], v10 offset:18688
    s_waitcnt lgkmcnt(7)
    v_mfma_f32_32x32x16_bf16 v[128:143], v[52:55], v[236:239], v[128:143]
    v_mov_b32 v23, s97
    s_waitcnt vmcnt(0)
    buffer_store_dword v23, off, s[48:51], s19 offset:0 sc1
    buffer_store_dword v23, off, s[48:51], s19 offset:256 sc1
    buffer_store_dword v23, off, s[48:51], s19 offset:512 sc1
    ds_read_b64_tr_b16 v[48:49], v10 offset:19456
    ds_read_b64_tr_b16 v[50:51], v10 offset:19712
    s_waitcnt lgkmcnt(7)
    v_mfma_f32_32x32x16_bf16 v[128:143], v[56:59], v[240:243], v[128:143]
    s_mov_b32 s76, 200000
L_ll26:
    ds_read_b32 v23, v5 offset:48
    s_waitcnt lgkmcnt(0)
    v_readfirstlane_b32 s77, v23
    s_nop 0
    s_cmp_eq_u32 s77, 8
    s_cbranch_scc1 L_lk26
    s_sleep 1
    s_sub_u32 s76, s76, 1
    s_cbranch_scc0 L_ll26
L_lk26:
    ds_read_b128 v[72:75], v16 offset:2048
    ds_read_b128 v[76:79], v16 offset:2560
    ds_read_b128 v[96:99], v16 offset:3072
    ds_read_b128 v[100:103], v16 offset:3584
    s_add_u32 m0, s11, 49152
    s_nop 0
    buffer_load_dwordx4 v2, s[56:59], s9 offen lds
    ds_read_b64_tr_b16 v[52:53], v10 offset:28672
    ds_read_b64_tr_b16 v[54:55], v10 offset:28928
    v_mfma_f32_32x32x16_bf16 v[128:143], v[40:43], v[244:247], v[128:143]
    s_waitcnt lgkmcnt(4)
    v_add_f32 v72, v72, v76
    v_add_f32 v73, v73, v77
    v_add_f32 v74, v74, v78
    v_add_f32 v75, v75, v79
    v_add_f32 v72, v72, v73
    s_add_u32 m0, s11, 49152
    s_nop 0
    buffer_load_dwordx4 v3, s[56:59], s9 offen offset:1024 lds
    s_add_u32 s9, s9, 14336
    s_cmp_eq_u32 s9, s13
    s_cselect_b32 s9, s12, s9
    ds_read_b64_tr_b16 v[56:57], v10 offset:29696
    ds_read_b64_tr_b16 v[58:59], v10 offset:29952
    v_mfma_f32_32x32x16_bf16 v[128:143], v[44:47], v[248:251], v[128:143]
    v_add_f32 v74, v74, v75
    v_add_f32 v72, v72, v74
    v_cvt_pk_bf16_f32 v73, v72, v72
    v_and_b32 v73, 0xffff0000, v73
    v_sub_f32 v73, v72, v73
    v_cvt_pk_bf16_f32 v36, v72, v73
    v_cvt_pk_bf16_f32 v37, v72, v73
    s_add_u32 m0, s11, 73728
    s_nop 0
    buffer_load_dwordx4 v2, s[56:59], s9 offen lds
    ds_read_b64_tr_b16 v[40:41], v10 offset:30720
    ds_read_b64_tr_b16 v[42:43], v10 offset:30976
    v_mfma_f32_32x32x16_bf16 v[128:143], v[48:51], v[252:255], v[128:143]
    v_mfma_f32_32x32x16_bf16 v[128:143], v[36:39], v[28:31], v[128:143]
    s_waitcnt lgkmcnt(6)
    v_add_f32 v96, v96, v100
    v_add_f32 v97, v97, v101
    v_add_f32 v98, v98, v102
    v_add_f32_e64 v99, v99, v103
    v_add_f32 v96, v96, v97
    s_add_u32 m0, s11, 73728
    s_nop 0
    buffer_load_dwordx4 v3, s[56:59], s9 offen offset:1024 lds
    s_add_u32 s9, s9, 14336
    s_cmp_eq_u32 s9, s13
    s_cselect_b32 s9, s12, s9
    ds_read_b64_tr_b16 v[44:45], v10 offset:31744
    ds_read_b64_tr_b16 v[46:47], v10 offset:32000
    s_waitcnt lgkmcnt(6)
    v_mfma_f32_32x32x16_bf16 v[80:95], v[52:55], v[144:147], 0
    v_add_f32 v98, v98, v99
    v_add_f32_e64 v96, v96, v98
    v_cvt_pk_bf16_f32 v97, v96, v96
    v_and_b32 v97, 0xffff0000, v97
    v_sub_f32 v97, v96, v97
    v_cvt_pk_bf16_f32 v32, v96, v97
    v_cvt_pk_bf16_f32 v33, v96, v97
    s_add_u32 m0, s11, 143360
    s_nop 0
    buffer_load_dwordx4 v2, s[56:59], s9 offen lds
    ds_read_b64_tr_b16 v[48:49], v10 offset:32768
    ds_read_b64_tr_b16 v[50:51], v10 offset:33024
    s_waitcnt lgkmcnt(6)
    v_mfma_f32_32x32x16_bf16 v[80:95], v[56:59], v[148:151], v[80:95]
    v_mfma_f32_32x32x16_bf16 v[80:95], v[32:35], v[28:31], v[80:95]
    s_mov_b64 exec, 1
    ds_add_u32 v5, v9 offset:64
    s_mov_b64 exec, -1
    s_add_u32 m0, s11, 143360
    s_nop 0
    buffer_load_dwordx4 v3, s[56:59], s9 offen offset:1024 lds
    s_add_u32 s9, s9, 14336
    s_cmp_eq_u32 s9, s13
    s_cselect_b32 s9, s12, s9
    ds_read_b64_tr_b16 v[52:53], v10 offset:33792
    ds_read_b64_tr_b16 v[54:55], v10 offset:34048
    s_waitcnt lgkmcnt(7)
    v_mfma_f32_32x32x16_bf16 v[80:95], v[40:43], v[152:155], v[80:95]
    v_mul_f32 v72, v128, v128
    v_mul_f32 v73, v129, v129
    v_mul_f32 v74, v130, v130
    v_mul_f32 v75, v131, v131
    v_lshrrev_b32 v150, 5, v0
    v_bfe_u32 v151, v0, 2, 2
    v_lshl_add_u32 v144, v150, 3, v151
    v_lshlrev_b32 v144, 7, v144
    v_lshrrev_b32 v151, 1, v151
    s_lshl_b32 s76, s4, 3
    s_add_u32 s76, s76, s5
    v_min_u32 v23, 12, v0
    v_lshlrev_b32 v23, 7, v23
    s_mul_i32 s77, s76, 1568
    buffer_load_dword v127, v23, s[60:63], s77 offen
    ds_read_b64_tr_b16 v[56:57], v10 offset:34816
    ds_read_b64_tr_b16 v[58:59], v10 offset:35072
    s_nop 0
    s_waitcnt lgkmcnt(7)
    v_mfma_f32_32x32x16_bf16 v[80:95], v[44:47], v[156:159], v[80:95]
    v_fma_f32 v72, v72, v21, v20
    v_fma_f32 v73, v73, v21, v20
    v_fma_f32 v74, v74, v21, v20
    v_fma_f32 v75, v75, v21, v20
    v_mul_f32_e64 v72, v72, v128
    v_lshl_add_u32 v144, v151, 6, v144
    v_bfe_u32 v151, v0, 4, 1
    v_lshl_add_u32 v144, v151, 5, v144
    v_and_b32_e64 v151, 1, v0
    v_lshl_add_u32 v144, v151, 4, v144
    v_bfe_u32 v151, v0, 1, 1
    ds_read_b64_tr_b16 v[40:41], v10 offset:35840
    ds_read_b64_tr_b16 v[42:43], v10 offset:36096
    s_waitcnt lgkmcnt(7)
    v_mfma_f32_32x32x16_bf16 v[80:95], v[48:51], v[160:163], v[80:95]
    v_mul_f32 v73, v73, v129
    v_mul_f32 v74, v74, v130
    v_mul_f32 v75, v75, v131
    v_exp_f32 v72, v72
    v_exp_f32 v73, v73
    v_lshl_add_u32 v144, v151, 3, v144
    s_lshr_b32 s34, s14, 1
    s_lshl_b32 s34, s34, 6
    v_xor_b32_e64 v144, s34, v144
    s_lshl_b32 s34, s14, 11
    s_add_u32 s34, s34, 0
    ds_read_b64_tr_b16 v[44:45], v11 offset:0
    ds_read_b64_tr_b16 v[46:47], v11 offset:256
    s_waitcnt lgkmcnt(6)
    v_mfma_f32_32x32x16_bf16 v[80:95], v[52:55], v[164:167], v[80:95]
    v_exp_f32 v74, v74
    v_exp_f32_e64 v75, v75
    v_fma_f32 v72, v72, v19, v19
    v_fma_f32 v73, v73, v19, v19
    v_add_u32 v144, s34, v144
    v_xor_b32 v145, 64, v144
    v_add_u32 v146, 0x10000, v144
    v_add_u32 v147, 0x10000, v145
    v_add_u32 v148, 0x20000, v144
    v_add_u32 v149, 0x20000, v145
    s_mov_b32 s76, 200000
L_ll27:
    ds_read_b32 v23, v5 offset:64
    s_waitcnt lgkmcnt(0)
    v_readfirstlane_b32 s77, v23
    s_nop 0
    s_cmp_eq_u32 s77, 8
    s_cbranch_scc1 L_lk27
    s_sleep 1
    s_sub_u32 s76, s76, 1
    s_cbranch_scc0 L_ll27
L_lk27:
    ds_read_b64_tr_b16 v[48:49], v11 offset:1024
    ds_read_b64_tr_b16 v[50:51], v11 offset:1280
    v_mfma_f32_32x32x16_bf16 v[80:95], v[56:59], v[168:171], v[80:95]
    v_fma_f32 v74, v74, v19, v19
    v_fma_f32 v75, v75, v19, v19
    v_rcp_f32 v72, v72
    v_rcp_f32 v73, v73
    v_rcp_f32 v74, v74
    s_add_u32 m0, s11, 40960
    s_nop 0
    buffer_load_dwordx4 v2, s[56:59], s9 offen lds
    ds_read_b64_tr_b16 v[52:53], v11 offset:2048
    ds_read_b64_tr_b16 v[54:55], v11 offset:2304
    v_mfma_f32_32x32x16_bf16 v[80:95], v[40:43], v[172:175], v[80:95]
    v_rcp_f32 v75, v75
    v_mul_f32 v128, v128, v72
    v_mul_f32 v129, v129, v73
    v_mul_f32 v130, v130, v74
    v_mul_f32 v131, v131, v75
    s_add_u32 m0, s11, 40960
    s_nop 0
    buffer_load_dwordx4 v3, s[56:59], s9 offen offset:1024 lds
    s_add_u32 s9, s9, 14336
    s_cmp_eq_u32 s9, s13
    s_cselect_b32 s9, s12, s9
    ds_read_b64_tr_b16 v[56:57], v11 offset:3072
    ds_read_b64_tr_b16 v[58:59], v11 offset:3328
    v_mfma_f32_32x32x16_bf16 v[80:95], v[44:47], v[176:179], v[80:95]
    v_mul_f32 v76, v132, v132
    v_mul_f32 v77, v133, v133
    v_mul_f32_e64 v78, v134, v134
    v_mul_f32 v79, v135, v135
    ds_read_b64_tr_b16 v[40:41], v11 offset:4096
    ds_read_b64_tr_b16 v[42:43], v11 offset:4352
    s_waitcnt lgkmcnt(6)
    v_mfma_f32_32x32x16_bf16 v[80:95], v[48:51], v[180:183], v[80:95]
    v_fma_f32 v76, v76, v21, v20
    v_fma_f32 v77, v77, v21, v20
    v_fma_f32 v78, v78, v21, v20
    v_fma_f32 v79, v79, v21, v20
    v_mul_f32_e64 v76, v76, v132
    ds_read_b64_tr_b16 v[44:45], v11 offset:5120
    ds_read_b64_tr_b16 v[46:47], v11 offset:5376
    s_waitcnt lgkmcnt(6)
    v_mfma_f32_32x32x16_bf16 v[80:95], v[52:55], v[184:187], v[80:95]
    v_mul_f32 v77, v77, v133
    v_mul_f32 v78, v78, v134
    v_mul_f32 v79, v79, v135
    v_exp_f32 v76, v76
    v_exp_f32 v77, v77
    ds_read_b64_tr_b16 v[48:49], v11 offset:6144
    ds_read_b64_tr_b16 v[50:51], v11 offset:6400
    s_waitcnt lgkmcnt(6)
    v_mfma_f32_32x32x16_bf16 v[80:95], v[56:59], v[188:191], v[80:95]
    v_exp_f32 v78, v78
    v_exp_f32_e64 v79, v79
    v_fma_f32 v76, v76, v19, v19
    v_fma_f32 v77, v77, v19, v19
    ds_read_b64_tr_b16 v[52:53], v11 offset:7168
    ds_read_b64_tr_b16 v[54:55], v11 offset:7424
    s_waitcnt lgkmcnt(6)
    v_mfma_f32_32x32x16_bf16 v[80:95], v[40:43], v[192:195], v[80:95]
    v_fma_f32 v78, v78, v19, v19
    v_fma_f32 v79, v79, v19, v19
    v_rcp_f32 v76, v76
    v_rcp_f32 v77, v77
    v_rcp_f32 v78, v78
    ds_read_b64_tr_b16 v[56:57], v11 offset:8192
    ds_read_b64_tr_b16 v[58:59], v11 offset:8448
    s_waitcnt lgkmcnt(6)
    v_mfma_f32_32x32x16_bf16 v[80:95], v[44:47], v[196:199], v[80:95]
    v_rcp_f32 v79, v79
    v_mul_f32 v132, v132, v76
    v_mul_f32 v133, v133, v77
    v_mul_f32 v134, v134, v78
    v_mul_f32 v135, v135, v79
    ds_read_b64_tr_b16 v[40:41], v11 offset:9216
    ds_read_b64_tr_b16 v[42:43], v11 offset:9472
    s_waitcnt lgkmcnt(6)
    v_mfma_f32_32x32x16_bf16 v[80:95], v[48:51], v[200:203], v[80:95]
    v_mul_f32 v72, v136, v136
    v_mul_f32 v73, v137, v137
    v_mul_f32 v74, v138, v138
    v_mul_f32 v75, v139, v139
    ds_read_b64_tr_b16 v[44:45], v11 offset:10240
    ds_read_b64_tr_b16 v[46:47], v11 offset:10496
    s_waitcnt lgkmcnt(6)
    v_mfma_f32_32x32x16_bf16 v[80:95], v[52:55], v[204:207], v[80:95]
    v_fma_f32 v72, v72, v21, v20
    v_fma_f32 v73, v73, v21, v20
    v_fma_f32 v74, v74, v21, v20
    v_fma_f32 v75, v75, v21, v20
    v_mul_f32 v72, v72, v136
    s_waitcnt vmcnt(7)
    ds_read_b64_tr_b16 v[152:153], v144 offset:49152
    ds_read_b64_tr_b16 v[154:155], v144 offset:49664
    ds_read_b64_tr_b16 v[156:157], v145 offset:49152
    ds_read_b64_tr_b16 v[158:159], v145 offset:49664
    ds_read_b64_tr_b16 v[48:49], v11 offset:11264
    ds_read_b64_tr_b16 v[50:51], v11 offset:11520
    s_waitcnt lgkmcnt(10)
    v_mfma_f32_32x32x16_bf16 v[80:95], v[56:59], v[208:211], v[80:95]
    v_mul_f32 v73, v73, v137
    v_mul_f32 v74, v74, v138
    v_mul_f32 v75, v75, v139
    v_exp_f32 v72, v72
    v_exp_f32 v73, v73
    s_waitcnt lgkmcnt(2)
    s_add_u32 m0, s11, 49152
    s_nop 0
    buffer_load_dwordx4 v2, s[56:59], s9 offen lds
    ds_read_b64_tr_b16 v[52:53], v11 offset:12288
    ds_read_b64_tr_b16 v[54:55], v11 offset:12544
    v_mfma_f32_32x32x16_bf16 v[80:95], v[40:43], v[212:215], v[80:95]
    v_exp_f32 v74, v74
    v_exp_f32 v75, v75
    v_fma_f32 v72, v72, v19, v19
    v_fma_f32 v73, v73, v19, v19
    s_waitcnt vmcnt(6)
    ds_read_b64_tr_b16 v[160:161], v146 offset:8192
    ds_read_b64_tr_b16 v[162:163], v146 offset:8704
    ds_read_b64_tr_b16 v[164:165], v147 offset:8192
    ds_read_b64_tr_b16 v[166:167], v147 offset:8704
    s_add_u32 m0, s11, 49152
    s_nop 0
    buffer_load_dwordx4 v3, s[56:59], s9 offen offset:1024 lds
    s_add_u32 s9, s9, 14336
    s_cmp_eq_u32 s9, s13
    s_cselect_b32 s9, s12, s9
    ds_read_b64_tr_b16 v[56:57], v11 offset:13312
    ds_read_b64_tr_b16 v[58:59], v11 offset:13568
    v_mfma_f32_32x32x16_bf16 v[80:95], v[44:47], v[216:219], v[80:95]
    v_fma_f32 v74, v74, v19, v19
    v_fma_f32 v75, v75, v19, v19
    v_rcp_f32 v72, v72
    v_rcp_f32 v73, v73
    v_rcp_f32_e64 v74, v74
    s_waitcnt lgkmcnt(2)
    s_add_u32 m0, s11, 73728
    s_nop 0
    buffer_load_dwordx4 v2, s[56:59], s9 offen lds
    ds_read_b64_tr_b16 v[40:41], v11 offset:14336
    ds_read_b64_tr_b16 v[42:43], v11 offset:14592
    v_mfma_f32_32x32x16_bf16 v[80:95], v[48:51], v[220:223], v[80:95]
    v_rcp_f32 v75, v75
    v_mul_f32 v136, v136, v72
    v_mul_f32 v137, v137, v73
    v_mul_f32 v138, v138, v74
    v_mul_f32 v139, v139, v75
    s_waitcnt vmcnt(6)
    ds_read_b64_tr_b16 v[168:169], v148 offset:12288
    ds_read_b64_tr_b16 v[170:171], v148 offset:12800
    ds_read_b64_tr_b16 v[172:173], v149 offset:12288
    ds_read_b64_tr_b16 v[174:175], v149 offset:12800
    s_add_u32 m0, s11, 73728
    s_nop 0
    s_nop 0
    buffer_load_dwordx4 v3, s[56:59], s9 offen offset:1024 lds
    s_add_u32 s9, s9, 14336
    s_cmp_eq_u32 s9, s13
    s_cselect_b32 s9, s12, s9
    ds_read_b64_tr_b16 v[44:45], v11 offset:15360
    ds_read_b64_tr_b16 v[46:47], v11 offset:15616
    v_mfma_f32_32x32x16_bf16 v[80:95], v[52:55], v[224:227], v[80:95]
    v_mul_f32 v76, v140, v140
    v_mul_f32 v77, v141, v141
    v_mul_f32 v78, v142, v142
    v_mul_f32 v79, v143, v143
    s_waitcnt lgkmcnt(2)
    s_add_u32 m0, s11, 143360
    s_nop 0
    buffer_load_dwordx4 v2, s[56:59], s9 offen lds
    ds_read_b64_tr_b16 v[48:49], v10 offset:36864
    ds_read_b64_tr_b16 v[50:51], v10 offset:37120
    v_mfma_f32_32x32x16_bf16 v[80:95], v[56:59], v[228:231], v[80:95]
    v_fma_f32 v76, v76, v21, v20
    v_fma_f32 v77, v77, v21, v20
    v_fma_f32 v78, v78, v21, v20
    v_fma_f32 v79, v79, v21, v20
    v_mul_f32 v76, v76, v140
    s_add_u32 m0, s11, 143360
    s_nop 0
    buffer_load_dwordx4 v3, s[56:59], s9 offen offset:1024 lds
    s_add_u32 s9, s9, 14336
    s_cmp_eq_u32 s9, s13
    s_cselect_b32 s9, s12, s9
    ds_read_b64_tr_b16 v[52:53], v10 offset:37888
    ds_read_b64_tr_b16 v[54:55], v10 offset:38144
    v_mfma_f32_32x32x16_bf16 v[80:95], v[40:43], v[232:235], v[80:95]
    v_mul_f32 v77, v77, v141
    v_mul_f32 v78, v78, v142
    v_mul_f32 v79, v79, v143
    v_exp_f32 v76, v76
    v_exp_f32 v77, v77
    s_waitcnt vmcnt(6)
    ds_read_b64_tr_b16 v[176:177], v144 offset:40960
    ds_read_b64_tr_b16 v[178:179], v144 offset:41472
    ds_read_b64_tr_b16 v[180:181], v145 offset:40960
    ds_read_b64_tr_b16 v[182:183], v145 offset:41472
    ds_read_b64_tr_b16 v[56:57], v10 offset:38912
    ds_read_b64_tr_b16 v[58:59], v10 offset:39168
    s_waitcnt lgkmcnt(10)
    v_mfma_f32_32x32x16_bf16 v[80:95], v[44:47], v[236:239], v[80:95]
    v_exp_f32 v78, v78
    v_exp_f32_e64 v79, v79
    v_fma_f32 v76, v76, v19, v19
    v_fma_f32 v77, v77, v19, v19
    s_waitcnt lgkmcnt(2)
    s_add_u32 m0, s11, 40960
    s_nop 0
    buffer_load_dwordx4 v2, s[56:59], s9 offen lds
    ds_read_b64_tr_b16 v[40:41], v10 offset:39936
    ds_read_b64_tr_b16 v[42:43], v10 offset:40192
    v_mfma_f32_32x32x16_bf16 v[80:95], v[48:51], v[240:243], v[80:95]
    v_fma_f32 v78, v78, v19, v19
    v_fma_f32 v79, v79, v19, v19
    v_rcp_f32 v76, v76
    v_rcp_f32 v77, v77
    v_rcp_f32 v78, v78
    s_add_u32 m0, s11, 40960
    s_nop 0
    buffer_load_dwordx4 v3, s[56:59], s9 offen offset:1024 lds
    s_add_u32 s9, s9, 14336
    s_cmp_eq_u32 s9, s13
    s_cselect_b32 s9, s12, s9
    v_mfma_f32_32x32x16_bf16 v[80:95], v[52:55], v[244:247], v[80:95]
    s_waitcnt lgkmcnt(0)
    s_mov_b64 exec, 1
    ds_add_u32 v5, v9 offset:80
    s_mov_b64 exec, -1
    v_rcp_f32 v79, v79
    v_mul_f32 v140, v140, v76
    v_mul_f32 v141, v141, v77
    v_mul_f32 v142, v142, v78
    v_mul_f32 v143, v143, v79
    v_mfma_f32_32x32x16_bf16 v[80:95], v[56:59], v[248:251], v[80:95]
    v_mfma_f32_32x32x16_bf16 v[80:95], v[40:43], v[252:255], v[80:95]
    s_lshl_b32 s99, s8, 7
    s_lshl_b32 s34, s7, 2
    s_add_u32 s99, s99, s34
    s_add_u32 s99, s99, 18956288
    s_nop 7
    v_mul_f32 v128, v128, v80
    v_mul_f32 v129, v129, v81
    v_mul_f32 v130, v130, v82
    v_mul_f32 v131, v131, v83
    v_mul_f32 v132, v132, v84
    v_mul_f32 v133, v133, v85
    v_mul_f32 v134, v134, v86
    v_mul_f32 v135, v135, v87
    v_cvt_pk_bf16_f32 v128, v128, v129
    v_cvt_pk_bf16_f32 v129, v130, v131
    v_cvt_pk_bf16_f32 v130, v132, v133
    v_cvt_pk_bf16_f32 v131, v134, v135
    buffer_store_dwordx4 v[128:131], v1, s[48:51], s18 offen offset:0 sc1
    v_mul_f32 v136, v136, v88
    v_mul_f32 v137, v137, v89
    v_mul_f32 v138, v138, v90
    v_mul_f32 v139, v139, v91
    v_mul_f32 v140, v140, v92
    v_mul_f32 v141, v141, v93
    v_mul_f32 v142, v142, v94
    v_mul_f32 v143, v143, v95
    v_cvt_pk_bf16_f32 v136, v136, v137
    v_cvt_pk_bf16_f32 v137, v138, v139
    v_cvt_pk_bf16_f32 v138, v140, v141
    v_cvt_pk_bf16_f32 v139, v142, v143
    buffer_store_dwordx4 v[136:139], v1, s[48:51], s18 offen offset:1024 sc1
    s_branch L_gemm
L_gemm:
    s_nop 0
    v_mov_b32 v20, 156672
    v_mov_b32 v21, 1
    s_setprio 2
    v_lshrrev_b32_e64 v10, 5, v0
    v_bfe_u32 v11, v0, 2, 2
    v_lshl_add_u32 v6, v10, 3, v11
    v_lshlrev_b32 v6, 7, v6
    v_lshrrev_b32 v11, 1, v11
    v_lshl_add_u32 v6, v11, 6, v6
    v_bfe_u32 v11, v0, 4, 1
    v_lshl_add_u32 v6, v11, 5, v6
    v_and_b32_e64 v11, 1, v0
    v_lshl_add_u32 v6, v11, 4, v6
    v_bfe_u32 v11, v0, 1, 1
    v_lshl_add_u32 v6, v11, 3, v6
    s_lshr_b32 s34, s14, 1
    s_lshl_b32 s34, s34, 6
    v_xor_b32 v6, s34, v6
    s_lshl_b32 s34, s14, 11
    s_add_u32 s34, s34, 0
    v_add_u32 v6, s34, v6
    v_xor_b32_e64 v7, 64, v6
    v_add_u32 v8, 0x10000, v6
    v_add_u32 v9, 0x10000, v7
    v_add_u32 v10, 0x20000, v6
    v_add_u32 v11, 0x20000, v7
    v_mov_b32 v22, s97
    s_min_u32 s34, s4, 27
    s_lshl_b32 s26, s3, 2
    s_and_b32 s35, s34, 3
    s_add_u32 s26, s26, s35
    s_lshr_b32 s27, s34, 2
    s_lshl_b32 s27, s27, 7
    s_and_b32 s34, s14, 1
    s_mul_i32 s34, s34, 114688
    s_sub_u32 s35, 114688, s34
    v_add_u32 v4, s34, v1
    v_add_u32 v5, s35, v1
    s_mul_i32 s28, s26, 229376
    s_mul_i32 s34, s14, 28672
    s_add_u32 s28, s28, s34
    s_add_u32 s28, s28, 8388608
    s_add_u32 s29, s28, 28672
    s_lshl_b32 s30, s10, 10
    s_add_u32 s30, s30, s28
    s_lshl_b32 s31, s26, 8
    s_add_u32 s31, s31, 18956288
    v_bfe_u32 v16, v0, 2, 3
    v_min_u32 v16, 6, v16
    s_lshr_b32 s34, s10, 2
    v_add_u32 v16, s34, v16
    v_subrev_u32 v17, 7, v16
    v_min_u32 v16, v16, v17
    s_mul_i32 s34, s14, 7
    v_add_u32_e64 v17, s34, v16
    v_bfe_u32 v18, v0, 1, 1
    v_lshl_add_u32 v18, v16, 1, v18
    v_add_u32 v18, 18, v18
    v_cmp_lt_u32 vcc, 23, v17
    v_and_b32 v19, 1, v0
    s_nop 0
    v_cndmask_b32_e64 v16, v17, v18, vcc
    v_lshl_add_u32 v16, v19, 5, v16
    v_lshlrev_b32_e64 v14, 2, v16
    s_mul_i32 s24, s14, 100352
    s_add_u32 s24, s24, s27
    v_lshrrev_b32 v17, 5, v0
    v_bfe_u32 v12, v0, 3, 2
    v_lshl_add_u32 v12, v17, 3, v12
    v_mul_u32_u24 v12, 896, v12
    v_and_b32 v13, 127, v2
    v_add_u32_e64 v12, v12, v13
    v_add_u32 v13, 2560, v12
    s_mul_i32 s34, s14, 12288
    s_add_u32 s34, s34, 86016
    v_add_u32 v15, s34, v1
    s_lshl_b32 s34, s14, 11
    s_add_u32 s34, s34, 135168
    v_add_u32 v19, s34, v1
    s_xor_b32 s34, s14, 1
    s_mul_i32 s34, s34, 12288
    s_add_u32 s34, s34, 86016
    v_add_u32 v16, s34, v1
    s_xor_b32 s34, s14, 2
    s_mul_i32 s34, s34, 12288
    s_add_u32 s34, s34, 90112
    v_add_u32 v17, s34, v1
    s_xor_b32 s34, s14, 3
    s_mul_i32 s34, s34, 12288
    s_add_u32 s34, s34, 94208
    v_add_u32 v18, s34, v1
    s_waitcnt vmcnt(0)
    buffer_store_dword v22, off, s[48:51], s99 sc1
    s_cmp_ge_u32 s4, 28
    s_cbranch_scc1 L_exit
    s_lshl_b32 s34, s14, 4
    v_add_u32 v22, s34, v20
    ds_read_b64_tr_b16 v[184:185], v6 offset:49152
    ds_read_b64_tr_b16 v[186:187], v6 offset:49664
    ds_read_b64_tr_b16 v[188:189], v7 offset:49152
    ds_read_b64_tr_b16 v[190:191], v7 offset:49664
    ds_read_b64_tr_b16 v[192:193], v8 offset:8192
    ds_read_b64_tr_b16 v[194:195], v8 offset:8704
    ds_read_b64_tr_b16 v[196:197], v9 offset:8192
    ds_read_b64_tr_b16 v[198:199], v9 offset:8704
    ds_read_b64_tr_b16 v[200:201], v10 offset:12288
    ds_read_b64_tr_b16 v[202:203], v10 offset:12800
    ds_read_b64_tr_b16 v[204:205], v11 offset:12288
    ds_read_b64_tr_b16 v[206:207], v11 offset:12800
    ds_read_b64_tr_b16 v[208:209], v6 offset:40960
    ds_read_b64_tr_b16 v[210:211], v6 offset:41472
    ds_read_b64_tr_b16 v[212:213], v7 offset:40960
    ds_read_b64_tr_b16 v[214:215], v7 offset:41472
    s_mov_b32 s76, 200000
L_ll30:
    ds_read_b32 v23, v20 offset:112
    s_waitcnt lgkmcnt(0)
    v_readfirstlane_b32 s77, v23
    s_nop 0
    s_cmp_eq_u32 s77, 4
    s_cbranch_scc1 L_lk30
    s_sleep 1
    s_sub_u32 s76, s76, 1
    s_cbranch_scc0 L_ll30
L_lk30:
    s_add_u32 m0, s11, 49152
    s_nop 0
    buffer_load_dwordx4 v2, s[56:59], s9 offen lds
    s_add_u32 m0, s11, 49152
    s_nop 0
    buffer_load_dwordx4 v3, s[56:59], s9 offen offset:1024 lds
    s_add_u32 s9, s9, 14336
    s_cmp_eq_u32 s9, s13
    s_cselect_b32 s9, s12, s9
    s_add_u32 m0, s11, 73728
    s_nop 0
    buffer_load_dwordx4 v2, s[56:59], s9 offen lds
    s_add_u32 m0, s11, 73728
    s_nop 0
    buffer_load_dwordx4 v3, s[56:59], s9 offen offset:1024 lds
    s_add_u32 s9, s9, 14336
    s_cmp_eq_u32 s9, s13
    s_cselect_b32 s9, s12, s9
    s_add_u32 m0, s11, 143360
    s_nop 0
    buffer_load_dwordx4 v2, s[56:59], s9 offen lds
    s_add_u32 m0, s11, 143360
    s_nop 0
    buffer_load_dwordx4 v3, s[56:59], s9 offen offset:1024 lds
    s_add_u32 s9, s9, 14336
    s_cmp_eq_u32 s9, s13
    s_cselect_b32 s9, s12, s9
    s_add_u32 m0, s11, 40960
    s_nop 0
    buffer_load_dwordx4 v2, s[56:59], s9 offen lds
    s_add_u32 m0, s11, 40960
    s_nop 0
    buffer_load_dwordx4 v3, s[56:59], s9 offen offset:1024 lds
    s_add_u32 s9, s9, 14336
    s_cmp_eq_u32 s9, s13
    s_cselect_b32 s9, s12, s9
    s_waitcnt vmcnt(6)
    ds_read_b64_tr_b16 v[216:217], v6 offset:49152
    ds_read_b64_tr_b16 v[218:219], v6 offset:49664
    ds_read_b64_tr_b16 v[220:221], v7 offset:49152
    ds_read_b64_tr_b16 v[222:223], v7 offset:49664
    s_waitcnt vmcnt(4)
    ds_read_b64_tr_b16 v[224:225], v8 offset:8192
    ds_read_b64_tr_b16 v[226:227], v8 offset:8704
    ds_read_b64_tr_b16 v[228:229], v9 offset:8192
    ds_read_b64_tr_b16 v[230:231], v9 offset:8704
    s_waitcnt vmcnt(2)
    ds_read_b64_tr_b16 v[232:233], v10 offset:12288
    ds_read_b64_tr_b16 v[234:235], v10 offset:12800
    ds_read_b64_tr_b16 v[236:237], v11 offset:12288
    ds_read_b64_tr_b16 v[238:239], v11 offset:12800
    s_waitcnt vmcnt(0)
    ds_read_b64_tr_b16 v[240:241], v6 offset:40960
    ds_read_b64_tr_b16 v[242:243], v6 offset:41472
    ds_read_b64_tr_b16 v[244:245], v7 offset:40960
    ds_read_b64_tr_b16 v[246:247], v7 offset:41472
    s_waitcnt lgkmcnt(12)
    s_add_u32 m0, s11, 49152
    s_nop 0
    buffer_load_dwordx4 v2, s[56:59], s9 offen lds
    s_add_u32 m0, s11, 49152
    s_nop 0
    buffer_load_dwordx4 v3, s[56:59], s9 offen offset:1024 lds
    s_add_u32 s9, s9, 14336
    s_cmp_eq_u32 s9, s13
    s_cselect_b32 s9, s12, s9
    s_waitcnt lgkmcnt(8)
    s_add_u32 m0, s11, 73728
    s_nop 0
    buffer_load_dwordx4 v2, s[56:59], s9 offen lds
    s_add_u32 m0, s11, 73728
    s_nop 0
    buffer_load_dwordx4 v3, s[56:59], s9 offen offset:1024 lds
    s_add_u32 s9, s9, 14336
    s_cmp_eq_u32 s9, s13
    s_cselect_b32 s9, s12, s9
    s_waitcnt lgkmcnt(4)
    s_add_u32 m0, s11, 143360
    s_nop 0
    buffer_load_dwordx4 v2, s[56:59], s9 offen lds
    s_add_u32 m0, s11, 143360
    s_nop 0
    buffer_load_dwordx4 v3, s[56:59], s9 offen offset:1024 lds
    s_add_u32 s9, s9, 14336
    s_cmp_eq_u32 s9, s13
    s_cselect_b32 s9, s12, s9
    s_waitcnt lgkmcnt(0)
    s_add_u32 m0, s11, 40960
    s_nop 0
    buffer_load_dwordx4 v2, s[56:59], s9 offen lds
    s_add_u32 m0, s11, 40960
    s_nop 0
    buffer_load_dwordx4 v3, s[56:59], s9 offen offset:1024 lds
    s_add_u32 s9, s9, 14336
    s_cmp_eq_u32 s9, s13
    s_cselect_b32 s9, s12, s9
    buffer_load_dword v23, v14, s[48:51], s31 offen sc1
    s_mov_b32 s76, 200000
L_ll31:
    ds_read_b32 v255, v20 offset:80
    s_waitcnt lgkmcnt(0)
    v_readfirstlane_b32 s77, v255
    s_nop 0
    s_cmp_eq_u32 s77, 8
    s_cbranch_scc1 L_lk31
    s_sleep 1
    s_sub_u32 s76, s76, 1
    s_cbranch_scc0 L_ll31
L_lk31:
    s_add_u32 m0, s11, 0
    s_nop 0
    buffer_load_dwordx4 v2, s[56:59], s9 offen lds
    s_add_u32 m0, s11, 0
    s_nop 0
    buffer_load_dwordx4 v3, s[56:59], s9 offen offset:1024 lds
    s_add_u32 s9, s9, 14336
    s_cmp_eq_u32 s9, s13
    s_cselect_b32 s9, s12, s9
    s_add_u32 m0, s11, 8192
    s_nop 0
    buffer_load_dwordx4 v2, s[56:59], s9 offen lds
    s_add_u32 m0, s11, 8192
    s_nop 0
    buffer_load_dwordx4 v3, s[56:59], s9 offen offset:1024 lds
    s_add_u32 s9, s9, 14336
    s_cmp_eq_u32 s9, s13
    s_cselect_b32 s9, s12, s9
    s_add_u32 m0, s11, 16384
    s_nop 0
    buffer_load_dwordx4 v2, s[56:59], s9 offen lds
    s_add_u32 m0, s11, 16384
    s_nop 0
    buffer_load_dwordx4 v3, s[56:59], s9 offen offset:1024 lds
    s_add_u32 s9, s9, 14336
    s_cmp_eq_u32 s9, s13
    s_cselect_b32 s9, s12, s9
    s_add_u32 m0, s11, 24576
    s_nop 0
    buffer_load_dwordx4 v2, s[56:59], s9 offen lds
    s_add_u32 m0, s11, 24576
    s_nop 0
    buffer_load_dwordx4 v3, s[56:59], s9 offen offset:1024 lds
    s_add_u32 s9, s9, 14336
    s_cmp_eq_u32 s9, s13
    s_cselect_b32 s9, s12, s9
    s_add_u32 m0, s11, 32768
    s_nop 0
    buffer_load_dwordx4 v2, s[56:59], s9 offen lds
    s_add_u32 m0, s11, 32768
    s_nop 0
    buffer_load_dwordx4 v3, s[56:59], s9 offen offset:1024 lds
    s_add_u32 s9, s9, 14336
    s_cmp_eq_u32 s9, s13
    s_cselect_b32 s9, s12, s9
    s_add_u32 m0, s11, 57344
    s_nop 0
    buffer_load_dwordx4 v2, s[56:59], s9 offen lds
    s_add_u32 m0, s11, 57344
    s_nop 0
    buffer_load_dwordx4 v3, s[56:59], s9 offen offset:1024 lds
    s_add_u32 s9, s9, 14336
    s_cmp_eq_u32 s9, s13
    s_cselect_b32 s9, s12, s9
    s_add_u32 m0, s11, 65536
    s_nop 0
    buffer_load_dwordx4 v2, s[56:59], s9 offen lds
    s_add_u32 m0, s11, 65536
    s_nop 0
    buffer_load_dwordx4 v3, s[56:59], s9 offen offset:1024 lds
    s_add_u32 s9, s9, 14336
    s_cmp_eq_u32 s9, s13
    s_cselect_b32 s9, s12, s9
    s_waitcnt vmcnt(14)
    v_cmp_ne_u32 vcc, s97, v23
    s_nop 1
    s_mov_b32 s22, vcc_lo
    s_and_b32 s34, s22, 15
    s_cbranch_scc0 L_ok32
    s_mov_b32 s76, 200000
L_lp32:
    s_nop 0
    s_sleep 4
    buffer_load_dword v23, v14, s[48:51], s31 offen sc1
    s_waitcnt vmcnt(0)
    v_cmp_ne_u32 vcc, s97, v23
    s_nop 1
    s_mov_b32 s22, vcc_lo
    s_and_b32 s34, s22, 15
    s_cbranch_scc0 L_ok32
    s_sub_u32 s76, s76, 1
    s_cbranch_scc0 L_lp32
L_ok32:
    buffer_load_dwordx4 v[88:91], v4, s[48:51], s30 offen sc1
    buffer_load_dwordx4 v[92:95], v5, s[48:51], s30 offen sc1
    s_add_u32 s30, s30, 1024
    s_cmp_eq_u32 s30, s29
    s_cselect_b32 s30, s28, s30
    buffer_load_dwordx4 v[96:99], v4, s[48:51], s30 offen sc1
    buffer_load_dwordx4 v[100:103], v5, s[48:51], s30 offen sc1
    s_add_u32 s30, s30, 1024
    s_cmp_eq_u32 s30, s29
    s_cselect_b32 s30, s28, s30
    buffer_load_dwordx4 v[104:107], v4, s[48:51], s30 offen sc1
    buffer_load_dwordx4 v[108:111], v5, s[48:51], s30 offen sc1
    s_add_u32 s30, s30, 1024
    s_cmp_eq_u32 s30, s29
    s_cselect_b32 s30, s28, s30
    buffer_load_dwordx4 v[112:115], v4, s[48:51], s30 offen sc1
    buffer_load_dwordx4 v[116:119], v5, s[48:51], s30 offen sc1
    s_add_u32 s30, s30, 1024
    s_cmp_eq_u32 s30, s29
    s_cselect_b32 s30, s28, s30
    s_and_b32 s34, s22, 240
    s_cbranch_scc0 L_ok33
    s_mov_b32 s76, 200000
L_lp33:
    s_sleep 4
    buffer_load_dword v23, v14, s[48:51], s31 offen sc1
    s_waitcnt vmcnt(0)
    v_cmp_ne_u32 vcc, s97, v23
    s_nop 1
    s_mov_b32 s22, vcc_lo
    s_and_b32 s34, s22, 240
    s_cbranch_scc0 L_ok33
    s_sub_u32 s76, s76, 1
    s_nop 0
    s_cbranch_scc0 L_lp33
L_ok33:
    buffer_load_dwordx4 v[120:123], v4, s[48:51], s30 offen sc1
    buffer_load_dwordx4 v[124:127], v5, s[48:51], s30 offen sc1
    s_add_u32 s30, s30, 1024
    s_cmp_eq_u32 s30, s29
    s_cselect_b32 s30, s28, s30
    buffer_load_dwordx4 v[128:131], v4, s[48:51], s30 offen sc1
    buffer_load_dwordx4 v[132:135], v5, s[48:51], s30 offen sc1
    s_add_u32 s30, s30, 1024
    s_cmp_eq_u32 s30, s29
    s_cselect_b32 s30, s28, s30
    buffer_load_dwordx4 v[136:139], v4, s[48:51], s30 offen sc1
    buffer_load_dwordx4 v[140:143], v5, s[48:51], s30 offen sc1
    s_add_u32 s30, s30, 1024
    s_cmp_eq_u32 s30, s29
    s_cselect_b32 s30, s28, s30
    buffer_load_dwordx4 v[144:147], v4, s[48:51], s30 offen sc1
    buffer_load_dwordx4 v[148:151], v5, s[48:51], s30 offen sc1
    s_add_u32 s30, s30, 1024
    s_cmp_eq_u32 s30, s29
    s_cselect_b32 s30, s28, s30
    s_waitcnt vmcnt(14)
    s_and_b32 s34, s22, 3840
    s_cbranch_scc0 L_ok34
    s_mov_b32 s76, 200000
L_lp34:
    s_sleep 4
    buffer_load_dword v23, v14, s[48:51], s31 offen sc1
    s_waitcnt vmcnt(0)
    v_cmp_ne_u32 vcc, s97, v23
    s_nop 1
    s_mov_b32 s22, vcc_lo
    s_and_b32 s34, s22, 3840
    s_cbranch_scc0 L_ok34
    s_sub_u32 s76, s76, 1
    s_cbranch_scc0 L_lp34
L_ok34:
    v_mfma_f32_32x32x16_bf16 v[40:55], v[152:155], v[92:95], 0
    v_mfma_f32_32x32x16_bf16 v[72:87], v[156:159], v[92:95], 0
    buffer_load_dwordx4 v[92:95], v5, s[48:51], s30 offen sc1
    v_mfma_f32_32x32x16_bf16 v[56:71], v[156:159], v[88:91], 0
    v_mfma_f32_32x32x16_bf16 v[24:39], v[152:155], v[88:91], 0
    buffer_load_dwordx4 v[88:91], v4, s[48:51], s30 offen sc1
    s_add_u32 s30, s30, 1024
    s_cmp_eq_u32 s30, s29
    s_cselect_b32 s30, s28, s30
    ds_read_b64_tr_b16 v[152:153], v6 offset:49152
    ds_read_b64_tr_b16 v[154:155], v6 offset:49664
    ds_read_b64_tr_b16 v[156:157], v7 offset:49152
    ds_read_b64_tr_b16 v[158:159], v7 offset:49664
    s_waitcnt vmcnt(14)
    v_mfma_f32_32x32x16_bf16 v[40:55], v[160:163], v[100:103], v[40:55]
    s_waitcnt lgkmcnt(0)
    s_add_u32 m0, s11, 49152
    s_add_u32 s34, s24, 75264
    buffer_load_dwordx4 v12, s[60:63], s34 offen offset:0 lds
    v_mfma_f32_32x32x16_bf16 v[72:87], v[164:167], v[100:103], v[72:87]
    buffer_load_dwordx4 v[100:103], v5, s[48:51], s30 offen sc1
    v_mfma_f32_32x32x16_bf16 v[56:71], v[164:167], v[96:99], v[56:71]
    s_add_u32 m0, s11, 49152
    s_add_u32 s34, s24, 75264
    buffer_load_dwordx4 v13, s[60:63], s34 offen offset:1024 lds
    v_mfma_f32_32x32x16_bf16 v[24:39], v[160:163], v[96:99], v[24:39]
    buffer_load_dwordx4 v[96:99], v4, s[48:51], s30 offen sc1
    s_add_u32 s30, s30, 1024
    s_cmp_eq_u32 s30, s29
    s_cselect_b32 s30, s28, s30
    ds_read_b64_tr_b16 v[160:161], v8 offset:8192
    ds_read_b64_tr_b16 v[162:163], v8 offset:8704
    ds_read_b64_tr_b16 v[164:165], v9 offset:8192
    ds_read_b64_tr_b16 v[166:167], v9 offset:8704
    s_waitcnt vmcnt(16)
    v_mfma_f32_32x32x16_bf16 v[40:55], v[168:171], v[108:111], v[40:55]
    s_waitcnt lgkmcnt(0)
    s_add_u32 m0, s11, 73728
    s_nop 0
    buffer_load_dwordx4 v2, s[56:59], s9 offen lds
    v_mfma_f32_32x32x16_bf16 v[72:87], v[172:175], v[108:111], v[72:87]
    buffer_load_dwordx4 v[108:111], v5, s[48:51], s30 offen sc1
    v_mfma_f32_32x32x16_bf16 v[56:71], v[172:175], v[104:107], v[56:71]
    s_add_u32 m0, s11, 73728
    s_nop 0
    buffer_load_dwordx4 v3, s[56:59], s9 offen offset:1024 lds
    s_add_u32 s9, s9, 14336
    s_cmp_eq_u32 s9, s13
    s_cselect_b32 s9, s12, s9
    v_mfma_f32_32x32x16_bf16 v[24:39], v[168:171], v[104:107], v[24:39]
    buffer_load_dwordx4 v[104:107], v4, s[48:51], s30 offen sc1
    s_add_u32 s30, s30, 1024
    s_cmp_eq_u32 s30, s29
    s_cselect_b32 s30, s28, s30
    ds_read_b64_tr_b16 v[168:169], v10 offset:12288
    ds_read_b64_tr_b16 v[170:171], v10 offset:12800
    ds_read_b64_tr_b16 v[172:173], v11 offset:12288
    ds_read_b64_tr_b16 v[174:175], v11 offset:12800
    s_waitcnt vmcnt(18)
    v_mfma_f32_32x32x16_bf16 v[40:55], v[176:179], v[116:119], v[40:55]
    s_waitcnt lgkmcnt(0)
    s_add_u32 m0, s11, 143360
    s_nop 0
    buffer_load_dwordx4 v2, s[56:59], s9 offen lds
    v_mfma_f32_32x32x16_bf16 v[72:87], v[180:183], v[116:119], v[72:87]
    buffer_load_dwordx4 v[116:119], v5, s[48:51], s30 offen sc1
    v_mfma_f32_32x32x16_bf16 v[56:71], v[180:183], v[112:115], v[56:71]
    s_add_u32 m0, s11, 143360
    s_nop 0
    buffer_load_dwordx4 v3, s[56:59], s9 offen offset:1024 lds
    s_add_u32 s9, s9, 14336
    s_cmp_eq_u32 s9, s13
    s_cselect_b32 s9, s12, s9
    v_mfma_f32_32x32x16_bf16 v[24:39], v[176:179], v[112:115], v[24:39]
    buffer_load_dwordx4 v[112:115], v4, s[48:51], s30 offen sc1
    s_add_u32 s30, s30, 1024
    s_cmp_eq_u32 s30, s29
    s_cselect_b32 s30, s28, s30
    ds_read_b64_tr_b16 v[176:177], v6 offset:40960
    ds_read_b64_tr_b16 v[178:179], v6 offset:41472
    ds_read_b64_tr_b16 v[180:181], v7 offset:40960
    ds_read_b64_tr_b16 v[182:183], v7 offset:41472
    s_waitcnt vmcnt(20)
    s_and_b32 s34, s22, 61440
    s_cbranch_scc0 L_ok35
    s_mov_b32 s76, 200000
L_lp35:
    s_nop 0
    s_sleep 4
    buffer_load_dword v23, v14, s[48:51], s31 offen sc1
    s_waitcnt vmcnt(0)
    v_cmp_ne_u32 vcc, s97, v23
    s_nop 1
    s_mov_b32 s22, vcc_lo
    s_and_b32 s34, s22, 61440
    s_cbranch_scc0 L_ok35
    s_sub_u32 s76, s76, 1
    s_cbranch_scc0 L_lp35
L_ok35:
    v_mfma_f32_32x32x16_bf16 v[40:55], v[184:187], v[124:127], v[40:55]
    s_waitcnt lgkmcnt(0)
    s_add_u32 m0, s11, 40960
    s_add_u32 s34, s24, 64512
    buffer_load_dwordx4 v12, s[60:63], s34 offen offset:0 lds
    v_mfma_f32_32x32x16_bf16 v[72:87], v[188:191], v[124:127], v[72:87]
    buffer_load_dwordx4 v[124:127], v5, s[48:51], s30 offen sc1
    v_mfma_f32_32x32x16_bf16 v[56:71], v[188:191], v[120:123], v[56:71]
    s_add_u32 m0, s11, 40960
    s_add_u32 s34, s24, 64512
    buffer_load_dwordx4 v13, s[60:63], s34 offen offset:1024 lds
    v_mfma_f32_32x32x16_bf16 v[24:39], v[184:187], v[120:123], v[24:39]
    buffer_load_dwordx4 v[120:123], v4, s[48:51], s30 offen sc1
    s_add_u32 s30, s30, 1024
    s_cmp_eq_u32 s30, s29
    s_cselect_b32 s30, s28, s30
    ds_read_b64_tr_b16 v[184:185], v6 offset:0
    ds_read_b64_tr_b16 v[186:187], v6 offset:512
    ds_read_b64_tr_b16 v[188:189], v7 offset:0
    ds_read_b64_tr_b16 v[190:191], v7 offset:512
    s_waitcnt vmcnt(22)
    v_mfma_f32_32x32x16_bf16 v[40:55], v[192:195], v[132:135], v[40:55]
    s_waitcnt lgkmcnt(0)
    s_add_u32 m0, s11, 0
    s_add_u32 s34, s24, 0
    buffer_load_dwordx4 v12, s[60:63], s34 offen offset:0 lds
    v_mfma_f32_32x32x16_bf16 v[72:87], v[196:199], v[132:135], v[72:87]
    buffer_load_dwordx4 v[132:135], v5, s[48:51], s30 offen sc1
    v_mfma_f32_32x32x16_bf16 v[56:71], v[196:199], v[128:131], v[56:71]
    s_add_u32 m0, s11, 0
    s_add_u32 s34, s24, 0
    buffer_load_dwordx4 v13, s[60:63], s34 offen offset:1024 lds
    v_mfma_f32_32x32x16_bf16 v[24:39], v[192:195], v[128:131], v[24:39]
    buffer_load_dwordx4 v[128:131], v4, s[48:51], s30 offen sc1
    s_add_u32 s30, s30, 1024
    s_cmp_eq_u32 s30, s29
    s_cselect_b32 s30, s28, s30
    ds_read_b64_tr_b16 v[192:193], v6 offset:8192
    ds_read_b64_tr_b16 v[194:195], v6 offset:8704
    ds_read_b64_tr_b16 v[196:197], v7 offset:8192
    ds_read_b64_tr_b16 v[198:199], v7 offset:8704
    s_waitcnt vmcnt(24)
    v_mfma_f32_32x32x16_bf16 v[40:55], v[200:203], v[140:143], v[40:55]
    s_waitcnt lgkmcnt(0)
    s_add_u32 m0, s11, 8192
    s_add_u32 s34, s24, 14336
    buffer_load_dwordx4 v12, s[60:63], s34 offen offset:0 lds
    v_mfma_f32_32x32x16_bf16 v[72:87], v[204:207], v[140:143], v[72:87]
    buffer_load_dwordx4 v[140:143], v5, s[48:51], s30 offen sc1
    v_mfma_f32_32x32x16_bf16 v[56:71], v[204:207], v[136:139], v[56:71]
    s_add_u32 m0, s11, 8192
    s_add_u32 s34, s24, 14336
    buffer_load_dwordx4 v13, s[60:63], s34 offen offset:1024 lds
    v_mfma_f32_32x32x16_bf16 v[24:39], v[200:203], v[136:139], v[24:39]
    buffer_load_dwordx4 v[136:139], v4, s[48:51], s30 offen sc1
    s_add_u32 s30, s30, 1024
    s_cmp_eq_u32 s30, s29
    s_cselect_b32 s30, s28, s30
    ds_read_b64_tr_b16 v[200:201], v6 offset:16384
    ds_read_b64_tr_b16 v[202:203], v6 offset:16896
    ds_read_b64_tr_b16 v[204:205], v7 offset:16384
    ds_read_b64_tr_b16 v[206:207], v7 offset:16896
    s_waitcnt vmcnt(26)
    v_mfma_f32_32x32x16_bf16 v[40:55], v[208:211], v[148:151], v[40:55]
    s_waitcnt lgkmcnt(0)
    s_add_u32 m0, s11, 16384
    s_add_u32 s34, s24, 25088
    buffer_load_dwordx4 v12, s[60:63], s34 offen offset:0 lds
    v_mfma_f32_32x32x16_bf16 v[72:87], v[212:215], v[148:151], v[72:87]
    buffer_load_dwordx4 v[148:151], v5, s[48:51], s30 offen sc1
    v_mfma_f32_32x32x16_bf16 v[56:71], v[212:215], v[144:147], v[56:71]
    s_add_u32 m0, s11, 16384
    s_add_u32 s34, s24, 25088
    buffer_load_dwordx4 v13, s[60:63], s34 offen offset:1024 lds
    v_mfma_f32_32x32x16_bf16 v[24:39], v[208:211], v[144:147], v[24:39]
    buffer_load_dwordx4 v[144:147], v4, s[48:51], s30 offen sc1
    s_add_u32 s30, s30, 1024
    s_cmp_eq_u32 s30, s29
    s_cselect_b32 s30, s28, s30
    ds_read_b64_tr_b16 v[208:209], v6 offset:24576
    ds_read_b64_tr_b16 v[210:211], v6 offset:25088
    ds_read_b64_tr_b16 v[212:213], v7 offset:24576
    ds_read_b64_tr_b16 v[214:215], v7 offset:25088
    s_waitcnt vmcnt(28)
    s_and_b32 s34, s22, 983040
    s_cbranch_scc0 L_ok36
    s_mov_b32 s76, 200000
L_lp36:
    s_nop 0
    s_sleep 4
    buffer_load_dword v23, v14, s[48:51], s31 offen sc1
    s_waitcnt vmcnt(0)
    v_cmp_ne_u32 vcc, s97, v23
    s_nop 1
    s_mov_b32 s22, vcc_lo
    s_and_b32 s34, s22, 983040
    s_cbranch_scc0 L_ok36
    s_sub_u32 s76, s76, 1
    s_cbranch_scc0 L_lp36
L_ok36:
    v_mfma_f32_32x32x16_bf16 v[40:55], v[216:219], v[92:95], v[40:55]
    s_waitcnt lgkmcnt(0)
    s_add_u32 m0, s11, 24576
    s_add_u32 s34, s24, 39424
    buffer_load_dwordx4 v12, s[60:63], s34 offen offset:0 lds
    v_mfma_f32_32x32x16_bf16 v[72:87], v[220:223], v[92:95], v[72:87]
    buffer_load_dwordx4 v[92:95], v5, s[48:51], s30 offen sc1
    v_mfma_f32_32x32x16_bf16 v[56:71], v[220:223], v[88:91], v[56:71]
    s_add_u32 m0, s11, 24576
    s_add_u32 s34, s24, 39424
    buffer_load_dwordx4 v13, s[60:63], s34 offen offset:1024 lds
    v_mfma_f32_32x32x16_bf16 v[24:39], v[216:219], v[88:91], v[24:39]
    buffer_load_dwordx4 v[88:91], v4, s[48:51], s30 offen sc1
    s_add_u32 s30, s30, 1024
    s_cmp_eq_u32 s30, s29
    s_cselect_b32 s30, s28, s30
    ds_read_b64_tr_b16 v[216:217], v6 offset:32768
    ds_read_b64_tr_b16 v[218:219], v6 offset:33280
    ds_read_b64_tr_b16 v[220:221], v7 offset:32768
    ds_read_b64_tr_b16 v[222:223], v7 offset:33280
    s_waitcnt vmcnt(28)
    v_mfma_f32_32x32x16_bf16 v[40:55], v[224:227], v[100:103], v[40:55]
    s_waitcnt lgkmcnt(0)
    s_add_u32 m0, s11, 32768
    s_add_u32 s34, s24, 50176
    buffer_load_dwordx4 v12, s[60:63], s34 offen offset:0 lds
    v_mfma_f32_32x32x16_bf16 v[72:87], v[228:231], v[100:103], v[72:87]
    buffer_load_dwordx4 v[100:103], v5, s[48:51], s30 offen sc1
    v_mfma_f32_32x32x16_bf16 v[56:71], v[228:231], v[96:99], v[56:71]
    s_add_u32 m0, s11, 32768
    s_add_u32 s34, s24, 50176
    buffer_load_dwordx4 v13, s[60:63], s34 offen offset:1024 lds
    v_mfma_f32_32x32x16_bf16 v[24:39], v[224:227], v[96:99], v[24:39]
    buffer_load_dwordx4 v[96:99], v4, s[48:51], s30 offen sc1
    s_add_u32 s30, s30, 1024
    s_cmp_eq_u32 s30, s29
    s_cselect_b32 s30, s28, s30
    ds_read_b64_tr_b16 v[224:225], v6 offset:57344
    ds_read_b64_tr_b16 v[226:227], v6 offset:57856
    ds_read_b64_tr_b16 v[228:229], v7 offset:57344
    ds_read_b64_tr_b16 v[230:231], v7 offset:57856
    s_waitcnt vmcnt(28)
    v_mfma_f32_32x32x16_bf16 v[40:55], v[232:235], v[108:111], v[40:55]
    s_waitcnt lgkmcnt(0)
    s_add_u32 m0, s11, 57344
    s_add_u32 s34, s24, 89600
    buffer_load_dwordx4 v12, s[60:63], s34 offen offset:0 lds
    v_mfma_f32_32x32x16_bf16 v[72:87], v[236:239], v[108:111], v[72:87]
    buffer_load_dwordx4 v[108:111], v5, s[48:51], s30 offen sc1
    v_mfma_f32_32x32x16_bf16 v[56:71], v[236:239], v[104:107], v[56:71]
    s_add_u32 m0, s11, 57344
    s_add_u32 s34, s24, 89600
    buffer_load_dwordx4 v13, s[60:63], s34 offen offset:1024 lds
    v_mfma_f32_32x32x16_bf16 v[24:39], v[232:235], v[104:107], v[24:39]
    buffer_load_dwordx4 v[104:107], v4, s[48:51], s30 offen sc1
    s_add_u32 s30, s30, 1024
    s_cmp_eq_u32 s30, s29
    s_cselect_b32 s30, s28, s30
    ds_read_b64_tr_b16 v[232:233], v8 offset:0
    ds_read_b64_tr_b16 v[234:235], v8 offset:512
    ds_read_b64_tr_b16 v[236:237], v9 offset:0
    ds_read_b64_tr_b16 v[238:239], v9 offset:512
    s_waitcnt vmcnt(28)
    v_mfma_f32_32x32x16_bf16 v[40:55], v[240:243], v[116:119], v[40:55]
    s_waitcnt lgkmcnt(0)
    s_add_u32 m0, s11, 65536
    s_nop 0
    buffer_load_dwordx4 v2, s[56:59], s9 offen lds
    v_mfma_f32_32x32x16_bf16 v[72:87], v[244:247], v[116:119], v[72:87]
    buffer_load_dwordx4 v[116:119], v5, s[48:51], s30 offen sc1
    v_mfma_f32_32x32x16_bf16 v[56:71], v[244:247], v[112:115], v[56:71]
    s_add_u32 m0, s11, 65536
    s_nop 0
    buffer_load_dwordx4 v3, s[56:59], s9 offen offset:1024 lds
    s_add_u32 s9, s9, 14336
    s_cmp_eq_u32 s9, s13
    s_cselect_b32 s9, s12, s9
    v_mfma_f32_32x32x16_bf16 v[24:39], v[240:243], v[112:115], v[24:39]
    buffer_load_dwordx4 v[112:115], v4, s[48:51], s30 offen sc1
    s_add_u32 s30, s30, 1024
    s_cmp_eq_u32 s30, s29
    s_cselect_b32 s30, s28, s30
    ds_read_b64_tr_b16 v[240:241], v8 offset:8192
    ds_read_b64_tr_b16 v[242:243], v8 offset:8704
    ds_read_b64_tr_b16 v[244:245], v9 offset:8192
    ds_read_b64_tr_b16 v[246:247], v9 offset:8704
    s_waitcnt vmcnt(28)
    s_and_b32 s34, s22, 15728640
    s_cbranch_scc0 L_ok37
    s_mov_b32 s76, 200000
L_lp37:
    s_sleep 4
    buffer_load_dword v23, v14, s[48:51], s31 offen sc1
    s_waitcnt vmcnt(0)
    v_cmp_ne_u32 vcc, s97, v23
    s_nop 1
    s_mov_b32 s22, vcc_lo
    s_and_b32 s34, s22, 15728640
    s_cbranch_scc0 L_ok37
    s_sub_u32 s76, s76, 1
    s_cbranch_scc0 L_lp37
L_ok37:
    v_mfma_f32_32x32x16_bf16 v[40:55], v[152:155], v[124:127], v[40:55]
    s_waitcnt lgkmcnt(0)
    s_add_u32 m0, s11, 73728
    s_nop 0
    buffer_load_dwordx4 v2, s[56:59], s9 offen lds
    v_mfma_f32_32x32x16_bf16 v[72:87], v[156:159], v[124:127], v[72:87]
    buffer_load_dwordx4 v[124:127], v5, s[48:51], s30 offen sc1
    v_mfma_f32_32x32x16_bf16 v[56:71], v[156:159], v[120:123], v[56:71]
    s_add_u32 m0, s11, 73728
    s_nop 0
    s_nop 0
    buffer_load_dwordx4 v3, s[56:59], s9 offen offset:1024 lds
    s_add_u32 s9, s9, 14336
    s_cmp_eq_u32 s9, s13
    s_cselect_b32 s9, s12, s9
    v_mfma_f32_32x32x16_bf16 v[24:39], v[152:155], v[120:123], v[24:39]
    buffer_load_dwordx4 v[120:123], v4, s[48:51], s30 offen sc1
    s_add_u32 s30, s30, 1024
    s_cmp_eq_u32 s30, s29
    s_cselect_b32 s30, s28, s30
    ds_read_b64_tr_b16 v[152:153], v10 offset:12288
    ds_read_b64_tr_b16 v[154:155], v10 offset:12800
    ds_read_b64_tr_b16 v[156:157], v11 offset:12288
    ds_read_b64_tr_b16 v[158:159], v11 offset:12800
    s_waitcnt vmcnt(28)
    v_mfma_f32_32x32x16_bf16 v[40:55], v[160:163], v[132:135], v[40:55]
    s_waitcnt lgkmcnt(0)
    s_add_u32 m0, s11, 143360
    s_nop 0
    s_nop 0
    buffer_load_dwordx4 v2, s[56:59], s9 offen lds
    v_mfma_f32_32x32x16_bf16 v[72:87], v[164:167], v[132:135], v[72:87]
    buffer_load_dwordx4 v[132:135], v5, s[48:51], s30 offen sc1
    v_mfma_f32_32x32x16_bf16 v[56:71], v[164:167], v[128:131], v[56:71]
    s_add_u32 m0, s11, 143360
    s_nop 0
    buffer_load_dwordx4 v3, s[56:59], s9 offen offset:1024 lds
    v_mfma_f32_32x32x16_bf16 v[24:39], v[160:163], v[128:131], v[24:39]
    buffer_load_dwordx4 v[128:131], v4, s[48:51], s30 offen sc1
    s_add_u32 s30, s30, 1024
    s_cmp_eq_u32 s30, s29
    s_cselect_b32 s30, s28, s30
    s_waitcnt vmcnt(28)
    v_mfma_f32_32x32x16_bf16 v[40:55], v[168:171], v[140:143], v[40:55]
    v_mfma_f32_32x32x16_bf16 v[72:87], v[172:175], v[140:143], v[72:87]
    buffer_load_dwordx4 v[140:143], v5, s[48:51], s30 offen sc1
    v_mfma_f32_32x32x16_bf16 v[56:71], v[172:175], v[136:139], v[56:71]
    v_mfma_f32_32x32x16_bf16 v[24:39], v[168:171], v[136:139], v[24:39]
    buffer_load_dwordx4 v[136:139], v4, s[48:51], s30 offen sc1
    s_add_u32 s30, s30, 1024
    s_cmp_eq_u32 s30, s29
    s_cselect_b32 s30, s28, s30
    s_nop 0
    s_waitcnt vmcnt(26)
    v_mfma_f32_32x32x16_bf16 v[40:55], v[176:179], v[148:151], v[40:55]
    v_mfma_f32_32x32x16_bf16 v[72:87], v[180:183], v[148:151], v[72:87]
    buffer_load_dwordx4 v[148:151], v5, s[48:51], s30 offen sc1
    v_mfma_f32_32x32x16_bf16 v[56:71], v[180:183], v[144:147], v[56:71]
    v_mfma_f32_32x32x16_bf16 v[24:39], v[176:179], v[144:147], v[24:39]
    buffer_load_dwordx4 v[144:147], v4, s[48:51], s30 offen sc1
    s_add_u32 s30, s30, 1024
    s_cmp_eq_u32 s30, s29
    s_cselect_b32 s30, s28, s30
    s_waitcnt vmcnt(13)
    ds_read_b64_tr_b16 v[160:161], v8 offset:0
    ds_read_b64_tr_b16 v[162:163], v8 offset:512
    ds_read_b64_tr_b16 v[164:165], v9 offset:0
    ds_read_b64_tr_b16 v[166:167], v9 offset:512
    s_and_b32 s34, s22, 251658240
    s_cbranch_scc0 L_ok38
    s_mov_b32 s76, 200000
L_lp38:
    s_sleep 4
    buffer_load_dword v23, v14, s[48:51], s31 offen sc1
    s_waitcnt vmcnt(0)
    v_cmp_ne_u32 vcc, s97, v23
    s_nop 1
    s_mov_b32 s22, vcc_lo
    s_and_b32 s34, s22, 251658240
    s_cbranch_scc0 L_ok38
    s_sub_u32 s76, s76, 1
    s_cbranch_scc0 L_lp38
L_ok38:
    v_mfma_f32_32x32x16_bf16 v[40:55], v[184:187], v[92:95], v[40:55]
    v_mfma_f32_32x32x16_bf16 v[72:87], v[188:191], v[92:95], v[72:87]
    buffer_load_dwordx4 v[92:95], v5, s[48:51], s30 offen sc1
    v_mfma_f32_32x32x16_bf16 v[56:71], v[188:191], v[88:91], v[56:71]
    v_mfma_f32_32x32x16_bf16 v[24:39], v[184:187], v[88:91], v[24:39]
    buffer_load_dwordx4 v[88:91], v4, s[48:51], s30 offen sc1
    s_add_u32 s30, s30, 1024
    s_cmp_eq_u32 s30, s29
    s_cselect_b32 s30, s28, s30
    s_nop 0
    s_waitcnt vmcnt(11)
    ds_read_b64_tr_b16 v[168:169], v8 offset:8192
    ds_read_b64_tr_b16 v[170:171], v8 offset:8704
    ds_read_b64_tr_b16 v[172:173], v9 offset:8192
    ds_read_b64_tr_b16 v[174:175], v9 offset:8704
    v_mfma_f32_32x32x16_bf16 v[40:55], v[192:195], v[100:103], v[40:55]
    v_mfma_f32_32x32x16_bf16 v[72:87], v[196:199], v[100:103], v[72:87]
    buffer_load_dwordx4 v[100:103], v5, s[48:51], s30 offen sc1
    v_mfma_f32_32x32x16_bf16 v[56:71], v[196:199], v[96:99], v[56:71]
    v_mfma_f32_32x32x16_bf16 v[24:39], v[192:195], v[96:99], v[24:39]
    buffer_load_dwordx4 v[96:99], v4, s[48:51], s30 offen sc1
    s_add_u32 s30, s30, 1024
    s_cmp_eq_u32 s30, s29
    s_cselect_b32 s30, s28, s30
    s_waitcnt vmcnt(9)
    ds_read_b64_tr_b16 v[176:177], v10 offset:12288
    ds_read_b64_tr_b16 v[178:179], v10 offset:12800
    ds_read_b64_tr_b16 v[180:181], v11 offset:12288
    ds_read_b64_tr_b16 v[182:183], v11 offset:12800
    s_waitcnt lgkmcnt(4)
    s_mov_b64 exec, 1
    ds_write_b32 v22, v21 offset:128
    s_mov_b64 exec, -1
    v_mfma_f32_32x32x16_bf16 v[40:55], v[200:203], v[108:111], v[40:55]
    v_mfma_f32_32x32x16_bf16 v[72:87], v[204:207], v[108:111], v[72:87]
    buffer_load_dwordx4 v[108:111], v5, s[48:51], s30 offen sc1
    v_mfma_f32_32x32x16_bf16 v[56:71], v[204:207], v[104:107], v[56:71]
    v_mfma_f32_32x32x16_bf16 v[24:39], v[200:203], v[104:107], v[24:39]
    buffer_load_dwordx4 v[104:107], v4, s[48:51], s30 offen sc1
    s_add_u32 s30, s30, 1024
    s_cmp_eq_u32 s30, s29
    s_cselect_b32 s30, s28, s30
    v_mfma_f32_32x32x16_bf16 v[40:55], v[208:211], v[116:119], v[40:55]
    v_mfma_f32_32x32x16_bf16 v[72:87], v[212:215], v[116:119], v[72:87]
    buffer_load_dwordx4 v[116:119], v5, s[48:51], s30 offen sc1
    v_mfma_f32_32x32x16_bf16 v[56:71], v[212:215], v[112:115], v[56:71]
    v_mfma_f32_32x32x16_bf16 v[24:39], v[208:211], v[112:115], v[24:39]
    buffer_load_dwordx4 v[112:115], v4, s[48:51], s30 offen sc1
    v_mfma_f32_32x32x16_bf16 v[40:55], v[216:219], v[124:127], v[40:55]
    v_mfma_f32_32x32x16_bf16 v[72:87], v[220:223], v[124:127], v[72:87]
    v_mfma_f32_32x32x16_bf16 v[56:71], v[220:223], v[120:123], v[56:71]
    v_mfma_f32_32x32x16_bf16 v[24:39], v[216:219], v[120:123], v[24:39]
    s_waitcnt vmcnt(12)
    v_mfma_f32_32x32x16_bf16 v[40:55], v[224:227], v[132:135], v[40:55]
    v_mfma_f32_32x32x16_bf16 v[72:87], v[228:231], v[132:135], v[72:87]
    v_mfma_f32_32x32x16_bf16 v[56:71], v[228:231], v[128:131], v[56:71]
    v_mfma_f32_32x32x16_bf16 v[24:39], v[224:227], v[128:131], v[24:39]
    s_waitcnt vmcnt(10)
    v_mfma_f32_32x32x16_bf16 v[40:55], v[232:235], v[140:143], v[40:55]
    v_mfma_f32_32x32x16_bf16 v[72:87], v[236:239], v[140:143], v[72:87]
    v_mfma_f32_32x32x16_bf16 v[56:71], v[236:239], v[136:139], v[56:71]
    v_mfma_f32_32x32x16_bf16 v[24:39], v[232:235], v[136:139], v[24:39]
    s_waitcnt vmcnt(8)
    v_mfma_f32_32x32x16_bf16 v[40:55], v[240:243], v[148:151], v[40:55]
    v_mfma_f32_32x32x16_bf16 v[72:87], v[244:247], v[148:151], v[72:87]
    v_mfma_f32_32x32x16_bf16 v[56:71], v[244:247], v[144:147], v[56:71]
    v_mfma_f32_32x32x16_bf16 v[24:39], v[240:243], v[144:147], v[24:39]
    s_waitcnt vmcnt(6)
    v_mfma_f32_32x32x16_bf16 v[40:55], v[152:155], v[92:95], v[40:55]
    v_mfma_f32_32x32x16_bf16 v[72:87], v[156:159], v[92:95], v[72:87]
    v_mfma_f32_32x32x16_bf16 v[56:71], v[156:159], v[88:91], v[56:71]
    v_mfma_f32_32x32x16_bf16 v[24:39], v[152:155], v[88:91], v[24:39]
    s_waitcnt vmcnt(4)
    v_mfma_f32_32x32x16_bf16 v[40:55], v[160:163], v[100:103], v[40:55]
    v_mfma_f32_32x32x16_bf16 v[72:87], v[164:167], v[100:103], v[72:87]
    v_mfma_f32_32x32x16_bf16 v[56:71], v[164:167], v[96:99], v[56:71]
    v_mfma_f32_32x32x16_bf16 v[24:39], v[160:163], v[96:99], v[24:39]
    s_mov_b32 s76, 200000
L_ll39:
    ds_read_b32 v23, v20 offset:16
    s_waitcnt lgkmcnt(0)
    v_readfirstlane_b32 s77, v23
    s_nop 0
    s_cmp_eq_u32 s77, 4
    s_cbranch_scc1 L_lk39
    s_sleep 1
    s_sub_u32 s76, s76, 1
    s_cbranch_scc0 L_ll39
L_lk39:
    s_waitcnt vmcnt(2)
    v_mfma_f32_32x32x16_bf16 v[40:55], v[168:171], v[108:111], v[40:55]
    v_mfma_f32_32x32x16_bf16 v[72:87], v[172:175], v[108:111], v[72:87]
    v_mfma_f32_32x32x16_bf16 v[56:71], v[172:175], v[104:107], v[56:71]
    v_mfma_f32_32x32x16_bf16 v[24:39], v[168:171], v[104:107], v[24:39]
    s_waitcnt vmcnt(0)
    v_mfma_f32_32x32x16_bf16 v[40:55], v[176:179], v[116:119], v[40:55]
    v_mfma_f32_32x32x16_bf16 v[72:87], v[180:183], v[116:119], v[72:87]
    v_mfma_f32_32x32x16_bf16 v[56:71], v[180:183], v[112:115], v[56:71]
    v_mfma_f32_32x32x16_bf16 v[24:39], v[176:179], v[112:115], v[24:39]
    s_setprio 2
    s_mov_b32 s10, 0xbfb8aa3b
    s_mov_b32 s11, s10
    s_mov_b32 s12, 1.0
    s_mov_b32 s13, 1.0
    s_nop 3
    ds_write_b128 v15, v[40:43] offset:0
    ds_write_b128 v15, v[44:47] offset:1024
    ds_write_b128 v15, v[48:51] offset:2048
    ds_write_b128 v15, v[52:55] offset:3072
    ds_write_b128 v15, v[72:75] offset:8192
    ds_write_b128 v15, v[76:79] offset:9216
    ds_write_b128 v15, v[80:83] offset:10240
    ds_write_b128 v15, v[84:87] offset:11264
    ds_write_b128 v15, v[56:59] offset:4096
    ds_write_b128 v15, v[60:63] offset:5120
    ds_write_b128 v15, v[64:67] offset:6144
    ds_write_b128 v15, v[68:71] offset:7168
    s_waitcnt lgkmcnt(0)
    s_mov_b64 exec, 1
    ds_add_u32 v20, v21 offset:208
    s_nop 0
    s_mov_b64 exec, -1
    s_mov_b32 s76, 200000
L_ll40:
    ds_read_b32 v23, v20 offset:208
    s_waitcnt lgkmcnt(0)
    v_readfirstlane_b32 s77, v23
    s_nop 0
    s_cmp_eq_u32 s77, 4
    s_cbranch_scc1 L_lk40
    s_sleep 1
    s_sub_u32 s76, s76, 1
    s_cbranch_scc0 L_ll40
L_lk40:
    ds_read_b128 v[40:43], v16 offset:0
    ds_read_b128 v[44:47], v16 offset:1024
    ds_read_b128 v[48:51], v16 offset:2048
    ds_read_b128 v[52:55], v16 offset:3072
    ds_read_b128 v[56:59], v17 offset:0
    ds_read_b128 v[60:63], v17 offset:1024
    ds_read_b128 v[64:67], v17 offset:2048
    ds_read_b128 v[68:71], v17 offset:3072
    ds_read_b128 v[72:75], v18 offset:0
    ds_read_b128 v[76:79], v18 offset:1024
    ds_read_b128 v[80:83], v18 offset:2048
    ds_read_b128 v[84:87], v18 offset:3072
    s_waitcnt lgkmcnt(10)
    v_add_f32 v24, v24, v40
    v_add_f32 v25, v25, v41
    v_add_f32 v26, v26, v42
    v_add_f32 v27, v27, v43
    v_add_f32 v28, v28, v44
    v_add_f32 v29, v29, v45
    v_add_f32 v30, v30, v46
    v_add_f32 v31, v31, v47
    s_waitcnt lgkmcnt(8)
    v_add_f32 v32, v32, v48
    v_add_f32 v33, v33, v49
    v_add_f32 v34, v34, v50
    v_add_f32 v35, v35, v51
    v_add_f32 v36, v36, v52
    v_add_f32 v37, v37, v53
    v_add_f32 v38, v38, v54
    v_add_f32 v39, v39, v55
    s_waitcnt lgkmcnt(6)
    v_add_f32 v24, v24, v56
    v_add_f32 v25, v25, v57
    v_add_f32 v26, v26, v58
    v_add_f32 v27, v27, v59
    v_add_f32 v28, v28, v60
    v_add_f32 v29, v29, v61
    v_add_f32 v30, v30, v62
    v_add_f32 v31, v31, v63
    s_waitcnt lgkmcnt(4)
    v_add_f32 v32, v32, v64
    v_add_f32 v33, v33, v65
    v_add_f32 v34, v34, v66
    v_add_f32 v35, v35, v67
    v_add_f32 v36, v36, v68
    v_add_f32 v37, v37, v69
    v_add_f32 v38, v38, v70
    v_add_f32 v39, v39, v71
    s_waitcnt lgkmcnt(2)
    v_add_f32 v24, v24, v72
    v_add_f32 v25, v25, v73
    v_add_f32 v26, v26, v74
    v_add_f32 v27, v27, v75
    v_add_f32 v28, v28, v76
    v_add_f32 v29, v29, v77
    v_add_f32 v30, v30, v78
    v_add_f32 v31, v31, v79
    s_waitcnt lgkmcnt(0)
    v_add_f32 v32, v32, v80
    v_add_f32 v33, v33, v81
    v_add_f32 v34, v34, v82
    v_add_f32 v35, v35, v83
    v_add_f32 v36, v36, v84
    v_add_f32 v37, v37, v85
    v_add_f32 v38, v38, v86
    v_add_f32 v39, v39, v87
    v_mul_f32 v40, s10, v24
    v_mul_f32 v41, s11, v25
    v_mul_f32 v42, s10, v26
    v_mul_f32 v43, s11, v27
    v_mul_f32 v44, s10, v28
    v_mul_f32 v45, s11, v29
    v_mul_f32 v46, s10, v30
    v_mul_f32 v47, s11, v31
    v_mul_f32 v48, s10, v32
    v_mul_f32 v49, s11, v33
    v_mul_f32 v50, s10, v34
    v_mul_f32 v51, s11, v35
    v_mul_f32 v52, s10, v36
    v_mul_f32 v53, s11, v37
    v_mul_f32 v54, s10, v38
    v_mul_f32 v55, s11, v39
    v_exp_f32 v40, v40
    v_exp_f32 v41, v41
    v_exp_f32 v42, v42
    v_exp_f32 v43, v43
    v_exp_f32 v44, v44
    v_exp_f32 v45, v45
    v_exp_f32 v46, v46
    v_exp_f32 v47, v47
    v_exp_f32 v48, v48
    v_exp_f32 v49, v49
    v_exp_f32 v50, v50
    v_exp_f32 v51, v51
    v_exp_f32 v52, v52
    v_exp_f32 v53, v53
    v_exp_f32 v54, v54
    v_exp_f32 v55, v55
    v_add_f32 v40, s12, v40
    v_add_f32 v41, s13, v41
    v_add_f32 v42, s12, v42
    v_add_f32 v43, s13, v43
    v_add_f32 v44, s12, v44
    v_add_f32 v45, s13, v45
    v_add_f32 v46, s12, v46
    v_add_f32 v47, s13, v47
    v_add_f32 v48, s12, v48
    v_add_f32 v49, s13, v49
    v_add_f32 v50, s12, v50
    v_add_f32 v51, s13, v51
    v_add_f32 v52, s12, v52
    v_add_f32 v53, s13, v53
    v_add_f32 v54, s12, v54
    v_add_f32 v55, s13, v55
    v_rcp_f32 v40, v40
    v_rcp_f32 v41, v41
    v_rcp_f32 v42, v42
    v_rcp_f32 v43, v43
    v_rcp_f32 v44, v44
    v_rcp_f32 v45, v45
    v_rcp_f32 v46, v46
    v_rcp_f32 v47, v47
    v_rcp_f32 v48, v48
    v_rcp_f32 v49, v49
    v_rcp_f32 v50, v50
    v_rcp_f32 v51, v51
    v_rcp_f32 v52, v52
    v_rcp_f32 v53, v53
    v_rcp_f32 v54, v54
    v_rcp_f32 v55, v55
    v_mul_f32 v24, v24, v40
    v_mul_f32 v25, v25, v41
    v_mul_f32 v26, v26, v42
    v_mul_f32 v27, v27, v43
    ds_write_b128 v19, v[24:27] offset:0
    v_mul_f32 v28, v28, v44
    v_mul_f32 v29, v29, v45
    v_mul_f32 v30, v30, v46
    v_mul_f32 v31, v31, v47
    ds_write_b128 v19, v[28:31] offset:1024
    v_mul_f32 v32, v32, v48
    v_mul_f32 v33, v33, v49
    v_mul_f32 v34, v34, v50
    v_mul_f32 v35, v35, v51
    ds_write_b128 v19, v[32:35] offset:8192
    v_mul_f32 v36, v36, v52
    v_mul_f32 v37, v37, v53
    v_mul_f32 v38, v38, v54
    v_mul_f32 v39, v39, v55
    ds_write_b128 v19, v[36:39] offset:9216
    s_waitcnt lgkmcnt(0)
    s_mov_b64 exec, 1
    ds_write_b32 v22, v21 offset:256
    s_mov_b64 exec, -1
    s_branch L_exit
L_attn:
    s_setprio 1
    s_nop 0
    v_mov_b32 v252, s97
    v_cmp_ne_u32 vcc, s97, v6
    s_cbranch_vccz L_kvgo
    buffer_load_dword v6, v3, s[48:51], s23 offen sc1
    s_waitcnt vmcnt(0)
    buffer_store_dword v252, off, s[48:51], s99 sc1
    v_cmp_ne_u32 vcc, s97, v6
    s_cbranch_vccz L_ok41
    s_mov_b32 s76, 200000
L_lp41:
    s_sleep 6
    buffer_load_dword v6, v3, s[48:51], s23 offen sc1
    s_waitcnt vmcnt(0)
    v_cmp_ne_u32 vcc, s97, v6
    s_cbranch_vccz L_ok41
    s_sub_u32 s76, s76, 1
    s_cbranch_scc0 L_lp41
L_ok41:
L_kvgo:
    s_lshl_b32 s34, s22, 11
    s_add_u32 s34, s34, s24
    s_lshl_b32 s35, s14, 11
    s_add_u32 m0, s35, 135168
    s_add_u32 s34, s34, 2097152
    buffer_load_dwordx4 v1, s[48:51], s34 offen offset:1024 sc1 lds
    s_lshl_b32 s34, s22, 11
    s_add_u32 s34, s34, s24
    s_lshl_b32 s35, s14, 11
    s_add_u32 m0, s35, 135168
    s_add_u32 s34, s34, 2097152
    buffer_load_dwordx4 v1, s[48:51], s34 offen offset:0 sc1 lds
    s_add_u32 s34, s20, 0
    s_max_u32 s34, s34, 8
    s_lshl_b32 s34, s34, 11
    s_add_u32 s34, s34, s24
    s_add_u32 m0, s21, 0
    s_add_u32 s34, s34, 4177920
    buffer_load_dwordx4 v1, s[48:51], s34 offen offset:0 sc1 lds
    s_add_u32 s34, s20, 0
    s_max_u32 s34, s34, 8
    s_lshl_b32 s34, s34, 11
    s_add_u32 s34, s34, s24
    s_add_u32 m0, s21, 0
    s_add_u32 s34, s34, 4177920
    buffer_load_dwordx4 v1, s[48:51], s34 offen offset:1024 sc1 lds
    s_add_u32 s34, s20, 1
    s_max_u32 s34, s34, 8
    s_lshl_b32 s34, s34, 11
    s_add_u32 s34, s34, s24
    s_add_u32 m0, s21, 4096
    s_add_u32 s34, s34, 4177920
    buffer_load_dwordx4 v1, s[48:51], s34 offen offset:0 sc1 lds
    s_add_u32 s34, s20, 1
    s_max_u32 s34, s34, 8
    s_lshl_b32 s34, s34, 11
    s_add_u32 s34, s34, s24
    s_add_u32 m0, s21, 4096
    s_add_u32 s34, s34, 4177920
    buffer_load_dwordx4 v1, s[48:51], s34 offen offset:1024 sc1 lds
    s_add_u32 s34, s20, 2
    s_max_u32 s34, s34, 8
    s_lshl_b32 s34, s34, 11
    s_add_u32 s34, s34, s24
    s_add_u32 m0, s21, 8192
    s_add_u32 s34, s34, 4177920
    buffer_load_dwordx4 v1, s[48:51], s34 offen offset:0 sc1 lds
    s_add_u32 s34, s20, 2
    s_max_u32 s34, s34, 8
    s_lshl_b32 s34, s34, 11
    s_add_u32 s34, s34, s24
    s_add_u32 m0, s21, 8192
    s_add_u32 s34, s34, 4177920
    buffer_load_dwordx4 v1, s[48:51], s34 offen offset:1024 sc1 lds
    s_add_u32 s34, s20, 0
    s_max_u32 s34, s34, 8
    s_lshl_b32 s34, s34, 11
    s_add_u32 s34, s34, s24
    s_add_u32 m0, s21, 2048
    s_add_u32 s34, s34, 6275072
    buffer_load_dwordx4 v1, s[48:51], s34 offen offset:0 sc1 lds
    s_add_u32 s34, s20, 0
    s_max_u32 s34, s34, 8
    s_lshl_b32 s34, s34, 11
    s_add_u32 s34, s34, s24
    s_add_u32 m0, s21, 2048
    s_add_u32 s34, s34, 6275072
    buffer_load_dwordx4 v1, s[48:51], s34 offen offset:1024 sc1 lds
    s_add_u32 s34, s20, 1
    s_max_u32 s34, s34, 8
    s_lshl_b32 s34, s34, 11
    s_add_u32 s34, s34, s24
    s_add_u32 m0, s21, 6144
    s_add_u32 s34, s34, 6275072
    buffer_load_dwordx4 v1, s[48:51], s34 offen offset:0 sc1 lds
    s_add_u32 s34, s20, 1
    s_max_u32 s34, s34, 8
    s_lshl_b32 s34, s34, 11
    s_add_u32 s34, s34, s24
    s_add_u32 m0, s21, 6144
    s_add_u32 s34, s34, 6275072
    buffer_load_dwordx4 v1, s[48:51], s34 offen offset:1024 sc1 lds
    s_add_u32 s34, s20, 2
    s_max_u32 s34, s34, 8
    s_lshl_b32 s34, s34, 11
    s_add_u32 s34, s34, s24
    s_add_u32 m0, s21, 10240
    s_add_u32 s34, s34, 6275072
    buffer_load_dwordx4 v1, s[48:51], s34 offen offset:0 sc1 lds
    s_add_u32 s34, s20, 2
    s_max_u32 s34, s34, 8
    s_lshl_b32 s34, s34, 11
    s_add_u32 s34, s34, s24
    s_add_u32 m0, s21, 10240
    s_add_u32 s34, s34, 6275072
    buffer_load_dwordx4 v1, s[48:51], s34 offen offset:1024 sc1 lds
    s_mov_b64 exec, 1
    ds_add_u32 v5, v9 offset:112
    s_mov_b64 exec, -1
    s_waitcnt vmcnt(14)
    buffer_store_dword v252, off, s[48:51], s99 sc1
    v_lshrrev_b32 v251, 5, v0
    v_and_b32 v5, 31, v0
    v_lshlrev_b32 v251, 2, v251
    v_sub_u32 v5, v5, v251
    v_mov_b32 v4, 0xf149f2ca
    s_lshl_b32 s34, s14, 12
    s_add_u32 s34, s34, 86016
    v_add_u32_e64 v7, s34, v1
    v_mov_b32 v250, 156672
    v_mov_b32 v251, 1
    v_cmp_le_i32 vcc, 0, v5
    v_cmp_le_i32 s[76:77], 1, v5
    s_nop 0
    v_cndmask_b32 v16, v4, 0, vcc
    v_cndmask_b32 v32, 0, v4, vcc
    v_cndmask_b32 v17, v4, 0, s[76:77]
    v_cndmask_b32 v33, 0, v4, s[76:77]
    v_cmp_le_i32 vcc, 2, v5
    v_cmp_le_i32 s[76:77], 3, v5
    s_nop 0
    v_cndmask_b32 v18, v4, 0, vcc
    v_cndmask_b32_e64 v34, 0, v4, vcc
    v_cndmask_b32 v19, v4, 0, s[76:77]
    v_cndmask_b32 v35, 0, v4, s[76:77]
    v_cmp_le_i32 vcc, 8, v5
    v_cmp_le_i32 s[76:77], 9, v5
    s_nop 0
    v_cndmask_b32 v20, v4, 0, vcc
    v_cndmask_b32_e64 v36, 0, v4, vcc
    v_cndmask_b32 v21, v4, 0, s[76:77]
    v_cndmask_b32 v37, 0, v4, s[76:77]
    v_cmp_le_i32 vcc, 10, v5
    v_cmp_le_i32 s[76:77], 11, v5
    s_nop 0
    v_cndmask_b32 v22, v4, 0, vcc
    v_cndmask_b32_e64 v38, 0, v4, vcc
    v_cndmask_b32 v23, v4, 0, s[76:77]
    v_cndmask_b32 v39, 0, v4, s[76:77]
    v_cmp_le_i32 vcc, 16, v5
    v_cmp_le_i32 s[76:77], 17, v5
    s_nop 0
    v_cndmask_b32 v24, v4, 0, vcc
    v_cndmask_b32_e64 v40, 0, v4, vcc
    v_cndmask_b32 v25, v4, 0, s[76:77]
    v_cndmask_b32 v41, 0, v4, s[76:77]
    v_cmp_le_i32 vcc, 18, v5
    v_cmp_le_i32 s[76:77], 19, v5
    s_nop 0
    v_cndmask_b32 v26, v4, 0, vcc
    v_cndmask_b32_e64 v42, 0, v4, vcc
    v_cndmask_b32 v27, v4, 0, s[76:77]
    v_cndmask_b32 v43, 0, v4, s[76:77]
    v_cmp_le_i32 vcc, 24, v5
    v_cmp_le_i32 s[76:77], 25, v5
    s_nop 0
    v_cndmask_b32 v28, v4, 0, vcc
    v_cndmask_b32_e64 v44, 0, v4, vcc
    v_cndmask_b32 v29, v4, 0, s[76:77]
    v_cndmask_b32 v45, 0, v4, s[76:77]
    v_cmp_le_i32 vcc, 26, v5
    v_cmp_le_i32 s[76:77], 27, v5
    s_nop 0
    v_cndmask_b32 v30, v4, 0, vcc
    v_cndmask_b32_e64 v46, 0, v4, vcc
    v_cndmask_b32 v31, v4, 0, s[76:77]
    v_cndmask_b32 v47, 0, v4, s[76:77]
    s_min_u32 s34, s4, 27
    s_lshl_b32 s26, s3, 2
    s_and_b32 s35, s34, 3
    s_add_u32 s26, s26, s35
    s_lshr_b32 s27, s34, 2
    s_lshl_b32 s27, s27, 7
    s_waitcnt vmcnt(7)
    s_cmp_ge_u32 s20, 8
    s_cbranch_scc1 L_b_nonull
    v_mov_b32 v48, 0
    v_mov_b32 v49, 0
    v_mov_b32 v50, 0
    v_mov_b32 v51, 0
    v_mov_b32 v52, 0
    v_mov_b32 v53, 0
    v_mov_b32 v55, 0
    v_mov_b32 v54, 61769
    v_cndmask_b32 v54, 0, v54, s[72:73]
    v_add_u32_e64 v5, s21, v1
    ds_write_b128 v5, v[48:51]
    ds_write_b128 v5, v[52:55] offset:1024
    s_cmp_ge_u32 s20, 7
    s_cbranch_scc1 L_b_nonull
    ds_write_b128 v5, v[48:51] offset:4096
    ds_write_b128 v5, v[52:55] offset:5120
    s_cmp_ge_u32 s20, 6
    s_cbranch_scc1 L_b_nonull
    ds_write_b128 v5, v[48:51] offset:8192
    ds_write_b128 v5, v[52:55] offset:9216
L_b_nonull:
    s_waitcnt lgkmcnt(0)
    s_mov_b64 exec, 1
    ds_add_u32 v250, v251 offset:0
    s_mov_b64 exec, -1
    s_lshl_b32 s34, s14, 11
    s_add_u32 s34, s34, 135168
    v_add_u32_e64 v5, s34, v1
    ds_read_b128 v[8:11], v5
    ds_read_b128 v[12:15], v5 offset:1024
    s_mov_b32 s76, 200000
L_ll42:
    ds_read_b32 v253, v250 offset:0
    s_waitcnt lgkmcnt(0)
    v_readfirstlane_b32 s77, v253
    s_nop 0
    s_cmp_eq_u32 s77, 4
    s_cbranch_scc1 L_lk42
    s_sleep 1
    s_sub_u32 s76, s76, 1
    s_cbranch_scc0 L_ll42
L_lk42:
    ds_read_b128 v[208:211], v7 offset:32768
    ds_read_b128 v[212:215], v7 offset:33792
    ds_read_b128 v[216:219], v7 offset:28672
    ds_read_b128 v[220:223], v7 offset:29696
    ds_read_b128 v[224:227], v7 offset:24576
    ds_read_b128 v[228:231], v7 offset:25600
    s_waitcnt lgkmcnt(4)
    v_mfma_f32_32x32x16_bf16 v[192:207], v[208:211], v[8:11], v[16:31]
    v_mfma_f32_32x32x16_bf16 v[192:207], v[212:215], v[12:15], v[192:207]
    ds_read_b128 v[208:211], v7 offset:20480
    ds_read_b128 v[212:215], v7 offset:21504
    s_waitcnt lgkmcnt(4)
    v_mfma_f32_32x32x16_bf16 v[176:191], v[216:219], v[8:11], 0
    v_mfma_f32_32x32x16_bf16 v[176:191], v[220:223], v[12:15], v[176:191]
    ds_read_b128 v[216:219], v7 offset:16384
    ds_read_b128 v[220:223], v7 offset:17408
    s_waitcnt lgkmcnt(4)
    v_mfma_f32_32x32x16_bf16 v[160:175], v[224:227], v[8:11], 0
    s_nop 2
    v_max3_f32 v5, v192, v193, v194
    v_max3_f32 v6, v195, v196, v197
    v_max3_f32 v5, v5, v198, v199
    v_max3_f32 v6, v6, v200, v201
    v_mfma_f32_32x32x16_bf16 v[160:175], v[228:231], v[12:15], v[160:175]
    v_max3_f32 v5, v5, v202, v203
    v_max3_f32 v6, v6, v204, v205
    v_max3_f32 v5, v5, v206, v207
    ds_read_b128 v[224:227], v7 offset:12288
    ds_read_b128 v[228:231], v7 offset:13312
    s_nop 0
    s_waitcnt lgkmcnt(4)
    v_mfma_f32_32x32x16_bf16 v[144:159], v[208:211], v[8:11], 0
    v_max3_f32 v5, v5, v176, v177
    v_max3_f32 v6, v6, v178, v179
    v_max3_f32 v5, v5, v180, v181
    v_max3_f32 v6, v6, v182, v183
    v_mfma_f32_32x32x16_bf16 v[144:159], v[212:215], v[12:15], v[144:159]
    v_max3_f32 v5, v5, v184, v185
    v_max3_f32 v6, v6, v186, v187
    v_max3_f32 v5, v5, v188, v189
    v_max3_f32 v6, v6, v190, v191
    s_waitcnt vmcnt(0)
    s_mov_b64 exec, 1
    ds_add_u32 v250, v251 offset:224
    s_mov_b64 exec, -1
    ds_read_b128 v[208:211], v7 offset:8192
    ds_read_b128 v[212:215], v7 offset:9216
    s_waitcnt lgkmcnt(5)
    v_mfma_f32_32x32x16_bf16 v[128:143], v[216:219], v[8:11], 0
    v_max3_f32 v5, v5, v160, v161
    v_max3_f32 v6, v6, v162, v163
    v_max3_f32 v5, v5, v164, v165
    v_max3_f32 v6, v6, v166, v167
    v_mfma_f32_32x32x16_bf16 v[128:143], v[220:223], v[12:15], v[128:143]
    v_max3_f32 v5, v5, v168, v169
    v_max3_f32 v6, v6, v170, v171
    v_max3_f32 v5, v5, v172, v173
    v_max3_f32 v6, v6, v174, v175
    ds_read_b128 v[216:219], v7 offset:4096
    ds_read_b128 v[220:223], v7 offset:5120
    s_nop 0
    s_waitcnt lgkmcnt(5)
    v_mfma_f32_32x32x16_bf16 v[112:127], v[224:227], v[8:11], 0
    v_max3_f32 v5, v5, v144, v145
    v_max3_f32 v6, v6, v146, v147
    v_max3_f32 v5, v5, v148, v149
    v_max3_f32 v6, v6, v150, v151
    v_mfma_f32_32x32x16_bf16 v[112:127], v[228:231], v[12:15], v[112:127]
    v_max3_f32 v5, v5, v152, v153
    v_max3_f32 v6, v6, v154, v155
    v_max3_f32 v5, v5, v156, v157
    v_max3_f32 v6, v6, v158, v159
    ds_read_b128 v[224:227], v7 offset:0
    ds_read_b128 v[228:231], v7 offset:1024
    s_nop 0
    s_waitcnt lgkmcnt(4)
    v_mfma_f32_32x32x16_bf16 v[96:111], v[208:211], v[8:11], 0
    v_max3_f32 v5, v5, v128, v129
    v_max3_f32 v6, v6, v130, v131
    v_max3_f32 v5, v5, v132, v133
    v_max3_f32 v6, v6, v134, v135
    v_mfma_f32_32x32x16_bf16 v[96:111], v[212:215], v[12:15], v[96:111]
    v_max3_f32 v5, v5, v136, v137
    v_max3_f32 v6, v6, v138, v139
    v_max3_f32 v5, v5, v140, v141
    v_max3_f32 v6, v6, v142, v143
    s_mov_b32 s76, 200000
L_ll43:
    ds_read_b32 v253, v250 offset:224
    s_waitcnt lgkmcnt(0)
    v_readfirstlane_b32 s77, v253
    s_nop 0
    s_cmp_eq_u32 s77, 4
    s_cbranch_scc1 L_lk43
    s_sleep 1
    s_sub_u32 s76, s76, 1
    s_cbranch_scc0 L_ll43
L_lk43:
    ds_read_b128 v[208:211], v7 offset:34816
    ds_read_b128 v[212:215], v7 offset:35840
    v_mfma_f32_32x32x16_bf16 v[80:95], v[216:219], v[8:11], 0
    v_max3_f32 v5, v5, v112, v113
    v_max3_f32 v6, v6, v114, v115
    v_max3_f32 v5, v5, v116, v117
    v_max3_f32 v6, v6, v118, v119
    v_mfma_f32_32x32x16_bf16 v[80:95], v[220:223], v[12:15], v[80:95]
    v_max3_f32 v5, v5, v120, v121
    v_max3_f32 v6, v6, v122, v123
    v_max3_f32 v5, v5, v124, v125
    v_max3_f32 v6, v6, v126, v127
    ds_read_b128 v[216:219], v7 offset:30720
    ds_read_b128 v[220:223], v7 offset:31744
    v_mfma_f32_32x32x16_bf16 v[64:79], v[224:227], v[8:11], v[32:47]
    v_max3_f32 v5, v5, v96, v97
    v_max3_f32 v6, v6, v98, v99
    v_max3_f32 v5, v5, v100, v101
    v_max3_f32 v6, v6, v102, v103
    v_mfma_f32_32x32x16_bf16 v[64:79], v[228:231], v[12:15], v[64:79]
    v_max3_f32 v5, v5, v104, v105
    v_max3_f32 v6, v6, v106, v107
    v_max3_f32 v5, v5, v108, v109
    v_max3_f32 v6, v6, v110, v111
    v_max3_f32 v5, v5, v80, v81
    v_max3_f32 v6, v6, v82, v83
    v_max3_f32 v5, v5, v84, v85
    v_max3_f32 v6, v6, v86, v87
    v_max3_f32 v5, v5, v88, v89
    v_max3_f32 v6, v6, v90, v91
    v_max3_f32 v5, v5, v92, v93
    v_max3_f32 v6, v6, v94, v95
    s_lshl_b32 s34, s22, 15
    s_lshl_b32 s35, s16, 11
    s_add_u32 s34, s34, s35
    s_add_u32 s28, s34, 16777216
    s_lshr_b32 s35, s22, 1
    s_lshl_b32 s35, s35, 7
    s_lshl_b32 s76, s16, 3
    s_add_u32 s35, s35, s76
    s_and_b32 s76, s22, 1
    s_lshl_b32 s76, s76, 2
    s_add_u32 s35, s35, s76
    s_add_u32 s23, s35, 18964480
    v_max3_f32 v5, v5, v64, v65
    v_max3_f32 v6, v6, v66, v67
    v_max3_f32 v5, v5, v68, v69
    v_max3_f32 v6, v6, v70, v71
    v_max3_f32 v5, v5, v72, v73
    v_max3_f32 v6, v6, v74, v75
    v_max3_f32 v5, v5, v76, v77
    v_max3_f32 v6, v6, v78, v79
    v_max_f32 v5, v5, v6
    v_mov_b32 v6, v5
    s_mov_b32 s10, 0x3e8b97f6
    s_nop 0
    v_permlane32_swap_b32 v5, v6
    v_max_f32 v5, v5, v6
    v_mul_f32 v5, s10, v5
    v_fma_f32 v192, v192, s10, -v5
    v_fma_f32 v193, v193, s10, -v5
    v_fma_f32 v194, v194, s10, -v5
    v_fma_f32 v195, v195, s10, -v5
    v_fma_f32 v196, v196, s10, -v5
    v_fma_f32 v197, v197, s10, -v5
    v_fma_f32 v198, v198, s10, -v5
    v_fma_f32 v199, v199, s10, -v5
    v_exp_f32 v192, v192
    v_exp_f32 v193, v193
    v_exp_f32 v194, v194
    v_exp_f32 v195, v195
    v_exp_f32 v196, v196
    v_exp_f32 v197, v197
    v_exp_f32 v198, v198
    v_exp_f32 v199, v199
    v_fma_f32 v200, v200, s10, -v5
    v_fma_f32 v201, v201, s10, -v5
    v_fma_f32 v202, v202, s10, -v5
    v_fma_f32 v203, v203, s10, -v5
    v_fma_f32 v204, v204, s10, -v5
    v_fma_f32 v205, v205, s10, -v5
    v_fma_f32 v206, v206, s10, -v5
    v_fma_f32 v207, v207, s10, -v5
    v_exp_f32 v200, v200
    v_exp_f32 v201, v201
    v_exp_f32 v202, v202
    v_exp_f32 v203, v203
    v_exp_f32 v204, v204
    v_exp_f32 v205, v205
    v_exp_f32 v206, v206
    v_exp_f32 v207, v207
    v_cvt_pk_bf16_f32 v192, v192, v193
    v_cvt_pk_bf16_f32 v193, v194, v195
    v_cvt_pk_bf16_f32 v194, v196, v197
    v_cvt_pk_bf16_f32 v195, v198, v199
    v_cvt_pk_bf16_f32 v196, v200, v201
    v_cvt_pk_bf16_f32 v197, v202, v203
    v_cvt_pk_bf16_f32 v198, v204, v205
    v_cvt_pk_bf16_f32 v199, v206, v207
    v_fma_f32 v176, v176, s10, -v5
    v_fma_f32 v177, v177, s10, -v5
    v_fma_f32 v178, v178, s10, -v5
    v_fma_f32 v179, v179, s10, -v5
    s_nop 0
    s_waitcnt lgkmcnt(2)
    v_mfma_f32_32x32x16_bf16 v[48:63], v[208:211], v[192:195], 0
    v_fma_f32 v180, v180, s10, -v5
    v_fma_f32 v181, v181, s10, -v5
    v_fma_f32 v182, v182, s10, -v5
    v_fma_f32 v183, v183, s10, -v5
    v_exp_f32 v176, v176
    v_exp_f32 v177, v177
    v_exp_f32 v178, v178
    v_exp_f32 v179, v179
    v_exp_f32 v180, v180
    v_exp_f32 v181, v181
    v_exp_f32 v182, v182
    v_exp_f32 v183, v183
    v_fma_f32 v184, v184, s10, -v5
    v_fma_f32 v185, v185, s10, -v5
    v_fma_f32 v186, v186, s10, -v5
    v_fma_f32 v187, v187, s10, -v5
    v_mfma_f32_32x32x16_bf16 v[48:63], v[212:215], v[196:199], v[48:63]
    v_fma_f32 v188, v188, s10, -v5
    v_fma_f32 v189, v189, s10, -v5
    v_fma_f32 v190, v190, s10, -v5
    v_fma_f32 v191, v191, s10, -v5
    ds_read_b128 v[224:227], v7 offset:26624
    ds_read_b128 v[228:231], v7 offset:27648
    v_exp_f32 v184, v184
    v_exp_f32 v185, v185
    v_exp_f32 v186, v186
    v_exp_f32 v187, v187
    v_exp_f32 v188, v188
    v_exp_f32 v189, v189
    v_exp_f32 v190, v190
    v_exp_f32 v191, v191
    v_cvt_pk_bf16_f32 v176, v176, v177
    v_cvt_pk_bf16_f32 v177, v178, v179
    v_cvt_pk_bf16_f32 v178, v180, v181
    v_cvt_pk_bf16_f32 v179, v182, v183
    v_cvt_pk_bf16_f32 v180, v184, v185
    v_cvt_pk_bf16_f32 v181, v186, v187
    v_cvt_pk_bf16_f32 v182, v188, v189
    v_cvt_pk_bf16_f32 v183, v190, v191
    v_fma_f32 v160, v160, s10, -v5
    v_fma_f32 v161, v161, s10, -v5
    v_fma_f32 v162, v162, s10, -v5
    v_fma_f32 v163, v163, s10, -v5
    s_nop 0
    s_waitcnt lgkmcnt(2)
    v_mfma_f32_32x32x16_bf16 v[48:63], v[216:219], v[176:179], v[48:63]
    v_fma_f32 v164, v164, s10, -v5
    v_fma_f32 v165, v165, s10, -v5
    v_fma_f32 v166, v166, s10, -v5
    v_fma_f32 v167, v167, s10, -v5
    v_exp_f32 v160, v160
    v_exp_f32 v161, v161
    v_exp_f32 v162, v162
    v_exp_f32 v163, v163
    v_exp_f32 v164, v164
    v_exp_f32 v165, v165
    v_exp_f32 v166, v166
    v_exp_f32 v167, v167
    v_fma_f32 v168, v168, s10, -v5
    v_fma_f32 v169, v169, s10, -v5
    v_fma_f32 v170, v170, s10, -v5
    v_fma_f32 v171, v171, s10, -v5
    v_mfma_f32_32x32x16_bf16 v[48:63], v[220:223], v[180:183], v[48:63]
    v_fma_f32 v172, v172, s10, -v5
    v_fma_f32 v173, v173, s10, -v5
    v_fma_f32 v174, v174, s10, -v5
    v_fma_f32 v175, v175, s10, -v5
    ds_read_b128 v[208:211], v7 offset:22528
    ds_read_b128 v[212:215], v7 offset:23552
    v_exp_f32 v168, v168
    v_exp_f32 v169, v169
    v_exp_f32 v170, v170
    v_exp_f32 v171, v171
    v_exp_f32 v172, v172
    v_exp_f32 v173, v173
    v_exp_f32 v174, v174
    v_exp_f32 v175, v175
    v_cvt_pk_bf16_f32 v160, v160, v161
    v_cvt_pk_bf16_f32 v161, v162, v163
    v_cvt_pk_bf16_f32 v162, v164, v165
    v_cvt_pk_bf16_f32 v163, v166, v167
    v_cvt_pk_bf16_f32 v164, v168, v169
    v_cvt_pk_bf16_f32 v165, v170, v171
    v_cvt_pk_bf16_f32 v166, v172, v173
    v_cvt_pk_bf16_f32 v167, v174, v175
    v_fma_f32 v144, v144, s10, -v5
    v_fma_f32 v145, v145, s10, -v5
    v_fma_f32 v146, v146, s10, -v5
    v_fma_f32 v147, v147, s10, -v5
    s_nop 0
    s_waitcnt lgkmcnt(2)
    v_mfma_f32_32x32x16_bf16 v[48:63], v[224:227], v[160:163], v[48:63]
    v_fma_f32 v148, v148, s10, -v5
    v_fma_f32 v149, v149, s10, -v5
    v_fma_f32 v150, v150, s10, -v5
    v_fma_f32 v151, v151, s10, -v5
    v_exp_f32 v144, v144
    v_exp_f32 v145, v145
    v_exp_f32 v146, v146
    v_exp_f32 v147, v147
    v_exp_f32 v148, v148
    v_exp_f32 v149, v149
    v_exp_f32 v150, v150
    v_exp_f32 v151, v151
    v_fma_f32 v152, v152, s10, -v5
    v_fma_f32 v153, v153, s10, -v5
    v_fma_f32 v154, v154, s10, -v5
    v_fma_f32 v155, v155, s10, -v5
    v_mfma_f32_32x32x16_bf16 v[48:63], v[228:231], v[164:167], v[48:63]
    v_fma_f32 v156, v156, s10, -v5
    v_fma_f32 v157, v157, s10, -v5
    v_fma_f32 v158, v158, s10, -v5
    v_fma_f32 v159, v159, s10, -v5
    ds_read_b128 v[216:219], v7 offset:18432
    ds_read_b128 v[220:223], v7 offset:19456
    v_exp_f32 v152, v152
    v_exp_f32 v153, v153
    v_exp_f32 v154, v154
    v_exp_f32 v155, v155
    v_exp_f32 v156, v156
    v_exp_f32 v157, v157
    v_exp_f32 v158, v158
    v_exp_f32 v159, v159
    v_cvt_pk_bf16_f32 v144, v144, v145
    v_cvt_pk_bf16_f32 v145, v146, v147
    v_cvt_pk_bf16_f32 v146, v148, v149
    v_cvt_pk_bf16_f32 v147, v150, v151
    v_cvt_pk_bf16_f32 v148, v152, v153
    v_cvt_pk_bf16_f32 v149, v154, v155
    v_cvt_pk_bf16_f32 v150, v156, v157
    v_cvt_pk_bf16_f32 v151, v158, v159
    v_fma_f32 v128, v128, s10, -v5
    v_fma_f32 v129, v129, s10, -v5
    v_fma_f32 v130, v130, s10, -v5
    v_fma_f32 v131, v131, s10, -v5
    s_nop 0
    s_waitcnt lgkmcnt(2)
    v_mfma_f32_32x32x16_bf16 v[48:63], v[208:211], v[144:147], v[48:63]
    v_fma_f32 v132, v132, s10, -v5
    v_fma_f32 v133, v133, s10, -v5
    v_fma_f32 v134, v134, s10, -v5
    v_fma_f32 v135, v135, s10, -v5
    v_exp_f32 v128, v128
    v_exp_f32 v129, v129
    v_exp_f32 v130, v130
    v_exp_f32 v131, v131
    v_exp_f32 v132, v132
    v_exp_f32 v133, v133
    v_exp_f32 v134, v134
    v_exp_f32 v135, v135
    v_fma_f32 v136, v136, s10, -v5
    v_fma_f32 v137, v137, s10, -v5
    v_fma_f32 v138, v138, s10, -v5
    v_fma_f32 v139, v139, s10, -v5
    v_mfma_f32_32x32x16_bf16 v[48:63], v[212:215], v[148:151], v[48:63]
    v_fma_f32 v140, v140, s10, -v5
    v_fma_f32 v141, v141, s10, -v5
    v_fma_f32 v142, v142, s10, -v5
    v_fma_f32 v143, v143, s10, -v5
    ds_read_b128 v[224:227], v7 offset:14336
    ds_read_b128 v[228:231], v7 offset:15360
    v_exp_f32 v136, v136
    v_exp_f32 v137, v137
    v_exp_f32 v138, v138
    v_exp_f32 v139, v139
    v_exp_f32 v140, v140
    v_exp_f32 v141, v141
    v_exp_f32 v142, v142
    v_exp_f32 v143, v143
    v_cvt_pk_bf16_f32 v128, v128, v129
    v_cvt_pk_bf16_f32 v129, v130, v131
    v_cvt_pk_bf16_f32 v130, v132, v133
    v_cvt_pk_bf16_f32 v131, v134, v135
    v_cvt_pk_bf16_f32 v132, v136, v137
    v_cvt_pk_bf16_f32 v133, v138, v139
    v_cvt_pk_bf16_f32 v134, v140, v141
    v_cvt_pk_bf16_f32 v135, v142, v143
    v_fma_f32 v112, v112, s10, -v5
    v_fma_f32 v113, v113, s10, -v5
    v_fma_f32 v114, v114, s10, -v5
    v_fma_f32 v115, v115, s10, -v5
    s_nop 0
    s_waitcnt lgkmcnt(2)
    v_mfma_f32_32x32x16_bf16 v[48:63], v[216:219], v[128:131], v[48:63]
    v_fma_f32 v116, v116, s10, -v5
    v_fma_f32 v117, v117, s10, -v5
    v_fma_f32 v118, v118, s10, -v5
    v_fma_f32 v119, v119, s10, -v5
    v_exp_f32 v112, v112
    v_exp_f32 v113, v113
    v_exp_f32 v114, v114
    v_exp_f32 v115, v115
    v_exp_f32 v116, v116
    v_exp_f32 v117, v117
    v_exp_f32 v118, v118
    v_exp_f32 v119, v119
    v_fma_f32 v120, v120, s10, -v5
    v_fma_f32 v121, v121, s10, -v5
    v_fma_f32 v122, v122, s10, -v5
    v_fma_f32 v123, v123, s10, -v5
    v_mfma_f32_32x32x16_bf16 v[48:63], v[220:223], v[132:135], v[48:63]
    v_fma_f32 v124, v124, s10, -v5
    v_fma_f32 v125, v125, s10, -v5
    v_fma_f32 v126, v126, s10, -v5
    v_fma_f32 v127, v127, s10, -v5
    ds_read_b128 v[208:211], v7 offset:10240
    ds_read_b128 v[212:215], v7 offset:11264
    v_exp_f32 v120, v120
    v_exp_f32 v121, v121
    v_exp_f32 v122, v122
    v_exp_f32 v123, v123
    v_exp_f32 v124, v124
    v_exp_f32 v125, v125
    v_exp_f32 v126, v126
    v_exp_f32 v127, v127
    v_cvt_pk_bf16_f32 v112, v112, v113
    v_cvt_pk_bf16_f32 v113, v114, v115
    v_cvt_pk_bf16_f32 v114, v116, v117
    v_cvt_pk_bf16_f32 v115, v118, v119
    v_cvt_pk_bf16_f32 v116, v120, v121
    v_cvt_pk_bf16_f32 v117, v122, v123
    v_cvt_pk_bf16_f32 v118, v124, v125
    v_cvt_pk_bf16_f32 v119, v126, v127
    v_fma_f32 v96, v96, s10, -v5
    v_fma_f32 v97, v97, s10, -v5
    v_fma_f32 v98, v98, s10, -v5
    v_fma_f32 v99, v99, s10, -v5
    s_nop 0
    s_waitcnt lgkmcnt(2)
    v_mfma_f32_32x32x16_bf16 v[48:63], v[224:227], v[112:115], v[48:63]
    v_fma_f32 v100, v100, s10, -v5
    v_fma_f32 v101, v101, s10, -v5
    v_fma_f32 v102, v102, s10, -v5
    v_fma_f32 v103, v103, s10, -v5
    v_exp_f32 v96, v96
    v_exp_f32 v97, v97
    v_exp_f32 v98, v98
    v_exp_f32 v99, v99
    v_exp_f32 v100, v100
    v_exp_f32 v101, v101
    v_exp_f32 v102, v102
    v_exp_f32 v103, v103
    v_fma_f32 v104, v104, s10, -v5
    v_fma_f32 v105, v105, s10, -v5
    v_fma_f32 v106, v106, s10, -v5
    v_fma_f32 v107, v107, s10, -v5
    v_mfma_f32_32x32x16_bf16 v[48:63], v[228:231], v[116:119], v[48:63]
    v_fma_f32 v108, v108, s10, -v5
    v_fma_f32 v109, v109, s10, -v5
    v_fma_f32 v110, v110, s10, -v5
    v_fma_f32 v111, v111, s10, -v5
    ds_read_b128 v[216:219], v7 offset:6144
    ds_read_b128 v[220:223], v7 offset:7168
    v_exp_f32 v104, v104
    v_exp_f32 v105, v105
    v_exp_f32 v106, v106
    v_exp_f32 v107, v107
    v_exp_f32 v108, v108
    v_exp_f32 v109, v109
    v_exp_f32 v110, v110
    v_exp_f32 v111, v111
    v_cvt_pk_bf16_f32 v96, v96, v97
    v_cvt_pk_bf16_f32 v97, v98, v99
    v_cvt_pk_bf16_f32 v98, v100, v101
    v_cvt_pk_bf16_f32 v99, v102, v103
    v_cvt_pk_bf16_f32 v100, v104, v105
    v_cvt_pk_bf16_f32 v101, v106, v107
    v_cvt_pk_bf16_f32 v102, v108, v109
    v_cvt_pk_bf16_f32 v103, v110, v111
    v_fma_f32 v80, v80, s10, -v5
    v_fma_f32 v81, v81, s10, -v5
    v_fma_f32 v82, v82, s10, -v5
    v_fma_f32 v83, v83, s10, -v5
    s_nop 0
    s_waitcnt lgkmcnt(2)
    v_mfma_f32_32x32x16_bf16 v[48:63], v[208:211], v[96:99], v[48:63]
    v_fma_f32 v84, v84, s10, -v5
    v_fma_f32 v85, v85, s10, -v5
    v_fma_f32 v86, v86, s10, -v5
    v_fma_f32 v87, v87, s10, -v5
    v_exp_f32 v80, v80
    v_exp_f32 v81, v81
    v_exp_f32 v82, v82
    v_exp_f32 v83, v83
    v_exp_f32 v84, v84
    v_exp_f32 v85, v85
    v_exp_f32 v86, v86
    v_exp_f32 v87, v87
    v_fma_f32 v88, v88, s10, -v5
    v_fma_f32 v89, v89, s10, -v5
    v_fma_f32 v90, v90, s10, -v5
    v_fma_f32 v91, v91, s10, -v5
    v_mfma_f32_32x32x16_bf16 v[48:63], v[212:215], v[100:103], v[48:63]
    v_fma_f32 v92, v92, s10, -v5
    v_fma_f32 v93, v93, s10, -v5
    v_fma_f32 v94, v94, s10, -v5
    v_fma_f32 v95, v95, s10, -v5
    ds_read_b128 v[224:227], v7 offset:2048
    ds_read_b128 v[228:231], v7 offset:3072
    v_exp_f32 v88, v88
    v_exp_f32 v89, v89
    v_exp_f32 v90, v90
    v_exp_f32 v91, v91
    v_exp_f32 v92, v92
    v_exp_f32 v93, v93
    v_exp_f32 v94, v94
    v_exp_f32 v95, v95
    v_cvt_pk_bf16_f32 v80, v80, v81
    v_cvt_pk_bf16_f32 v81, v82, v83
    v_cvt_pk_bf16_f32 v82, v84, v85
    v_cvt_pk_bf16_f32 v83, v86, v87
    v_cvt_pk_bf16_f32 v84, v88, v89
    v_cvt_pk_bf16_f32 v85, v90, v91
    v_cvt_pk_bf16_f32 v86, v92, v93
    v_cvt_pk_bf16_f32 v87, v94, v95
    v_fma_f32 v64, v64, s10, -v5
    v_fma_f32 v65, v65, s10, -v5
    v_fma_f32 v66, v66, s10, -v5
    v_fma_f32 v67, v67, s10, -v5
    s_nop 0
    s_waitcnt lgkmcnt(2)
    v_mfma_f32_32x32x16_bf16 v[48:63], v[216:219], v[80:83], v[48:63]
    v_fma_f32 v68, v68, s10, -v5
    v_fma_f32 v69, v69, s10, -v5
    v_fma_f32 v70, v70, s10, -v5
    v_fma_f32 v71, v71, s10, -v5
    v_exp_f32 v64, v64
    v_exp_f32 v65, v65
    v_exp_f32 v66, v66
    v_exp_f32 v67, v67
    v_exp_f32 v68, v68
    v_exp_f32 v69, v69
    v_exp_f32 v70, v70
    v_exp_f32 v71, v71
    v_fma_f32 v72, v72, s10, -v5
    v_fma_f32 v73, v73, s10, -v5
    v_fma_f32 v74, v74, s10, -v5
    v_fma_f32 v75, v75, s10, -v5
    v_mfma_f32_32x32x16_bf16 v[48:63], v[220:223], v[84:87], v[48:63]
    v_fma_f32 v76, v76, s10, -v5
    v_fma_f32 v77, v77, s10, -v5
    v_fma_f32 v78, v78, s10, -v5
    v_fma_f32 v79, v79, s10, -v5
    v_exp_f32 v72, v72
    v_exp_f32 v73, v73
    v_exp_f32 v74, v74
    v_exp_f32 v75, v75
    v_exp_f32 v76, v76
    v_exp_f32 v77, v77
    v_exp_f32 v78, v78
    v_exp_f32 v79, v79
    v_cvt_pk_bf16_f32 v64, v64, v65
    v_cvt_pk_bf16_f32 v65, v66, v67
    v_cvt_pk_bf16_f32 v66, v68, v69
    v_cvt_pk_bf16_f32 v67, v70, v71
    v_cvt_pk_bf16_f32 v68, v72, v73
    v_cvt_pk_bf16_f32 v69, v74, v75
    v_cvt_pk_bf16_f32 v70, v76, v77
    v_cvt_pk_bf16_f32 v71, v78, v79
    s_waitcnt lgkmcnt(0)
    v_mfma_f32_32x32x16_bf16 v[48:63], v[224:227], v[64:67], v[48:63]
    v_mfma_f32_32x32x16_bf16 v[48:63], v[228:231], v[68:71], v[48:63]
    s_mov_b64 exec, 1
    ds_add_u32 v250, v251 offset:16
    s_mov_b64 exec, -1
    v_lshrrev_b32 v20, 5, v0
    v_bfe_u32 v21, v0, 2, 2
    v_lshl_add_u32 v16, v20, 3, v21
    v_lshlrev_b32 v16, 7, v16
    v_lshrrev_b32 v21, 1, v21
    v_lshl_add_u32 v16, v21, 6, v16
    v_bfe_u32 v21, v0, 4, 1
    v_lshl_add_u32 v16, v21, 5, v16
    v_and_b32_e64 v21, 1, v0
    v_lshl_add_u32 v16, v21, 4, v16
    v_bfe_u32 v21, v0, 1, 1
    v_lshl_add_u32 v16, v21, 3, v16
    s_lshr_b32 s34, s14, 1
    s_lshl_b32 s34, s34, 6
    v_xor_b32 v16, s34, v16
    s_lshl_b32 s34, s14, 11
    s_add_u32 s34, s34, 0
    v_add_u32 v16, s34, v16
    v_xor_b32 v17, 64, v16
    s_and_b32 s34, s14, 1
    s_mul_i32 s34, s34, 32768
    s_sub_u32 s35, 32768, s34
    v_add_u32 v18, s34, v1
    v_add_u32 v19, s35, v1
    v_mov_b32 v5, v60
    v_mov_b32 v6, v60
    s_nop 1
    v_permlane32_swap_b32 v5, v6
    v_rcp_f32 v6, v6
    s_nop 0
    v_mul_f32 v48, v48, v6
    v_mul_f32 v49, v49, v6
    v_mul_f32 v50, v50, v6
    v_mul_f32 v51, v51, v6
    v_mul_f32 v52, v52, v6
    v_mul_f32 v53, v53, v6
    v_mul_f32 v54, v54, v6
    v_mul_f32 v55, v55, v6
    v_mul_f32 v56, v56, v6
    v_mul_f32 v57, v57, v6
    v_mul_f32 v58, v58, v6
    v_mul_f32 v59, v59, v6
    v_mul_f32 v60, v60, v6
    v_mul_f32 v61, v61, v6
    v_mul_f32 v62, v62, v6
    v_mul_f32 v63, v63, v6
    v_cvt_pk_bf16_f32 v8, v48, v49
    v_cvt_pk_bf16_f32 v9, v50, v51
    v_cvt_pk_bf16_f32 v10, v52, v53
    v_cvt_pk_bf16_f32 v11, v54, v55
    v_cvt_pk_bf16_f32 v12, v56, v57
    v_cvt_pk_bf16_f32 v13, v58, v59
    v_cvt_pk_bf16_f32 v14, v60, v61
    v_cvt_pk_bf16_f32 v15, v62, v63
    v_cndmask_b32 v14, v14, 0, s[72:73]
    v_cndmask_b32 v15, v15, 0, s[72:73]
    buffer_store_dwordx4 v[8:11], v1, s[48:51], s28 offen sc1
    buffer_store_dwordx4 v[12:15], v1, s[48:51], s28 offen offset:1024 sc1
    s_lshl_b32 s30, s26, 16
    s_and_b32 s34, s14, 2
    s_lshl_b32 s34, s34, 13
    s_add_u32 s30, s30, s34
    s_add_u32 s30, s30, 16777216
    s_lshl_b32 s31, s26, 7
    s_add_u32 s31, s31, 18964480
    v_and_b32 v20, 31, v0
    v_lshlrev_b32 v20, 2, v20
    s_lshl_b32 s34, s14, 11
    s_add_u32 s34, s34, 65536
    v_add_u32_e64 v22, s34, v1
    v_xor_b32 v23, 4096, v22
    s_and_b32 s34, s14, 1
    s_lshl_b32 s35, s34, 11
    v_subrev_u32 v16, s35, v16
    v_subrev_u32 v17, s35, v17
    s_lshl_b32 s34, s34, 4
    v_add_u32 v24, s34, v250
    s_and_b32 s34, s14, 2
    s_lshl_b32 s34, s34, 4
    v_add_u32 v25, s34, v250
    s_lshl_b32 s34, s14, 4
    v_add_u32 v26, s34, v250
    s_lshl_b32 s34, s26, 6
    s_and_b32 s35, s14, 1
    s_lshl_b32 s35, s35, 5
    s_add_u32 s34, s34, s35
    v_and_b32 v27, 31, v0
    v_add_u32_e64 v27, s34, v27
    v_mul_u32_u24 v27, 896, v27
    v_lshrrev_b32_e64 v28, 5, v0
    v_lshl_add_u32 v27, v28, 4, v27
    s_lshr_b32 s34, s14, 1
    s_lshl_b32 s34, s34, 6
    s_add_u32 s25, s27, s34
    s_lshl_b32 s34, s14, 11
    s_add_u32 s34, s34, 135168
    v_add_u32_e64 v28, s34, v1
    buffer_load_dwordx4 v[32:35], v27, s[52:55], s25 offen
    buffer_load_dwordx4 v[36:39], v27, s[52:55], s25 offen offset:32
    s_waitcnt vmcnt(2)
    buffer_store_dword v252, off, s[48:51], s23 sc1
    s_cmp_ge_u32 s4, 28
    s_cbranch_scc1 L_exit
    s_waitcnt vmcnt(1)
    v_lshlrev_b32_e64 v40, 16, v32
    v_and_b32 v41, 0xffff0000, v32
    v_lshlrev_b32_e64 v42, 16, v33
    v_and_b32 v43, 0xffff0000, v33
    v_lshlrev_b32_e64 v44, 16, v34
    v_and_b32 v45, 0xffff0000, v34
    v_lshlrev_b32_e64 v46, 16, v35
    v_and_b32 v47, 0xffff0000, v35
    v_lshlrev_b32_e64 v48, 16, v36
    v_and_b32 v49, 0xffff0000, v36
    v_lshlrev_b32_e64 v50, 16, v37
    v_and_b32 v51, 0xffff0000, v37
    v_lshlrev_b32_e64 v52, 16, v38
    v_and_b32 v53, 0xffff0000, v38
    v_lshlrev_b32 v54, 16, v39
    v_and_b32 v55, 0xffff0000, v39
    s_setprio 0
    s_cmp_eq_u32 s14, 0
    s_cbranch_scc1 L_wp44
    s_mov_b32 s76, 200000
L_ll45:
    ds_read_b32 v253, v25 offset:128
    s_waitcnt lgkmcnt(0)
    v_readfirstlane_b32 s77, v253
    s_nop 0
    s_cmp_eq_u32 s77, 1
    s_cbranch_scc1 L_lk45
    s_sleep 1
    s_sub_u32 s76, s76, 1
    s_cbranch_scc0 L_ll45
L_lk45:
    s_mov_b32 s76, 200000
L_ll46:
    ds_read_b32 v253, v25 offset:144
    s_waitcnt lgkmcnt(0)
    v_readfirstlane_b32 s77, v253
    s_nop 0
    s_cmp_eq_u32 s77, 1
    s_cbranch_scc1 L_lk46
    s_sleep 1
    s_sub_u32 s76, s76, 1
    s_cbranch_scc0 L_ll46
L_lk46:
    ds_read_b64_tr_b16 v[152:153], v16 offset:0
    ds_read_b64_tr_b16 v[154:155], v16 offset:512
    ds_read_b64_tr_b16 v[156:157], v17 offset:0
    ds_read_b64_tr_b16 v[158:159], v17 offset:512
    ds_read_b64_tr_b16 v[160:161], v16 offset:8192
    ds_read_b64_tr_b16 v[162:163], v16 offset:8704
    ds_read_b64_tr_b16 v[164:165], v17 offset:8192
    ds_read_b64_tr_b16 v[166:167], v17 offset:8704
    ds_read_b64_tr_b16 v[168:169], v16 offset:16384
    ds_read_b64_tr_b16 v[170:171], v16 offset:16896
    ds_read_b64_tr_b16 v[172:173], v17 offset:16384
    ds_read_b64_tr_b16 v[174:175], v17 offset:16896
    ds_read_b64_tr_b16 v[176:177], v16 offset:24576
    ds_read_b64_tr_b16 v[178:179], v16 offset:25088
    ds_read_b64_tr_b16 v[180:181], v17 offset:24576
    ds_read_b64_tr_b16 v[182:183], v17 offset:25088
    ds_read_b64_tr_b16 v[184:185], v16 offset:32768
    ds_read_b64_tr_b16 v[186:187], v16 offset:33280
    ds_read_b64_tr_b16 v[188:189], v17 offset:32768
    ds_read_b64_tr_b16 v[190:191], v17 offset:33280
    ds_read_b64_tr_b16 v[192:193], v16 offset:40960
    ds_read_b64_tr_b16 v[194:195], v16 offset:41472
    ds_read_b64_tr_b16 v[196:197], v17 offset:40960
    ds_read_b64_tr_b16 v[198:199], v17 offset:41472
    ds_read_b64_tr_b16 v[200:201], v16 offset:49152
    ds_read_b64_tr_b16 v[202:203], v16 offset:49664
    ds_read_b64_tr_b16 v[204:205], v17 offset:49152
    ds_read_b64_tr_b16 v[206:207], v17 offset:49664
    ds_read_b64_tr_b16 v[208:209], v16 offset:57344
    ds_read_b64_tr_b16 v[210:211], v16 offset:57856
    ds_read_b64_tr_b16 v[212:213], v17 offset:57344
    ds_read_b64_tr_b16 v[214:215], v17 offset:57856
    ds_read_b64_tr_b16 v[216:217], v16 offset:2048
    ds_read_b64_tr_b16 v[218:219], v16 offset:2560
    ds_read_b64_tr_b16 v[220:221], v17 offset:2048
    ds_read_b64_tr_b16 v[222:223], v17 offset:2560
    ds_read_b64_tr_b16 v[224:225], v16 offset:10240
    ds_read_b64_tr_b16 v[226:227], v16 offset:10752
    ds_read_b64_tr_b16 v[228:229], v17 offset:10240
    ds_read_b64_tr_b16 v[230:231], v17 offset:10752
    ds_read_b64_tr_b16 v[232:233], v16 offset:18432
    ds_read_b64_tr_b16 v[234:235], v16 offset:18944
    ds_read_b64_tr_b16 v[236:237], v17 offset:18432
    ds_read_b64_tr_b16 v[238:239], v17 offset:18944
    ds_read_b64_tr_b16 v[240:241], v16 offset:26624
    ds_read_b64_tr_b16 v[242:243], v16 offset:27136
    ds_read_b64_tr_b16 v[244:245], v17 offset:26624
    ds_read_b64_tr_b16 v[246:247], v17 offset:27136
L_wp44:
    s_cmp_lg_u32 s14, 0
    s_cbranch_scc1 L_fo47
    s_mov_b32 s76, 200000
L_fp47:
    s_sleep 22
    buffer_load_dword v21, v20, s[48:51], s31 offen sc1
    s_waitcnt vmcnt(0)
    v_cmp_ne_u32 vcc, s97, v21
    s_cbranch_vccz L_fq47
    s_sub_u32 s76, s76, 1
    s_cbranch_scc0 L_fp47
L_fq47:
    ds_write_b32 v250, v251 offset:192
L_fo47:
    s_mov_b32 s76, 200000
L_ll48:
    ds_read_b32 v253, v250 offset:192
    s_waitcnt lgkmcnt(0)
    v_readfirstlane_b32 s77, v253
    s_nop 0
    s_cmp_eq_u32 s77, 1
    s_cbranch_scc1 L_lk48
    s_sleep 1
    s_sub_u32 s76, s76, 1
    s_cbranch_scc0 L_ll48
L_lk48:
    s_nop 0
    s_setprio 0
    buffer_load_dwordx4 v[88:91], v18, s[48:51], s30 offen offset:0 sc1
    buffer_load_dwordx4 v[92:95], v18, s[48:51], s30 offen offset:1024 sc1
    buffer_load_dwordx4 v[96:99], v18, s[48:51], s30 offen offset:2048 sc1
    buffer_load_dwordx4 v[100:103], v18, s[48:51], s30 offen offset:3072 sc1
    s_add_u32 s30, s30, 4096
    buffer_load_dwordx4 v[104:107], v18, s[48:51], s30 offen offset:0 sc1
    buffer_load_dwordx4 v[108:111], v18, s[48:51], s30 offen offset:1024 sc1
    buffer_load_dwordx4 v[112:115], v18, s[48:51], s30 offen offset:2048 sc1
    buffer_load_dwordx4 v[116:119], v18, s[48:51], s30 offen offset:3072 sc1
    s_add_u32 s30, s30, 4096
    buffer_load_dwordx4 v[120:123], v18, s[48:51], s30 offen offset:0 sc1
    buffer_load_dwordx4 v[124:127], v18, s[48:51], s30 offen offset:1024 sc1
    buffer_load_dwordx4 v[128:131], v18, s[48:51], s30 offen offset:2048 sc1
    buffer_load_dwordx4 v[132:135], v18, s[48:51], s30 offen offset:3072 sc1
    s_add_u32 s30, s30, 4096
    buffer_load_dwordx4 v[136:139], v18, s[48:51], s30 offen offset:0 sc1
    buffer_load_dwordx4 v[140:143], v18, s[48:51], s30 offen offset:1024 sc1
    buffer_load_dwordx4 v[144:147], v18, s[48:51], s30 offen offset:2048 sc1
    buffer_load_dwordx4 v[148:151], v18, s[48:51], s30 offen offset:3072 sc1
    s_cmp_eq_u32 s14, 0
    s_cbranch_scc0 L_wp49
    s_mov_b32 s76, 200000
L_ll50:
    ds_read_b32 v253, v25 offset:128
    s_waitcnt lgkmcnt(0)
    v_readfirstlane_b32 s77, v253
    s_nop 0
    s_cmp_eq_u32 s77, 1
    s_cbranch_scc1 L_lk50
    s_sleep 1
    s_sub_u32 s76, s76, 1
    s_cbranch_scc0 L_ll50
L_lk50:
    s_mov_b32 s76, 200000
L_ll51:
    ds_read_b32 v253, v25 offset:144
    s_waitcnt lgkmcnt(0)
    v_readfirstlane_b32 s77, v253
    s_nop 0
    s_cmp_eq_u32 s77, 1
    s_cbranch_scc1 L_lk51
    s_sleep 1
    s_sub_u32 s76, s76, 1
    s_cbranch_scc0 L_ll51
L_lk51:
    ds_read_b64_tr_b16 v[152:153], v16 offset:0
    ds_read_b64_tr_b16 v[154:155], v16 offset:512
    ds_read_b64_tr_b16 v[156:157], v17 offset:0
    ds_read_b64_tr_b16 v[158:159], v17 offset:512
    ds_read_b64_tr_b16 v[160:161], v16 offset:8192
    ds_read_b64_tr_b16 v[162:163], v16 offset:8704
    ds_read_b64_tr_b16 v[164:165], v17 offset:8192
    ds_read_b64_tr_b16 v[166:167], v17 offset:8704
    ds_read_b64_tr_b16 v[168:169], v16 offset:16384
    ds_read_b64_tr_b16 v[170:171], v16 offset:16896
    ds_read_b64_tr_b16 v[172:173], v17 offset:16384
    ds_read_b64_tr_b16 v[174:175], v17 offset:16896
    ds_read_b64_tr_b16 v[176:177], v16 offset:24576
    ds_read_b64_tr_b16 v[178:179], v16 offset:25088
    ds_read_b64_tr_b16 v[180:181], v17 offset:24576
    ds_read_b64_tr_b16 v[182:183], v17 offset:25088
    ds_read_b64_tr_b16 v[184:185], v16 offset:32768
    ds_read_b64_tr_b16 v[186:187], v16 offset:33280
    ds_read_b64_tr_b16 v[188:189], v17 offset:32768
    ds_read_b64_tr_b16 v[190:191], v17 offset:33280
    ds_read_b64_tr_b16 v[192:193], v16 offset:40960
    ds_read_b64_tr_b16 v[194:195], v16 offset:41472
    ds_read_b64_tr_b16 v[196:197], v17 offset:40960
    ds_read_b64_tr_b16 v[198:199], v17 offset:41472
    ds_read_b64_tr_b16 v[200:201], v16 offset:49152
    ds_read_b64_tr_b16 v[202:203], v16 offset:49664
    ds_read_b64_tr_b16 v[204:205], v17 offset:49152
    ds_read_b64_tr_b16 v[206:207], v17 offset:49664
    ds_read_b64_tr_b16 v[208:209], v16 offset:57344
    ds_read_b64_tr_b16 v[210:211], v16 offset:57856
    ds_read_b64_tr_b16 v[212:213], v17 offset:57344
    ds_read_b64_tr_b16 v[214:215], v17 offset:57856
    ds_read_b64_tr_b16 v[216:217], v16 offset:2048
    ds_read_b64_tr_b16 v[218:219], v16 offset:2560
    ds_read_b64_tr_b16 v[220:221], v17 offset:2048
    ds_read_b64_tr_b16 v[222:223], v17 offset:2560
    ds_read_b64_tr_b16 v[224:225], v16 offset:10240
    ds_read_b64_tr_b16 v[226:227], v16 offset:10752
    ds_read_b64_tr_b16 v[228:229], v17 offset:10240
    ds_read_b64_tr_b16 v[230:231], v17 offset:10752
    ds_read_b64_tr_b16 v[232:233], v16 offset:18432
    ds_read_b64_tr_b16 v[234:235], v16 offset:18944
    ds_read_b64_tr_b16 v[236:237], v17 offset:18432
    ds_read_b64_tr_b16 v[238:239], v17 offset:18944
    ds_read_b64_tr_b16 v[240:241], v16 offset:26624
    ds_read_b64_tr_b16 v[242:243], v16 offset:27136
    ds_read_b64_tr_b16 v[244:245], v17 offset:26624
    ds_read_b64_tr_b16 v[246:247], v17 offset:27136
L_wp49:
    s_waitcnt vmcnt(15) lgkmcnt(0)
    v_mfma_f32_32x32x16_bf16 v[72:87], v[156:159], v[88:91], 0
    v_mfma_f32_32x32x16_bf16 v[56:71], v[152:155], v[88:91], 0
    s_waitcnt vmcnt(14)
    v_mfma_f32_32x32x16_bf16 v[72:87], v[164:167], v[92:95], v[72:87]
    v_mfma_f32_32x32x16_bf16 v[56:71], v[160:163], v[92:95], v[56:71]
    ds_read_b64_tr_b16 v[152:153], v16 offset:34816
    ds_read_b64_tr_b16 v[154:155], v16 offset:35328
    ds_read_b64_tr_b16 v[156:157], v17 offset:34816
    ds_read_b64_tr_b16 v[158:159], v17 offset:35328
    s_waitcnt vmcnt(13)
    v_mfma_f32_32x32x16_bf16 v[72:87], v[172:175], v[96:99], v[72:87]
    v_mfma_f32_32x32x16_bf16 v[56:71], v[168:171], v[96:99], v[56:71]
    ds_read_b64_tr_b16 v[160:161], v16 offset:43008
    ds_read_b64_tr_b16 v[162:163], v16 offset:43520
    ds_read_b64_tr_b16 v[164:165], v17 offset:43008
    ds_read_b64_tr_b16 v[166:167], v17 offset:43520
    s_waitcnt vmcnt(12)
    v_mfma_f32_32x32x16_bf16 v[72:87], v[180:183], v[100:103], v[72:87]
    v_mfma_f32_32x32x16_bf16 v[56:71], v[176:179], v[100:103], v[56:71]
    ds_read_b64_tr_b16 v[168:169], v16 offset:51200
    ds_read_b64_tr_b16 v[170:171], v16 offset:51712
    ds_read_b64_tr_b16 v[172:173], v17 offset:51200
    ds_read_b64_tr_b16 v[174:175], v17 offset:51712
    s_nop 0
    s_waitcnt vmcnt(11)
    v_mfma_f32_32x32x16_bf16 v[72:87], v[188:191], v[104:107], v[72:87]
    v_mfma_f32_32x32x16_bf16 v[56:71], v[184:187], v[104:107], v[56:71]
    ds_read_b64_tr_b16 v[176:177], v16 offset:59392
    ds_read_b64_tr_b16 v[178:179], v16 offset:59904
    ds_read_b64_tr_b16 v[180:181], v17 offset:59392
    ds_read_b64_tr_b16 v[182:183], v17 offset:59904
    s_waitcnt vmcnt(10)
    v_mfma_f32_32x32x16_bf16 v[72:87], v[196:199], v[108:111], v[72:87]
    v_mfma_f32_32x32x16_bf16 v[56:71], v[192:195], v[108:111], v[56:71]
    s_waitcnt vmcnt(9)
    v_mfma_f32_32x32x16_bf16 v[72:87], v[204:207], v[112:115], v[72:87]
    v_mfma_f32_32x32x16_bf16 v[56:71], v[200:203], v[112:115], v[56:71]
    s_waitcnt vmcnt(8)
    v_mfma_f32_32x32x16_bf16 v[72:87], v[212:215], v[116:119], v[72:87]
    v_mfma_f32_32x32x16_bf16 v[56:71], v[208:211], v[116:119], v[56:71]
    s_waitcnt vmcnt(7)
    v_mfma_f32_32x32x16_bf16 v[72:87], v[220:223], v[120:123], v[72:87]
    v_mfma_f32_32x32x16_bf16 v[56:71], v[216:219], v[120:123], v[56:71]
    s_waitcnt vmcnt(6)
    v_mfma_f32_32x32x16_bf16 v[72:87], v[228:231], v[124:127], v[72:87]
    v_mfma_f32_32x32x16_bf16 v[56:71], v[224:227], v[124:127], v[56:71]
    s_waitcnt vmcnt(5)
    v_mfma_f32_32x32x16_bf16 v[72:87], v[236:239], v[128:131], v[72:87]
    v_mfma_f32_32x32x16_bf16 v[56:71], v[232:235], v[128:131], v[56:71]
    s_waitcnt vmcnt(4)
    v_mfma_f32_32x32x16_bf16 v[72:87], v[244:247], v[132:135], v[72:87]
    v_mfma_f32_32x32x16_bf16 v[56:71], v[240:243], v[132:135], v[56:71]
    s_waitcnt vmcnt(3) lgkmcnt(12)
    v_mfma_f32_32x32x16_bf16 v[72:87], v[156:159], v[136:139], v[72:87]
    v_mfma_f32_32x32x16_bf16 v[56:71], v[152:155], v[136:139], v[56:71]
    s_waitcnt vmcnt(2) lgkmcnt(8)
    v_mfma_f32_32x32x16_bf16 v[72:87], v[164:167], v[140:143], v[72:87]
    v_mfma_f32_32x32x16_bf16 v[56:71], v[160:163], v[140:143], v[56:71]
    s_waitcnt vmcnt(1) lgkmcnt(4)
    v_mfma_f32_32x32x16_bf16 v[72:87], v[172:175], v[144:147], v[72:87]
    v_mfma_f32_32x32x16_bf16 v[56:71], v[168:171], v[144:147], v[56:71]
    s_waitcnt vmcnt(0) lgkmcnt(0)
    v_mfma_f32_32x32x16_bf16 v[72:87], v[180:183], v[148:151], v[72:87]
    v_mfma_f32_32x32x16_bf16 v[56:71], v[176:179], v[148:151], v[56:71]
    s_nop 10
    ds_write_b128 v22, v[72:75] offset:0
    ds_write_b128 v22, v[76:79] offset:1024
    ds_write_b128 v22, v[80:83] offset:8192
    ds_write_b128 v22, v[84:87] offset:9216
    s_waitcnt lgkmcnt(0)
    s_mov_b64 exec, 1
    ds_add_u32 v24, v251 offset:320
    s_nop 0
    s_mov_b64 exec, -1
    s_mov_b32 s76, 200000
L_ll52:
    ds_read_b32 v253, v24 offset:320
    s_waitcnt lgkmcnt(0)
    v_readfirstlane_b32 s77, v253
    s_nop 0
    s_cmp_eq_u32 s77, 2
    s_cbranch_scc1 L_lk52
    s_sleep 1
    s_sub_u32 s76, s76, 1
    s_cbranch_scc0 L_ll52
L_lk52:
    ds_read_b128 v[88:91], v23 offset:0
    ds_read_b128 v[92:95], v23 offset:1024
    ds_read_b128 v[96:99], v23 offset:8192
    ds_read_b128 v[100:103], v23 offset:9216
    s_mov_b32 s76, 200000
L_ll53:
    ds_read_b32 v253, v26 offset:256
    s_waitcnt lgkmcnt(0)
    v_readfirstlane_b32 s77, v253
    s_nop 0
    s_cmp_eq_u32 s77, 1
    s_cbranch_scc1 L_lk53
    s_sleep 1
    s_sub_u32 s76, s76, 1
    s_cbranch_scc0 L_ll53
L_lk53:
    ds_read_b128 v[152:155], v28 offset:0
    ds_read_b128 v[156:159], v28 offset:1024
    ds_read_b128 v[160:163], v28 offset:8192
    ds_read_b128 v[164:167], v28 offset:9216
    v_pk_add_f32 v[56:57], v[56:57], v[88:89]
    v_pk_add_f32 v[58:59], v[58:59], v[90:91]
    v_pk_add_f32 v[60:61], v[60:61], v[92:93]
    v_pk_add_f32 v[62:63], v[62:63], v[94:95]
    v_pk_add_f32 v[64:65], v[64:65], v[96:97]
    v_pk_add_f32 v[66:67], v[66:67], v[98:99]
    v_pk_add_f32 v[68:69], v[68:69], v[100:101]
    v_pk_add_f32 v[70:71], v[70:71], v[102:103]
    s_nop 0
    s_waitcnt lgkmcnt(2)
    v_pk_fma_f32 v[56:57], v[56:57], v[152:153], v[40:41]
    v_pk_fma_f32 v[58:59], v[58:59], v[154:155], v[42:43]
    v_pk_fma_f32 v[60:61], v[60:61], v[156:157], v[44:45]
    v_pk_fma_f32 v[62:63], v[62:63], v[158:159], v[46:47]
    v_cvt_pk_bf16_f32 v32, v56, v57
    v_cvt_pk_bf16_f32 v33, v58, v59
    v_cvt_pk_bf16_f32 v34, v60, v61
    v_cvt_pk_bf16_f32 v35, v62, v63
    buffer_store_dwordx4 v[32:35], v27, s[64:67], s25 offen offset:0
    s_nop 0
    s_waitcnt lgkmcnt(0)
    v_pk_fma_f32 v[64:65], v[64:65], v[160:161], v[48:49]
    v_pk_fma_f32 v[66:67], v[66:67], v[162:163], v[50:51]
    v_pk_fma_f32 v[68:69], v[68:69], v[164:165], v[52:53]
    v_pk_fma_f32 v[70:71], v[70:71], v[166:167], v[54:55]
    v_cvt_pk_bf16_f32 v36, v64, v65
    v_cvt_pk_bf16_f32 v37, v66, v67
    v_cvt_pk_bf16_f32 v38, v68, v69
    v_cvt_pk_bf16_f32 v39, v70, v71
    buffer_store_dwordx4 v[36:39], v27, s[64:67], s25 offen offset:32
L_exit:
    s_endpgm
L_end:
    s_endpgm
L_code_end:
.section .rodata,"a"
.p2align 6
.amdhsa_kernel recurrent_scan__sliding_block__geglu_ffn__prompt_kernel
  .amdhsa_next_free_vgpr 256
  .amdhsa_next_free_sgpr 102
  .amdhsa_accum_offset 256
  .amdhsa_group_segment_fixed_size 0
  .amdhsa_kernarg_size 80
  .amdhsa_user_sgpr_count 2
  .amdhsa_user_sgpr_kernarg_segment_ptr 1
  .amdhsa_system_sgpr_workgroup_id_x 1
.end_amdhsa_kernel
```
